```python
import torch

def _softmax(x, axis=-1):
    return torch.softmax(x, dim=axis)

def _gelu(x):
    return torch.nn.functional.gelu(x, approximate='tanh')

def _silu(x):
    return torch.nn.functional.silu(x)

def _sigmoid(x):
    return torch.sigmoid(x)

def _layernorm(x, axis=-1, eps=1e-05):
    m = x.mean(dim=axis, keepdim=True)
    v = x.var(dim=axis, keepdim=True, unbiased=False)
    return (x - m) / torch.sqrt(v + eps)

def _scatter_add(tgt, idx, src, axis=0):
    return tgt.clone().index_add_(axis, idx, src)

def _segment_sum(src, seg, n):
    out = torch.zeros((n,) + src.shape[1:], dtype=src.dtype)
    return out.index_add_(0, seg, src)

def _pad(x, pw):
    flat = tuple((v for pair in reversed(pw) for v in pair))
    return torch.nn.functional.pad(x, flat)
kernel_name = 'concat_heads__linear_kernel_hedgehog__memory_aug_recurrent_mem_tr__prompt'

def setup_inputs():

    _w = lambda a: (lambda t: t.to(torch.bfloat16) if t.is_floating_point() else t)(torch.as_tensor(a))

    def _A_setup():
        B, S, D, H = (1, 2048, 640, 32)
        Dh = D // H
        return {'x': _w((lambda *s: torch.randn(*s, dtype=torch.bfloat16) * 0.8)(B, S, D)), 'wqkv': _w((lambda *s: torch.randn(*s, dtype=torch.bfloat16) * 0.8)(D, 3 * D)), 'w_phi': _w((lambda *s: torch.randn(*s, dtype=torch.bfloat16) * 0.8)(H, Dh, Dh) * Dh ** (-0.5)), 'wo': _w((lambda *s: torch.randn(*s, dtype=torch.bfloat16) * 0.05)(D, D))}
    _A_in = _A_setup()

    def _B_setup():
        B, S, Dm = (1, 2048, 640)
        H, Dh = (32, 192)
        M, seg = (8, 32)
        seg = min(seg, S)
        S = S // seg * seg
        return {'x': _w((lambda *s: torch.randn(*s, dtype=torch.bfloat16) * 0.05)(B, S, Dm)), 'mem0': _w((lambda *s: torch.randn(*s, dtype=torch.bfloat16) * 1.6)(B, M, Dm)), 'Wq': _w((lambda *s: torch.randn(*s, dtype=torch.bfloat16) * 0.8)(Dm, H, Dh) * Dm ** (-0.5)), 'Wk': _w((lambda *s: torch.randn(*s, dtype=torch.bfloat16) * 0.8)(Dm, H, Dh) * Dm ** (-0.5)), 'Wv': _w((lambda *s: torch.randn(*s, dtype=torch.bfloat16) * 1.6)(Dm, H, Dh) * Dm ** (-0.5)), 'Wo': _w((lambda *s: torch.randn(*s, dtype=torch.bfloat16) * 1.6)(H, Dh, Dm) * (H * Dh) ** (-0.5)), 'seg_len': seg}
    _B_in = _B_setup()
    return {'A_x': _A_in['x'], 'A_wqkv': _A_in['wqkv'], 'A_w_phi': _A_in['w_phi'], 'A_wo': _A_in['wo'], 'B_x': _B_in['x'], 'B_mem0': _B_in['mem0'], 'B_Wq': _B_in['Wq'], 'B_Wk': _B_in['Wk'], 'B_Wv': _B_in['Wv'], 'B_Wo': _B_in['Wo'], 'B_seg_len': _B_in['seg_len']}

def reference(A_x, A_wqkv, A_w_phi, A_wo, B_x, B_mem0, B_Wq, B_Wk, B_Wv, B_Wo, B_seg_len):

    def _A_ref(x, wqkv, w_phi, wo):
        B, S, D = x.shape
        H = 32
        Dh = D // H
        qkv = (lambda x, *d: x.permute(*d))((x @ wqkv).reshape(B, S, 3, H, Dh), 2, 0, 3, 1, 4)
        q, k, v = (qkv[0], qkv[1], qkv[2])
        pq = torch.einsum('bhsd,hdf->bhsf', q, w_phi)
        pk = torch.einsum('bhsd,hdf->bhsf', k, w_phi)
        phi_q = torch.concatenate([_softmax(pq, axis=-1), _softmax(-pq, axis=-1)], axis=-1)
        phi_k = torch.concatenate([_softmax(pk, axis=-1), _softmax(-pk, axis=-1)], axis=-1)
        kv = torch.einsum('bhsf,bhsd->bhfd', phi_k, v)
        z = torch.einsum('bhsf->bhf', phi_k)
        num = torch.einsum('bhqf,bhfd->bhqd', phi_q, kv)
        den = torch.einsum('bhqf,bhf->bhq', phi_q, z)[..., None] + 1e-06
        o = num / den
        return (lambda x, *d: x.permute(*d))(o, 0, 2, 1, 3).reshape(B, S, D) @ wo

    def _B_ref(x, mem0, Wq, Wk, Wv, Wo, seg_len):
        B, S, Dm = x.shape
        H, Dh = (Wq.shape[1], Wq.shape[2])
        M = mem0.shape[1]
        scale = Dh ** (-0.5)
        n_seg = S // seg_len
        L = M + seg_len
        idx = torch.arange(L)
        mask = (idx[:, None] < M) | (idx[:, None] >= idx[None, :])
        mem = mem0
        outs = []
        for s in range(n_seg):
            xs = x[:, s * seg_len:(s + 1) * seg_len, :].clone()
            h = torch.concatenate([mem, xs], axis=1)
            q = torch.einsum('btd,dhe->bhte', h, Wq)
            k = torch.einsum('btd,dhe->bhte', h, Wk)
            v = torch.einsum('btd,dhe->bhte', h, Wv)
            scores = torch.einsum('bhqe,bhke->bhqk', q, k) * scale
            scores = torch.where(mask[None, None], scores, -1000000000.0)
            p = _softmax(scores, axis=-1)
            o = torch.einsum('bhqk,bhke->bhqe', p, v)
            o = torch.einsum('bhte,hed->btd', o, Wo)
            mem = o[:, :M, :].clone()
            outs.append(o[:, M:, :])
        return torch.concatenate(outs, axis=1)
    a = _A_ref(A_x, A_wqkv, A_w_phi, A_wo)
    b = _B_ref(B_x, B_mem0, B_Wq, B_Wk, B_Wv, B_Wo, B_seg_len)
    return torch.concatenate([a, b], axis=-1)
```

```asm
; @launch grid=(256,1,1) block=(512,1,1) lds=163840
.amdgcn_target "amdgcn-amd-amdhsa--gfx950"
.text
.globl concat_heads__linear_kernel_hedgehog__memory_aug_recurrent_mem_tr__prompt_kernel
.p2align 8
.type concat_heads__linear_kernel_hedgehog__memory_aug_recurrent_mem_tr__prompt_kernel,@function
concat_heads__linear_kernel_hedgehog__memory_aug_recurrent_mem_tr__prompt_kernel:
    s_cmp_ge_u32 s2, 256
    s_cbranch_scc1 L_end
    s_load_dwordx16 s[4:19], s[0:1], 0
    s_load_dwordx8 s[20:27], s[0:1], 64
    s_load_dwordx4 s[28:31], s[0:1], 96
    s_getreg_b32 s56, hwreg(HW_REG_XCC_ID, 0, 3)
    v_lshrrev_b32 v1, 6, v0
    v_and_b32 v0, 63, v0
    v_readfirstlane_b32 s57, v1
    s_mov_b32 s60, 300000
    v_mov_b32 v2, 157696
    s_waitcnt lgkmcnt(0)
    s_mov_b32 s32, s30
    s_and_b32 s33, s31, 0xffff
    s_mov_b32 s34, 0x10000000
    s_mov_b32 s35, 0x20000
    s_mov_b32 s36, s28
    s_and_b32 s37, s29, 0xffff
    s_mov_b32 s38, 0x100
    s_mov_b32 s39, 0x20000
    s_cmp_lg_u32 s57, 0
    s_cbranch_scc1 L_ticket
    s_lshl_b32 s61, s56, 5
    v_mov_b32 v1, 1
    v_mov_b32 v3, 0
    s_mov_b64 exec, 1
    buffer_atomic_add v1, v3, s[36:39], s61 offen sc0
    s_waitcnt vmcnt(0)
    ds_write_b32 v2, v1
    s_mov_b64 exec, -1
    s_waitcnt lgkmcnt(0)
L_ticket:
    s_barrier
    ds_read_b32 v1, v2
    s_waitcnt lgkmcnt(0)
    v_readfirstlane_b32 s58, v1
    s_nop 1
    s_cmp_lt_u32 s58, 12
    s_cbranch_scc1 L_role_p
    s_cmp_lt_u32 s58, 22
    s_cbranch_scc1 L_role_o
    s_cmp_lt_u32 s58, 24
    s_cbranch_scc1 L_role_ax
    s_cmp_lt_u32 s58, 28
    s_cbranch_scc1 L_role_ox
    s_cmp_lt_u32 s58, 32
    s_cbranch_scc1 L_role_a
L_end:
    s_endpgm
L_role_p:
    s_mul_i32 s61, s58, 11
    s_lshr_b32 s61, s61, 5
    s_mul_i32 s62, s61, 3
    s_sub_u32 s62, s58, s62
    s_lshl_b32 s63, s56, 2
    s_add_u32 s63, s63, s61
    s_lshl_b32 s64, s56, 17
    s_add_u32 s64, s64, 0xa000000
    s_mov_b32 s40, s16
    s_and_b32 s41, s17, 0xffff
    s_mov_b32 s42, 0x780000
    s_mov_b32 s43, 0x20000
    s_mov_b32 s44, s18
    s_and_b32 s45, s19, 0xffff
    s_mov_b32 s46, 0x780000
    s_mov_b32 s47, 0x20000
    s_mov_b32 s48, s20
    s_and_b32 s49, s21, 0xffff
    s_mov_b32 s50, 0x780000
    s_mov_b32 s51, 0x20000
    s_mov_b32 s52, s12
    s_and_b32 s53, s13, 0xffff
    s_mov_b32 s54, 0x280000
    s_mov_b32 s55, 0x20000
    v_lshrrev_b32 v88, 3, v0
    v_and_b32 v89, 2, v88
    s_and_b32 s71, s57, 1
    s_lshl_b32 s71, s71, 2
    v_or_b32 v89, s71, v89
    v_and_b32 v90, 7, v0
    v_xor_b32 v89, v89, v90
    v_lshlrev_b32 v89, 4, v89
    s_lshl_b32 s71, s57, 3
    v_add_u32 v88, s71, v88
    v_mul_u32_u24 v88, 12288, v88
    s_mul_i32 s71, s63, 384
    s_lshl_b32 s70, s62, 7
    s_add_u32 s71, s71, s70
    v_add3_u32 v94, v88, v89, s71
    s_cmp_eq_u32 s62, 2
    s_cselect_b32 s70, 0, 0
    s_lshl_b32 s71, s70, 7
    v_add_u32 v87, s71, v94
    s_cmp_ge_u32 s57, 4
    s_cselect_b32 s70, s70, 0
    s_add_u32 s62, s62, s70
    s_lshl_b32 s71, s57, 10
    s_add_u32 m0, s71, 0
    s_mov_b32 s70, 0
    buffer_load_dwordx4 v94, s[40:43], s70 offen nt lds
    s_add_u32 m0, s71, 32768
    s_mov_b32 s70, 0
    buffer_load_dwordx4 v87, s[48:51], s70 offen nt lds
    s_add_u32 m0, s71, 16384
    s_mov_b32 s70, 0
    buffer_load_dwordx4 v94, s[44:47], s70 offen nt lds
    s_add_u32 m0, s71, 8192
    s_mov_b32 s70, 786432
    buffer_load_dwordx4 v94, s[40:43], s70 offen nt lds
    s_add_u32 m0, s71, 40960
    s_mov_b32 s70, 786432
    buffer_load_dwordx4 v87, s[48:51], s70 offen nt lds
    s_add_u32 m0, s71, 24576
    s_mov_b32 s70, 786432
    buffer_load_dwordx4 v94, s[44:47], s70 offen nt lds
    v_lshrrev_b32 v88, 4, v0
    v_bfe_u32 v89, v0, 2, 2
    v_and_b32 v90, 2, v89
    v_and_b32 v91, 1, v88
    v_lshl_or_b32 v90, v91, 2, v90
    v_bfe_u32 v91, v0, 1, 1
    s_and_b32 s71, s57, 3
    s_lshl_b32 s71, s71, 1
    v_or_b32 v91, s71, v91
    v_xor_b32 v90, v90, v91
    v_lshlrev_b32 v90, 4, v90
    v_lshl_add_u32 v90, v88, 10, v90
    v_lshl_add_u32 v90, v89, 7, v90
    v_and_b32 v91, 1, v0
    v_lshl_add_u32 v95, v91, 3, v90
    v_and_b32 v89, 15, v0
    v_lshrrev_b32 v90, 1, v89
    v_xor_b32 v90, v90, v88
    v_lshlrev_b32 v90, 4, v90
    v_and_b32 v91, 7, v0
    v_lshl_add_u32 v90, v91, 7, v90
    v_bfe_u32 v91, v0, 3, 1
    v_lshl_add_u32 v85, v91, 11, v90
    v_add_u32 v85, 147456, v85
    v_xor_b32 v86, 64, v85
    v_mul_u32_u24 v91, 10240, v91
    v_add_u32 v90, v90, v91
    v_add_u32 v1, 98304, v90
    v_xor_b32 v2, 64, v1
    v_and_b32 v90, 60, v0
    v_and_b32 v91, 1, v0
    v_lshl_or_b32 v90, v91, 1, v90
    v_bfe_u32 v91, v0, 1, 1
    v_or_b32 v90, v90, v91
    v_lshlrev_b32 v3, 4, v90
    v_add_u32 v3, 147456, v3
    v_bfe_u32 v91, v0, 1, 1
    v_mul_u32_u24 v4, 0xaaaa, v91
    v_add_u32 v4, 0x4444, v4
    v_mov_b32 v5, -1
    s_and_b32 s71, s57, 3
    s_lshr_b32 s70, s71, 1
    s_lshl_b32 s70, s70, 11
    s_and_b32 s71, s71, 1
    s_lshl_b32 s71, s71, 9
    s_add_u32 s70, s70, s71
    s_lshl_b32 s71, s62, 12
    s_add_u32 s70, s70, s71
    s_mul_i32 s71, s63, 12288
    s_add_u32 s70, s70, s71
    v_and_b32 v90, 1, v88
    v_lshlrev_b32 v90, 10, v90
    v_lshrrev_b32 v91, 1, v88
    v_lshl_add_u32 v90, v91, 8, v90
    v_lshl_add_u32 v90, v89, 4, v90
    v_add_u32 v6, s70, v90
    v_lshrrev_b32 v90, 2, v89
    v_and_b32 v91, 1, v89
    v_lshl_add_u32 v92, v90, 1, v91
    v_bfe_u32 v93, v0, 1, 1
    s_mov_b32 s59, 0
    s_mov_b32 s68, 1000
    s_cmp_ge_u32 s57, 4
    s_cbranch_scc1 L_p_v
    s_lshl_b32 s71, s57, 10
    s_add_u32 s71, s71, 49152
    v_lshl_add_u32 v7, v0, 3, s71
    s_and_b32 s71, s57, 1
    s_lshl_b32 s71, s71, 9
    s_add_u32 s71, s71, 49152
    v_lshl_add_u32 v8, v0, 3, s71
    v_lshrrev_b32 v90, 1, v88
    v_lshlrev_b32 v90, 3, v90
    v_xor_b32 v90, v90, v89
    v_lshlrev_b32 v90, 3, v90
    v_lshl_add_u32 v90, v88, 7, v90
    s_lshl_b32 s71, s57, 9
    s_add_u32 s71, s71, 157696
    v_add_u32 v9, s71, v90
    v_lshrrev_b32 v90, 2, v0
    v_mov_b32 v10, 157696
    s_cmp_lg_u32 s57, 3
    s_cbranch_scc1 L_p_w3_1
    v_and_b32 v90, 3, v90
    v_and_b32 v91, 1, v88
    v_lshl_add_u32 v90, v91, 3, v90
    v_lshrrev_b32 v91, 1, v88
    v_lshl_add_u32 v10, v91, 9, v10
L_p_w3_1:
    v_lshlrev_b32 v91, 3, v93
    v_xor_b32 v90, v90, v91
    v_lshl_add_u32 v10, v90, 3, v10
    v_and_b32 v91, 3, v0
    v_lshl_add_u32 v10, v91, 7, v10
    s_mul_i32 s70, s58, 768
    s_add_u32 s70, s70, 10240
    s_lshl_b32 s71, s57, 8
    s_cmp_eq_u32 s57, 3
    s_cselect_b32 s71, 0x40000000, s71
    s_add_u32 s70, s70, s71
    v_lshl_add_u32 v11, v0, 2, s70
    s_mul_i32 s70, s63, 3072
    s_lshl_b32 s71, s62, 10
    s_add_u32 s70, s70, s71
    v_lshlrev_b32 v90, 7, v88
    v_lshl_add_u32 v90, v92, 4, v90
    v_xor_b32 v91, 1, v93
    v_lshl_add_u32 v90, v91, 30, v90
    v_add_u32 v12, s70, v90
    s_add_u32 s67, s64, 32768
    buffer_store_dword v5, v11, s[32:35], s64 offen
    buffer_store_dword v5, v11, s[32:35], s67 offen
    s_lshl_b32 s70, s58, 2
    s_add_u32 s70, s70, s57
    s_lshl_b32 s70, s70, 2
    s_add_u32 s70, s70, s64
    s_add_u32 s70, s70, 65792
    v_cmp_eq_u32 vcc, 0, v0
    v_mov_b32 v90, 0x40000000
    v_mov_b32 v91, s70
    v_cndmask_b32 v13, v90, v91, vcc
    buffer_store_dword v5, v13, s[32:35], 0 offen
    s_lshl_b32 s71, s57, 10
    s_barrier
    s_add_u32 m0, s71, 49152
    s_mov_b32 s70, 1572864
    buffer_load_dwordx4 v94, s[40:43], s70 offen nt lds
    s_add_u32 m0, s71, 81920
    s_mov_b32 s70, 1572864
    buffer_load_dwordx4 v87, s[48:51], s70 offen nt lds
    s_add_u32 m0, s71, 65536
    s_mov_b32 s70, 1572864
    buffer_load_dwordx4 v94, s[44:47], s70 offen nt lds
    s_add_u32 m0, s71, 57344
    s_mov_b32 s70, 2359296
    buffer_load_dwordx4 v94, s[40:43], s70 offen nt lds
    s_add_u32 m0, s71, 90112
    s_mov_b32 s70, 2359296
    buffer_load_dwordx4 v87, s[48:51], s70 offen nt lds
    s_add_u32 m0, s71, 73728
    s_mov_b32 s70, 2359296
    buffer_load_dwordx4 v94, s[44:47], s70 offen nt lds
    s_waitcnt vmcnt(6)
    s_barrier
    s_cmp_lg_u32 s57, 0
    s_cbranch_scc1 L_rdy_2
    s_lshl_b32 s61, s56, 4
    v_mov_b32 v88, 1
    v_mov_b32 v89, 8
    s_mov_b64 exec, 1
    buffer_atomic_add v88, v89, s[36:39], s61 offen
    s_mov_b64 exec, -1
L_rdy_2:
    s_add_u32 m0, s71, 98304
    s_mov_b32 s70, 3145728
    buffer_load_dwordx4 v94, s[40:43], s70 offen nt lds
    s_add_u32 m0, s71, 131072
    s_mov_b32 s70, 3145728
    buffer_load_dwordx4 v87, s[48:51], s70 offen nt lds
    s_add_u32 m0, s71, 114688
    s_mov_b32 s70, 3145728
    buffer_load_dwordx4 v94, s[44:47], s70 offen nt lds
    s_add_u32 m0, s71, 106496
    s_mov_b32 s70, 3932160
    buffer_load_dwordx4 v94, s[40:43], s70 offen nt lds
    s_add_u32 m0, s71, 139264
    s_mov_b32 s70, 3932160
    buffer_load_dwordx4 v87, s[48:51], s70 offen nt lds
    s_add_u32 m0, s71, 122880
    s_mov_b32 s70, 3932160
    buffer_load_dwordx4 v94, s[44:47], s70 offen nt lds
    v_add_u32 v88, 0, v95
    ds_read_b64_tr_b16 v[96:97], v88 offset:0
    ds_read_b64_tr_b16 v[98:99], v88 offset:512
    ds_read_b64_tr_b16 v[100:101], v88 offset:4096
    ds_read_b64_tr_b16 v[102:103], v88 offset:4608
    ds_read_b64_tr_b16 v[104:105], v88 offset:8192
    ds_read_b64_tr_b16 v[106:107], v88 offset:8704
    ds_read_b64_tr_b16 v[108:109], v88 offset:12288
    ds_read_b64_tr_b16 v[110:111], v88 offset:12800
    ds_read_b64_tr_b16 v[176:177], v88 offset:16384
    ds_read_b64_tr_b16 v[178:179], v88 offset:16896
    ds_read_b64_tr_b16 v[180:181], v88 offset:20480
    ds_read_b64_tr_b16 v[182:183], v88 offset:20992
    s_waitcnt lgkmcnt(4)
    ds_read_b64_tr_b16 v[184:185], v88 offset:24576
    ds_read_b64_tr_b16 v[186:187], v88 offset:25088
    ds_read_b64_tr_b16 v[188:189], v88 offset:28672
    ds_read_b64_tr_b16 v[190:191], v88 offset:29184
    s_waitcnt lgkmcnt(0)
    s_waitcnt vmcnt(6)
    s_barrier
    s_add_u32 m0, s71, 0
    s_mov_b32 s70, 4718592
    buffer_load_dwordx4 v94, s[40:43], s70 offen nt lds
    s_add_u32 m0, s71, 32768
    s_mov_b32 s70, 4718592
    buffer_load_dwordx4 v87, s[48:51], s70 offen nt lds
    s_add_u32 m0, s71, 16384
    s_mov_b32 s70, 4718592
    buffer_load_dwordx4 v94, s[44:47], s70 offen nt lds
    s_add_u32 m0, s71, 8192
    s_mov_b32 s70, 5505024
    buffer_load_dwordx4 v94, s[40:43], s70 offen nt lds
    s_add_u32 m0, s71, 40960
    s_mov_b32 s70, 5505024
    buffer_load_dwordx4 v87, s[48:51], s70 offen nt lds
    s_add_u32 m0, s71, 24576
    s_mov_b32 s70, 5505024
    buffer_load_dwordx4 v94, s[44:47], s70 offen nt lds
    v_add_u32 v88, 49152, v95
    ds_read_b64_tr_b16 v[112:113], v88 offset:0
    ds_read_b64_tr_b16 v[114:115], v88 offset:512
    ds_read_b64_tr_b16 v[116:117], v88 offset:4096
    ds_read_b64_tr_b16 v[118:119], v88 offset:4608
    ds_read_b64_tr_b16 v[120:121], v88 offset:8192
    ds_read_b64_tr_b16 v[122:123], v88 offset:8704
    ds_read_b64_tr_b16 v[124:125], v88 offset:12288
    ds_read_b64_tr_b16 v[126:127], v88 offset:12800
    ds_read_b64_tr_b16 v[192:193], v88 offset:16384
    ds_read_b64_tr_b16 v[194:195], v88 offset:16896
    ds_read_b64_tr_b16 v[196:197], v88 offset:20480
    ds_read_b64_tr_b16 v[198:199], v88 offset:20992
    s_waitcnt lgkmcnt(4)
    ds_read_b64_tr_b16 v[200:201], v88 offset:24576
    ds_read_b64_tr_b16 v[202:203], v88 offset:25088
    ds_read_b64_tr_b16 v[204:205], v88 offset:28672
    ds_read_b64_tr_b16 v[206:207], v88 offset:29184
    s_waitcnt lgkmcnt(0)
    s_waitcnt vmcnt(6)
    s_barrier
    s_add_u32 m0, s71, 49152
    s_mov_b32 s70, 6291456
    buffer_load_dwordx4 v94, s[40:43], s70 offen nt lds
    s_add_u32 m0, s71, 81920
    s_mov_b32 s70, 6291456
    buffer_load_dwordx4 v87, s[48:51], s70 offen nt lds
    s_add_u32 m0, s71, 65536
    s_mov_b32 s70, 6291456
    buffer_load_dwordx4 v94, s[44:47], s70 offen nt lds
    s_add_u32 m0, s71, 57344
    s_mov_b32 s70, 7077888
    buffer_load_dwordx4 v94, s[40:43], s70 offen nt lds
    s_add_u32 m0, s71, 90112
    s_mov_b32 s70, 7077888
    buffer_load_dwordx4 v87, s[48:51], s70 offen nt lds
    s_add_u32 m0, s71, 73728
    s_mov_b32 s70, 7077888
    buffer_load_dwordx4 v94, s[44:47], s70 offen nt lds
    v_add_u32 v88, 98304, v95
    ds_read_b64_tr_b16 v[128:129], v88 offset:0
    ds_read_b64_tr_b16 v[130:131], v88 offset:512
    ds_read_b64_tr_b16 v[132:133], v88 offset:4096
    ds_read_b64_tr_b16 v[134:135], v88 offset:4608
    ds_read_b64_tr_b16 v[136:137], v88 offset:8192
    ds_read_b64_tr_b16 v[138:139], v88 offset:8704
    ds_read_b64_tr_b16 v[140:141], v88 offset:12288
    ds_read_b64_tr_b16 v[142:143], v88 offset:12800
    ds_read_b64_tr_b16 v[208:209], v88 offset:16384
    ds_read_b64_tr_b16 v[210:211], v88 offset:16896
    ds_read_b64_tr_b16 v[212:213], v88 offset:20480
    ds_read_b64_tr_b16 v[214:215], v88 offset:20992
    s_waitcnt lgkmcnt(4)
    ds_read_b64_tr_b16 v[216:217], v88 offset:24576
    ds_read_b64_tr_b16 v[218:219], v88 offset:25088
    ds_read_b64_tr_b16 v[220:221], v88 offset:28672
    ds_read_b64_tr_b16 v[222:223], v88 offset:29184
    s_waitcnt lgkmcnt(0)
    s_waitcnt vmcnt(6)
    s_barrier
    v_add_u32 v88, 0, v95
    ds_read_b64_tr_b16 v[144:145], v88 offset:0
    ds_read_b64_tr_b16 v[146:147], v88 offset:512
    ds_read_b64_tr_b16 v[148:149], v88 offset:4096
    ds_read_b64_tr_b16 v[150:151], v88 offset:4608
    ds_read_b64_tr_b16 v[152:153], v88 offset:8192
    ds_read_b64_tr_b16 v[154:155], v88 offset:8704
    ds_read_b64_tr_b16 v[156:157], v88 offset:12288
    ds_read_b64_tr_b16 v[158:159], v88 offset:12800
    ds_read_b64_tr_b16 v[224:225], v88 offset:16384
    ds_read_b64_tr_b16 v[226:227], v88 offset:16896
    ds_read_b64_tr_b16 v[228:229], v88 offset:20480
    ds_read_b64_tr_b16 v[230:231], v88 offset:20992
    s_waitcnt lgkmcnt(4)
    ds_read_b64_tr_b16 v[232:233], v88 offset:24576
    ds_read_b64_tr_b16 v[234:235], v88 offset:25088
    ds_read_b64_tr_b16 v[236:237], v88 offset:28672
    ds_read_b64_tr_b16 v[238:239], v88 offset:29184
    s_waitcnt lgkmcnt(0)
    s_cmp_lg_u32 s57, 3
    s_cbranch_scc1 L_nrdy_3
    v_mov_b32 v88, 0
L_wrdy_4:
    buffer_load_dword v89, v88, s[36:39], 0 offen offset:252 sc1
    s_waitcnt vmcnt(0)
    v_cmp_gt_u32 vcc, 1, v89
    s_cbranch_vccnz L_retry_5
L_ok_6:
L_nrdy_3:
    s_waitcnt vmcnt(0)
    s_barrier
    v_add_u32 v88, 49152, v95
    ds_read_b64_tr_b16 v[160:161], v88 offset:0
    ds_read_b64_tr_b16 v[162:163], v88 offset:512
    ds_read_b64_tr_b16 v[164:165], v88 offset:4096
    ds_read_b64_tr_b16 v[166:167], v88 offset:4608
    ds_read_b64_tr_b16 v[168:169], v88 offset:8192
    ds_read_b64_tr_b16 v[170:171], v88 offset:8704
    ds_read_b64_tr_b16 v[172:173], v88 offset:12288
    ds_read_b64_tr_b16 v[174:175], v88 offset:12800
    ds_read_b64_tr_b16 v[240:241], v88 offset:16384
    ds_read_b64_tr_b16 v[242:243], v88 offset:16896
    ds_read_b64_tr_b16 v[244:245], v88 offset:20480
    ds_read_b64_tr_b16 v[246:247], v88 offset:20992
    s_waitcnt lgkmcnt(4)
    ds_read_b64_tr_b16 v[248:249], v88 offset:24576
    ds_read_b64_tr_b16 v[250:251], v88 offset:25088
    ds_read_b64_tr_b16 v[252:253], v88 offset:28672
    ds_read_b64_tr_b16 v[254:255], v88 offset:29184
    s_waitcnt lgkmcnt(0)
    s_waitcnt vmcnt(0)
    s_barrier
    s_mov_b32 s42, 0x8000
    s_mov_b32 s43, 0x20000
    s_mov_b32 s46, 0x8000
    s_mov_b32 s47, 0x20000
    s_xor_b32 s67, s64, 32768
    s_add_u32 s44, s32, s67
    s_addc_u32 s45, s33, 0
    s_xor_b32 s67, s67, 32768
    s_add_u32 s40, s32, s67
    s_addc_u32 s41, s33, 0
    s_mov_b32 s65, 0x0
    s_mov_b32 s66, 0x1800000
    s_mov_b32 s70, 0x6000000
    s_mov_b32 s59, -1
L_pqk_loop:
    s_setprio 0
    ds_read_b128 v[16:19], v1 offset:0
    ds_read_b128 v[20:23], v1 offset:20480
    ds_read_b128 v[24:27], v2 offset:0
    ds_read_b128 v[28:31], v2 offset:20480
    ds_read_b128 v[32:35], v1 offset:1024
    ds_read_b128 v[36:39], v1 offset:21504
    ds_read_b128 v[40:43], v2 offset:1024
    ds_read_b128 v[44:47], v2 offset:21504
    s_waitcnt lgkmcnt(6)
    v_mfma_f32_16x16x32_bf16 v[56:59], v[96:99], v[16:19], 0
    ds_read_b128 v[48:51], v1 offset:2048
    ds_read_b128 v[52:55], v1 offset:22528
    v_mfma_f32_16x16x32_bf16 v[64:67], v[176:179], v[16:19], 0
    v_mfma_f32_16x16x32_bf16 v[60:63], v[96:99], v[20:23], 0
    v_mfma_f32_16x16x32_bf16 v[68:71], v[176:179], v[20:23], 0
    s_waitcnt lgkmcnt(6)
    v_mfma_f32_16x16x32_bf16 v[56:59], v[100:103], v[24:27], v[56:59]
    ds_read_b128 v[16:19], v2 offset:2048
    ds_read_b128 v[20:23], v2 offset:22528
    v_mfma_f32_16x16x32_bf16 v[64:67], v[180:183], v[24:27], v[64:67]
    v_mfma_f32_16x16x32_bf16 v[60:63], v[100:103], v[28:31], v[60:63]
    v_mfma_f32_16x16x32_bf16 v[68:71], v[180:183], v[28:31], v[68:71]
    s_waitcnt lgkmcnt(6)
    v_mfma_f32_16x16x32_bf16 v[56:59], v[104:107], v[32:35], v[56:59]
    ds_read_b128 v[24:27], v1 offset:3072
    ds_read_b128 v[28:31], v1 offset:23552
    v_mfma_f32_16x16x32_bf16 v[64:67], v[184:187], v[32:35], v[64:67]
    v_mfma_f32_16x16x32_bf16 v[60:63], v[104:107], v[36:39], v[60:63]
    v_mfma_f32_16x16x32_bf16 v[68:71], v[184:187], v[36:39], v[68:71]
    v_mov_b32 v14, s59
    s_waitcnt vmcnt(0)
    buffer_store_dword v14, v13, s[32:35], 0 offen
    s_waitcnt lgkmcnt(6)
    v_mfma_f32_16x16x32_bf16 v[56:59], v[108:111], v[40:43], v[56:59]
    ds_read_b128 v[32:35], v2 offset:3072
    ds_read_b128 v[36:39], v2 offset:23552
    v_mfma_f32_16x16x32_bf16 v[64:67], v[188:191], v[40:43], v[64:67]
    v_mfma_f32_16x16x32_bf16 v[60:63], v[108:111], v[44:47], v[60:63]
    v_mfma_f32_16x16x32_bf16 v[68:71], v[188:191], v[44:47], v[68:71]
    s_waitcnt lgkmcnt(6)
    v_mfma_f32_16x16x32_bf16 v[56:59], v[112:115], v[48:51], v[56:59]
    ds_read_b128 v[40:43], v1 offset:4096
    ds_read_b128 v[44:47], v1 offset:24576
    v_mfma_f32_16x16x32_bf16 v[64:67], v[192:195], v[48:51], v[64:67]
    v_mfma_f32_16x16x32_bf16 v[60:63], v[112:115], v[52:55], v[60:63]
    v_mfma_f32_16x16x32_bf16 v[68:71], v[192:195], v[52:55], v[68:71]
    s_waitcnt lgkmcnt(6)
    v_mfma_f32_16x16x32_bf16 v[56:59], v[116:119], v[16:19], v[56:59]
    ds_read_b128 v[48:51], v2 offset:4096
    ds_read_b128 v[52:55], v2 offset:24576
    v_mfma_f32_16x16x32_bf16 v[64:67], v[196:199], v[16:19], v[64:67]
    v_mfma_f32_16x16x32_bf16 v[60:63], v[116:119], v[20:23], v[60:63]
    v_mfma_f32_16x16x32_bf16 v[68:71], v[196:199], v[20:23], v[68:71]
    s_waitcnt lgkmcnt(6)
    v_mfma_f32_16x16x32_bf16 v[56:59], v[120:123], v[24:27], v[56:59]
    ds_read_b128 v[16:19], v1 offset:5120
    ds_read_b128 v[20:23], v1 offset:25600
    v_mfma_f32_16x16x32_bf16 v[64:67], v[200:203], v[24:27], v[64:67]
    v_mfma_f32_16x16x32_bf16 v[60:63], v[120:123], v[28:31], v[60:63]
    v_mfma_f32_16x16x32_bf16 v[68:71], v[200:203], v[28:31], v[68:71]
    s_waitcnt lgkmcnt(6)
    v_mfma_f32_16x16x32_bf16 v[56:59], v[124:127], v[32:35], v[56:59]
    ds_read_b128 v[24:27], v2 offset:5120
    ds_read_b128 v[28:31], v2 offset:25600
    v_mfma_f32_16x16x32_bf16 v[64:67], v[204:207], v[32:35], v[64:67]
    v_mfma_f32_16x16x32_bf16 v[60:63], v[124:127], v[36:39], v[60:63]
    v_mfma_f32_16x16x32_bf16 v[68:71], v[204:207], v[36:39], v[68:71]
    s_waitcnt lgkmcnt(6)
    v_mfma_f32_16x16x32_bf16 v[56:59], v[128:131], v[40:43], v[56:59]
    ds_read_b128 v[32:35], v1 offset:6144
    ds_read_b128 v[36:39], v1 offset:26624
    v_mfma_f32_16x16x32_bf16 v[64:67], v[208:211], v[40:43], v[64:67]
    v_mfma_f32_16x16x32_bf16 v[60:63], v[128:131], v[44:47], v[60:63]
    v_mfma_f32_16x16x32_bf16 v[68:71], v[208:211], v[44:47], v[68:71]
    s_waitcnt lgkmcnt(6)
    v_mfma_f32_16x16x32_bf16 v[56:59], v[132:135], v[48:51], v[56:59]
    ds_read_b128 v[40:43], v2 offset:6144
    ds_read_b128 v[44:47], v2 offset:26624
    v_mfma_f32_16x16x32_bf16 v[64:67], v[212:215], v[48:51], v[64:67]
    v_mfma_f32_16x16x32_bf16 v[60:63], v[132:135], v[52:55], v[60:63]
    v_mfma_f32_16x16x32_bf16 v[68:71], v[212:215], v[52:55], v[68:71]
    s_waitcnt lgkmcnt(6)
    v_mfma_f32_16x16x32_bf16 v[56:59], v[136:139], v[16:19], v[56:59]
    ds_read_b128 v[48:51], v1 offset:7168
    ds_read_b128 v[52:55], v1 offset:27648
    v_mfma_f32_16x16x32_bf16 v[64:67], v[216:219], v[16:19], v[64:67]
    v_mfma_f32_16x16x32_bf16 v[60:63], v[136:139], v[20:23], v[60:63]
    v_mfma_f32_16x16x32_bf16 v[68:71], v[216:219], v[20:23], v[68:71]
    s_waitcnt lgkmcnt(6)
    v_mfma_f32_16x16x32_bf16 v[56:59], v[140:143], v[24:27], v[56:59]
    ds_read_b128 v[16:19], v2 offset:7168
    ds_read_b128 v[20:23], v2 offset:27648
    v_mfma_f32_16x16x32_bf16 v[64:67], v[220:223], v[24:27], v[64:67]
    v_mfma_f32_16x16x32_bf16 v[60:63], v[140:143], v[28:31], v[60:63]
    v_mfma_f32_16x16x32_bf16 v[68:71], v[220:223], v[28:31], v[68:71]
    s_waitcnt lgkmcnt(6)
    v_mfma_f32_16x16x32_bf16 v[56:59], v[144:147], v[32:35], v[56:59]
    ds_read_b128 v[24:27], v1 offset:8192
    ds_read_b128 v[28:31], v1 offset:28672
    v_mfma_f32_16x16x32_bf16 v[64:67], v[224:227], v[32:35], v[64:67]
    v_mfma_f32_16x16x32_bf16 v[60:63], v[144:147], v[36:39], v[60:63]
    v_mfma_f32_16x16x32_bf16 v[68:71], v[224:227], v[36:39], v[68:71]
    s_waitcnt lgkmcnt(6)
    v_mfma_f32_16x16x32_bf16 v[56:59], v[148:151], v[40:43], v[56:59]
    ds_read_b128 v[32:35], v2 offset:8192
    ds_read_b128 v[36:39], v2 offset:28672
    v_mfma_f32_16x16x32_bf16 v[64:67], v[228:231], v[40:43], v[64:67]
    v_mfma_f32_16x16x32_bf16 v[60:63], v[148:151], v[44:47], v[60:63]
    v_mfma_f32_16x16x32_bf16 v[68:71], v[228:231], v[44:47], v[68:71]
    s_waitcnt lgkmcnt(6)
    v_mfma_f32_16x16x32_bf16 v[56:59], v[152:155], v[48:51], v[56:59]
    ds_read_b128 v[40:43], v1 offset:9216
    ds_read_b128 v[44:47], v1 offset:29696
    v_mfma_f32_16x16x32_bf16 v[64:67], v[232:235], v[48:51], v[64:67]
    v_mfma_f32_16x16x32_bf16 v[60:63], v[152:155], v[52:55], v[60:63]
    v_mfma_f32_16x16x32_bf16 v[68:71], v[232:235], v[52:55], v[68:71]
    s_waitcnt lgkmcnt(6)
    v_mfma_f32_16x16x32_bf16 v[56:59], v[156:159], v[16:19], v[56:59]
    ds_read_b128 v[48:51], v2 offset:9216
    ds_read_b128 v[52:55], v2 offset:29696
    v_mfma_f32_16x16x32_bf16 v[64:67], v[236:239], v[16:19], v[64:67]
    v_mfma_f32_16x16x32_bf16 v[60:63], v[156:159], v[20:23], v[60:63]
    v_mfma_f32_16x16x32_bf16 v[68:71], v[236:239], v[20:23], v[68:71]
    s_waitcnt lgkmcnt(6)
    v_mfma_f32_16x16x32_bf16 v[56:59], v[160:163], v[24:27], v[56:59]
    v_mfma_f32_16x16x32_bf16 v[64:67], v[240:243], v[24:27], v[64:67]
    v_mfma_f32_16x16x32_bf16 v[60:63], v[160:163], v[28:31], v[60:63]
    v_mfma_f32_16x16x32_bf16 v[68:71], v[240:243], v[28:31], v[68:71]
    s_waitcnt lgkmcnt(4)
    v_mfma_f32_16x16x32_bf16 v[56:59], v[164:167], v[32:35], v[56:59]
    v_mfma_f32_16x16x32_bf16 v[64:67], v[244:247], v[32:35], v[64:67]
    v_mfma_f32_16x16x32_bf16 v[60:63], v[164:167], v[36:39], v[60:63]
    v_mfma_f32_16x16x32_bf16 v[68:71], v[244:247], v[36:39], v[68:71]
    s_waitcnt lgkmcnt(2)
    v_mfma_f32_16x16x32_bf16 v[56:59], v[168:171], v[40:43], v[56:59]
    v_mfma_f32_16x16x32_bf16 v[64:67], v[248:251], v[40:43], v[64:67]
    v_mfma_f32_16x16x32_bf16 v[60:63], v[168:171], v[44:47], v[60:63]
    v_mfma_f32_16x16x32_bf16 v[68:71], v[248:251], v[44:47], v[68:71]
    s_waitcnt lgkmcnt(0)
    v_mfma_f32_16x16x32_bf16 v[56:59], v[172:175], v[48:51], v[56:59]
    v_mfma_f32_16x16x32_bf16 v[64:67], v[252:255], v[48:51], v[64:67]
    v_mfma_f32_16x16x32_bf16 v[60:63], v[172:175], v[52:55], v[60:63]
    v_mfma_f32_16x16x32_bf16 v[68:71], v[252:255], v[52:55], v[68:71]
    s_cmp_eq_u32 s59, -1
    s_cbranch_scc1 L_pqk_first
L_pqk_crit:
    s_setprio 2
    s_waitcnt vmcnt(0)
.p2align 6
L_pqk_a:
    s_barrier
    ds_read_b128 v[16:19], v3 offset:0
    ds_read_b128 v[20:23], v3 offset:1024
    ds_read_b128 v[24:27], v3 offset:2048
    s_waitcnt lgkmcnt(2)
    v_smfmac_f32_16x16x64_bf16 v[92:95], v[16:19], v[176:183], v4
    ds_read_b128 v[28:31], v3 offset:3072
    v_smfmac_f32_16x16x64_bf16 v[88:91], v[16:19], v[96:103], v4
    ds_read_b128 v[32:35], v3 offset:4096
    s_waitcnt lgkmcnt(3)
    v_smfmac_f32_16x16x64_bf16 v[92:95], v[20:23], v[184:191], v4
    ds_read_b128 v[36:39], v3 offset:5120
    v_smfmac_f32_16x16x64_bf16 v[88:91], v[20:23], v[104:111], v4
    ds_read_b128 v[40:43], v3 offset:6144
    s_waitcnt lgkmcnt(4)
    v_smfmac_f32_16x16x64_bf16 v[92:95], v[24:27], v[192:199], v4
    ds_read_b128 v[44:47], v3 offset:7168
    v_smfmac_f32_16x16x64_bf16 v[88:91], v[24:27], v[112:119], v4
    ds_read_b128 v[48:51], v3 offset:8192
    s_waitcnt lgkmcnt(5)
    v_smfmac_f32_16x16x64_bf16 v[92:95], v[28:31], v[200:207], v4
    ds_read_b128 v[52:55], v3 offset:9216
    v_smfmac_f32_16x16x64_bf16 v[88:91], v[28:31], v[120:127], v4
    ds_read_b64 v[72:73], v8 offset:0
    s_waitcnt lgkmcnt(6)
    v_smfmac_f32_16x16x64_bf16 v[92:95], v[32:35], v[208:215], v4
    ds_read_b64 v[74:75], v8 offset:1024
    v_smfmac_f32_16x16x64_bf16 v[88:91], v[32:35], v[128:135], v4
    ds_read_b64 v[76:77], v8 offset:2048
    s_waitcnt lgkmcnt(7)
    v_smfmac_f32_16x16x64_bf16 v[92:95], v[36:39], v[216:223], v4
    ds_read_b64 v[78:79], v8 offset:3072
    v_smfmac_f32_16x16x64_bf16 v[88:91], v[36:39], v[136:143], v4
    s_waitcnt lgkmcnt(7)
    v_smfmac_f32_16x16x64_bf16 v[92:95], v[40:43], v[224:231], v4
    v_smfmac_f32_16x16x64_bf16 v[88:91], v[40:43], v[144:151], v4
    s_waitcnt lgkmcnt(6)
    v_smfmac_f32_16x16x64_bf16 v[92:95], v[44:47], v[232:239], v4
    s_waitcnt lgkmcnt(5)
    v_smfmac_f32_16x16x64_bf16 v[92:95], v[48:51], v[240:247], v4
    s_waitcnt lgkmcnt(4)
    v_smfmac_f32_16x16x64_bf16 v[92:95], v[52:55], v[248:255], v4
    v_smfmac_f32_16x16x64_bf16 v[88:91], v[44:47], v[152:159], v4
    v_smfmac_f32_16x16x64_bf16 v[88:91], v[48:51], v[160:167], v4
    v_smfmac_f32_16x16x64_bf16 v[88:91], v[52:55], v[168:175], v4
    s_nop 4
    v_pk_add_f32 v[92:93], v[92:93], v[94:95]
    v_cvt_pk_bf16_f32 v15, v92, v93
    v_cmp_u_f32 vcc, v92, v93
    v_pk_add_f32 v[88:89], v[88:89], v[90:91]
    v_cvt_pk_bf16_f32 v14, v88, v89
    ds_write_b64 v9, v[14:15]
    s_cbranch_vccnz L_pqk_nan
L_pqk_ok:
    s_cmp_ge_u32 s57, 2
    s_waitcnt lgkmcnt(0)
    s_barrier
    ds_read_b64_tr_b16 v[80:81], v10 offset:0
    ds_read_b64_tr_b16 v[82:83], v10 offset:512
    ds_read_b64_tr_b16 v[84:85], v10 offset:1024
    ds_read_b64_tr_b16 v[86:87], v10 offset:1536
    s_cbranch_scc1 L_pqk_23
    s_waitcnt lgkmcnt(2)
    v_mfma_f32_16x16x32_bf16 v[88:91], v[80:83], v[72:75], 0
    s_waitcnt lgkmcnt(0)
    v_mfma_f32_16x16x32_bf16 v[88:91], v[84:87], v[76:79], v[88:91]
    s_nop 7
    v_cvt_pk_bf16_f32 v14, v88, v89
    buffer_store_dword v14, v11, s[40:43], 0 offen
    s_barrier
    s_branch L_pqk_join
L_pqk_23:
    s_cmp_eq_u32 s57, 3
    s_cbranch_scc1 L_pqk_3
    s_waitcnt lgkmcnt(2)
    v_mfma_f32_16x16x32_bf16 v[88:91], v[80:83], v[80:83], 0
    s_waitcnt lgkmcnt(0)
    v_mfma_f32_16x16x32_bf16 v[88:91], v[84:87], v[84:87], v[88:91]
    s_nop 7
    v_cvt_pk_bf16_f32 v14, v88, v89
    buffer_store_dword v14, v11, s[40:43], 0 offen
    s_barrier
    s_branch L_pqk_join
L_pqk_3:
    ds_read_b64_tr_b16 v[80:81], v10 offset:0
    ds_read_b64_tr_b16 v[82:83], v10 offset:32
    ds_read_b64_tr_b16 v[84:85], v10 offset:1024
    ds_read_b64_tr_b16 v[86:87], v10 offset:1056
    s_waitcnt lgkmcnt(0)
    s_barrier
    buffer_store_dwordx4 v[80:83], v12, s[32:35], s70 offen
    buffer_store_dwordx4 v[84:87], v12, s[32:35], s70 offen offset:512
L_pqk_join:
    buffer_store_dword v5, v11, s[44:47], 0 offen
    s_add_u32 s70, s70, 98304
    s_cmp_ge_u32 s70, 0x6060000
    s_cselect_b32 vcc_lo, 393216, 0
    s_sub_u32 s70, s70, vcc_lo
    s_add_u32 s44, s32, s67
    s_addc_u32 s45, s33, 0
    s_xor_b32 s67, s67, 32768
    s_add_u32 s40, s32, s67
    s_addc_u32 s41, s33, 0
    s_cmp_eq_u32 s59, 63
    s_cbranch_scc1 L_pqk_end
L_pqk_out:
    s_setprio 0
    v_cvt_pk_bf16_f32 v16, v56, v57
    v_cvt_pk_bf16_f32 v17, v58, v59
    v_cvt_pk_bf16_f32 v18, v60, v61
    v_cvt_pk_bf16_f32 v19, v62, v63
    v_cvt_pk_bf16_f32 v20, v64, v65
    v_cvt_pk_bf16_f32 v21, v66, v67
    v_cvt_pk_bf16_f32 v22, v68, v69
    v_cvt_pk_bf16_f32 v23, v70, v71
    ds_write_b64 v7, v[20:21]
    ds_write_b64 v7, v[22:23] offset:512
    v_permlane16_swap_b32 v16, v18
    v_permlane16_swap_b32 v17, v19
    buffer_store_dwordx4 v[16:19], v6, s[32:35], s65 offen
    v_mov_b32 v88, 0
    v_mov_b32 v89, 0
    v_mov_b32 v90, 0
    v_mov_b32 v91, 0
    v_mov_b32 v92, 0
    v_mov_b32 v93, 0
    v_mov_b32 v94, 0
    v_mov_b32 v95, 0
    s_waitcnt lgkmcnt(0)
    v_permlane16_swap_b32 v20, v22
    v_permlane16_swap_b32 v21, v23
    buffer_store_dwordx4 v[20:23], v6, s[32:35], s66 offen
    v_xor_b32 v1, 98304, v1
    v_xor_b32 v2, 98304, v2
    s_add_u32 s65, s65, 393216
    s_cmp_ge_u32 s65, 0x180000
    s_cselect_b32 vcc_lo, 1572864, 0
    s_sub_u32 s65, s65, vcc_lo
    s_add_u32 s66, s65, 0x1800000
    s_add_u32 s59, s59, 1
    s_cmp_lt_u32 s59, 63
    s_cbranch_scc1 L_pqk_loop
    v_mov_b32 v14, 63
    s_waitcnt vmcnt(0)
    buffer_store_dword v14, v13, s[32:35], 0 offen
    s_branch L_pqk_crit
L_pqk_end:
    v_mov_b32 v14, 64
    s_waitcnt vmcnt(0)
    buffer_store_dword v14, v13, s[32:35], 0 offen
    s_endpgm
L_pqk_first:
    s_barrier
    s_nop 3
    s_branch L_pqk_out
L_p_v:
    s_and_b32 s71, s57, 3
    v_lshrrev_b32 v90, 3, v0
    s_lshl_b32 s70, s71, 3
    v_add_u32 v90, s70, v90
    v_bfe_u32 v91, v90, 1, 3
    v_and_b32 v7, 7, v0
    v_xor_b32 v91, v91, v7
    v_mul_u32_u24 v90, 1280, v90
    v_lshl_add_u32 v7, v91, 4, v90
    s_mul_i32 s70, s71, 2560
    v_lshl_add_u32 v8, v0, 4, s70
    v_lshl_add_u32 v9, v0, 2, s70
    s_add_u32 s65, s70, 147456
    s_mul_i32 s70, s71, 40
    s_add_u32 s70, s70, s64
    s_add_u32 s70, s70, 71680
    s_mul_i32 s69, s58, 129
    s_lshr_b32 s69, s69, 9
    s_lshl_b32 s69, s69, 8
    s_add_u32 s70, s70, s69
    v_min_u32 v90, 9, v0
    v_lshl_add_u32 v80, v90, 2, s70
    v_add_u32 v10, 147456, v8
    v_add_u32 v11, 149504, v9
    s_mul_i32 s70, s61, 3
    s_add_u32 s70, s70, s62
    s_lshl_b32 s70, s70, 2
    s_add_u32 s70, s70, s71
    s_lshl_b32 s69, s70, 2
    s_add_u32 s69, s69, s64
    s_add_u32 s69, s69, 65536
    v_cmp_eq_u32 vcc, 0, v0
    v_mov_b32 v90, 0x40000000
    v_mov_b32 v91, s69
    v_cndmask_b32 v14, v90, v91, vcc
    s_lshl_b32 s70, s70, 8
    s_add_u32 s70, s70, 19456
    v_lshl_add_u32 v15, v0, 2, s70
    v_lshlrev_b32 v90, 6, v88
    v_lshl_add_u32 v90, v89, 1, v90
    v_add_u32 v12, s70, v90
    s_mul_i32 s70, s63, 3072
    s_lshl_b32 s69, s62, 7
    s_add_u32 s70, s70, s69
    s_lshl_b32 s69, s71, 5
    s_add_u32 s70, s70, s69
    v_mul_u32_u24 v90, 768, v88
    v_bfe_u32 v91, v0, 1, 2
    v_lshl_add_u32 v90, v91, 3, v90
    v_bfe_u32 v91, v0, 3, 1
    v_lshl_add_u32 v90, v91, 2, v90
    v_and_b32 v91, 1, v0
    v_lshl_add_u32 v90, v91, 1, v90
    v_add_u32 v13, s70, v90
    v_and_b32 v90, 1, v88
    v_lshrrev_b32 v91, 1, v88
    v_sub_u32 v90, v91, v90
    v_mul_i32_i24 v90, 768, v90
    v_add_u32 v6, v6, v90
    s_lshl_b32 s70, s61, 2
    s_add_u32 s70, s70, s64
    s_add_u32 s70, s70, 66304
    v_bfe_u32 v90, v0, 2, 2
    v_lshl_add_u32 v78, v90, 4, s70
    s_lshl_b32 s70, s58, 2
    s_add_u32 s70, s70, s64
    s_add_u32 s70, s70, 67584
    s_cmp_eq_u32 s57, 4
    s_cselect_b32 s70, s70, 0x40000000
    v_cmp_gt_u32 vcc, 11, v0
    v_mov_b32 v90, 0x40000000
    v_lshl_add_u32 v91, v0, 7, s70
    v_cndmask_b32 v74, v90, v91, vcc
    v_mov_b32 v75, 0
    s_add_u32 s67, s64, 32768
    buffer_store_dword v5, v15, s[32:35], s64 offen
    buffer_store_dword v5, v15, s[32:35], s67 offen
    buffer_store_dword v75, v14, s[32:35], 0 offen
    buffer_store_dword v75, v74, s[32:35], 0 offen
    buffer_store_dword v75, v74, s[32:35], 0 offen offset:64
    s_lshl_b32 s71, s57, 10
    s_barrier
    s_add_u32 m0, s71, 49152
    s_mov_b32 s70, 1572864
    buffer_load_dwordx4 v94, s[40:43], s70 offen nt lds
    s_add_u32 m0, s71, 81920
    s_mov_b32 s70, 1572864
    buffer_load_dwordx4 v87, s[48:51], s70 offen nt lds
    s_add_u32 m0, s71, 65536
    s_mov_b32 s70, 1572864
    buffer_load_dwordx4 v94, s[44:47], s70 offen nt lds
    s_add_u32 m0, s71, 57344
    s_mov_b32 s70, 2359296
    buffer_load_dwordx4 v94, s[40:43], s70 offen nt lds
    s_add_u32 m0, s71, 90112
    s_mov_b32 s70, 2359296
    buffer_load_dwordx4 v87, s[48:51], s70 offen nt lds
    s_add_u32 m0, s71, 73728
    s_mov_b32 s70, 2359296
    buffer_load_dwordx4 v94, s[44:47], s70 offen nt lds
    v_bfe_u32 v91, v0, 1, 2
    v_and_b32 v90, 49, v0
    v_lshl_add_u32 v90, v91, 2, v90
    v_bfe_u32 v91, v0, 3, 1
    v_lshl_add_u32 v90, v91, 1, v90
    v_lshlrev_b32 v90, 2, v90
    s_waitcnt vmcnt(6)
    s_barrier
    s_cmp_lg_u32 s57, 0
    s_cbranch_scc1 L_rdy_7
    s_lshl_b32 s61, s56, 4
    v_mov_b32 v88, 1
    v_mov_b32 v89, 8
    s_mov_b64 exec, 1
    buffer_atomic_add v88, v89, s[36:39], s61 offen
    s_mov_b64 exec, -1
L_rdy_7:
    v_add_u32 v88, 0, v95
    ds_read_b64_tr_b16 v[96:97], v88 offset:32768
    ds_read_b64_tr_b16 v[98:99], v88 offset:33280
    ds_read_b64_tr_b16 v[100:101], v88 offset:36864
    ds_read_b64_tr_b16 v[102:103], v88 offset:37376
    ds_read_b64_tr_b16 v[104:105], v88 offset:40960
    ds_read_b64_tr_b16 v[106:107], v88 offset:41472
    ds_read_b64_tr_b16 v[108:109], v88 offset:45056
    ds_read_b64_tr_b16 v[110:111], v88 offset:45568
    s_waitcnt lgkmcnt(0)
    ds_bpermute_b32 v96, v90, v96
    ds_bpermute_b32 v97, v90, v97
    ds_bpermute_b32 v98, v90, v98
    ds_bpermute_b32 v99, v90, v99
    ds_bpermute_b32 v100, v90, v100
    ds_bpermute_b32 v101, v90, v101
    ds_bpermute_b32 v102, v90, v102
    ds_bpermute_b32 v103, v90, v103
    s_waitcnt lgkmcnt(6)
    ds_bpermute_b32 v104, v90, v104
    ds_bpermute_b32 v105, v90, v105
    ds_bpermute_b32 v106, v90, v106
    ds_bpermute_b32 v107, v90, v107
    ds_bpermute_b32 v108, v90, v108
    ds_bpermute_b32 v109, v90, v109
    ds_bpermute_b32 v110, v90, v110
    ds_bpermute_b32 v111, v90, v111
    s_waitcnt lgkmcnt(6)
    s_waitcnt lgkmcnt(0)
    s_add_u32 m0, s71, 98304
    s_mov_b32 s70, 3145728
    buffer_load_dwordx4 v94, s[40:43], s70 offen nt lds
    s_add_u32 m0, s71, 131072
    s_mov_b32 s70, 3145728
    buffer_load_dwordx4 v87, s[48:51], s70 offen nt lds
    s_add_u32 m0, s71, 114688
    s_mov_b32 s70, 3145728
    buffer_load_dwordx4 v94, s[44:47], s70 offen nt lds
    s_add_u32 m0, s71, 106496
    s_mov_b32 s70, 3932160
    buffer_load_dwordx4 v94, s[40:43], s70 offen nt lds
    s_add_u32 m0, s71, 139264
    s_mov_b32 s70, 3932160
    buffer_load_dwordx4 v87, s[48:51], s70 offen nt lds
    s_add_u32 m0, s71, 122880
    s_mov_b32 s70, 3932160
    buffer_load_dwordx4 v94, s[44:47], s70 offen nt lds
    s_waitcnt vmcnt(6)
    s_barrier
    v_add_u32 v88, 49152, v95
    ds_read_b64_tr_b16 v[112:113], v88 offset:32768
    ds_read_b64_tr_b16 v[114:115], v88 offset:33280
    ds_read_b64_tr_b16 v[116:117], v88 offset:36864
    ds_read_b64_tr_b16 v[118:119], v88 offset:37376
    ds_read_b64_tr_b16 v[120:121], v88 offset:40960
    ds_read_b64_tr_b16 v[122:123], v88 offset:41472
    ds_read_b64_tr_b16 v[124:125], v88 offset:45056
    ds_read_b64_tr_b16 v[126:127], v88 offset:45568
    s_waitcnt lgkmcnt(0)
    ds_bpermute_b32 v112, v90, v112
    ds_bpermute_b32 v113, v90, v113
    ds_bpermute_b32 v114, v90, v114
    ds_bpermute_b32 v115, v90, v115
    ds_bpermute_b32 v116, v90, v116
    ds_bpermute_b32 v117, v90, v117
    ds_bpermute_b32 v118, v90, v118
    ds_bpermute_b32 v119, v90, v119
    s_waitcnt lgkmcnt(6)
    ds_bpermute_b32 v120, v90, v120
    ds_bpermute_b32 v121, v90, v121
    ds_bpermute_b32 v122, v90, v122
    ds_bpermute_b32 v123, v90, v123
    ds_bpermute_b32 v124, v90, v124
    ds_bpermute_b32 v125, v90, v125
    ds_bpermute_b32 v126, v90, v126
    ds_bpermute_b32 v127, v90, v127
    s_waitcnt lgkmcnt(6)
    s_waitcnt lgkmcnt(0)
    s_add_u32 m0, s71, 0
    s_mov_b32 s70, 4718592
    buffer_load_dwordx4 v94, s[40:43], s70 offen nt lds
    s_add_u32 m0, s71, 32768
    s_mov_b32 s70, 4718592
    buffer_load_dwordx4 v87, s[48:51], s70 offen nt lds
    s_add_u32 m0, s71, 16384
    s_mov_b32 s70, 4718592
    buffer_load_dwordx4 v94, s[44:47], s70 offen nt lds
    s_add_u32 m0, s71, 8192
    s_mov_b32 s70, 5505024
    buffer_load_dwordx4 v94, s[40:43], s70 offen nt lds
    s_add_u32 m0, s71, 40960
    s_mov_b32 s70, 5505024
    buffer_load_dwordx4 v87, s[48:51], s70 offen nt lds
    s_add_u32 m0, s71, 24576
    s_mov_b32 s70, 5505024
    buffer_load_dwordx4 v94, s[44:47], s70 offen nt lds
    s_waitcnt vmcnt(6)
    s_barrier
    v_add_u32 v88, 98304, v95
    ds_read_b64_tr_b16 v[128:129], v88 offset:32768
    ds_read_b64_tr_b16 v[130:131], v88 offset:33280
    ds_read_b64_tr_b16 v[132:133], v88 offset:36864
    ds_read_b64_tr_b16 v[134:135], v88 offset:37376
    ds_read_b64_tr_b16 v[136:137], v88 offset:40960
    ds_read_b64_tr_b16 v[138:139], v88 offset:41472
    ds_read_b64_tr_b16 v[140:141], v88 offset:45056
    ds_read_b64_tr_b16 v[142:143], v88 offset:45568
    s_waitcnt lgkmcnt(0)
    ds_bpermute_b32 v128, v90, v128
    ds_bpermute_b32 v129, v90, v129
    ds_bpermute_b32 v130, v90, v130
    ds_bpermute_b32 v131, v90, v131
    ds_bpermute_b32 v132, v90, v132
    ds_bpermute_b32 v133, v90, v133
    ds_bpermute_b32 v134, v90, v134
    ds_bpermute_b32 v135, v90, v135
    s_waitcnt lgkmcnt(6)
    ds_bpermute_b32 v136, v90, v136
    ds_bpermute_b32 v137, v90, v137
    ds_bpermute_b32 v138, v90, v138
    ds_bpermute_b32 v139, v90, v139
    ds_bpermute_b32 v140, v90, v140
    ds_bpermute_b32 v141, v90, v141
    ds_bpermute_b32 v142, v90, v142
    ds_bpermute_b32 v143, v90, v143
    s_waitcnt lgkmcnt(6)
    s_waitcnt lgkmcnt(0)
    s_add_u32 m0, s71, 49152
    s_mov_b32 s70, 6291456
    buffer_load_dwordx4 v94, s[40:43], s70 offen nt lds
    s_add_u32 m0, s71, 81920
    s_mov_b32 s70, 6291456
    buffer_load_dwordx4 v87, s[48:51], s70 offen nt lds
    s_add_u32 m0, s71, 65536
    s_mov_b32 s70, 6291456
    buffer_load_dwordx4 v94, s[44:47], s70 offen nt lds
    s_add_u32 m0, s71, 57344
    s_mov_b32 s70, 7077888
    buffer_load_dwordx4 v94, s[40:43], s70 offen nt lds
    s_add_u32 m0, s71, 90112
    s_mov_b32 s70, 7077888
    buffer_load_dwordx4 v87, s[48:51], s70 offen nt lds
    s_add_u32 m0, s71, 73728
    s_mov_b32 s70, 7077888
    buffer_load_dwordx4 v94, s[44:47], s70 offen nt lds
    s_waitcnt vmcnt(6)
    s_barrier
    s_mul_i32 s70, s57, 10240
    s_add_u32 m0, s70, 57344
    s_mov_b32 s69, 0
    buffer_load_dwordx4 v7, s[52:55], s69 offen offset:0 lds
    s_add_u32 m0, m0, 896
    s_nop 0
    buffer_load_dwordx4 v7, s[52:55], s69 offen offset:128 lds
    s_add_u32 m0, m0, 896
    s_nop 0
    buffer_load_dwordx4 v7, s[52:55], s69 offen offset:256 lds
    s_add_u32 m0, m0, 896
    s_nop 0
    buffer_load_dwordx4 v7, s[52:55], s69 offen offset:384 lds
    s_add_u32 m0, m0, 896
    s_nop 0
    buffer_load_dwordx4 v7, s[52:55], s69 offen offset:512 lds
    s_add_u32 m0, m0, 896
    s_nop 0
    buffer_load_dwordx4 v7, s[52:55], s69 offen offset:640 lds
    s_add_u32 m0, m0, 896
    s_nop 0
    buffer_load_dwordx4 v7, s[52:55], s69 offen offset:768 lds
    s_add_u32 m0, m0, 896
    s_nop 0
    buffer_load_dwordx4 v7, s[52:55], s69 offen offset:896 lds
    s_add_u32 m0, m0, 896
    s_nop 0
    buffer_load_dwordx4 v7, s[52:55], s69 offen offset:1024 lds
    s_add_u32 m0, m0, 896
    s_nop 0
    buffer_load_dwordx4 v7, s[52:55], s69 offen offset:1152 lds
    v_add_u32 v88, 0, v95
    ds_read_b64_tr_b16 v[144:145], v88 offset:32768
    ds_read_b64_tr_b16 v[146:147], v88 offset:33280
    ds_read_b64_tr_b16 v[148:149], v88 offset:36864
    ds_read_b64_tr_b16 v[150:151], v88 offset:37376
    ds_read_b64_tr_b16 v[152:153], v88 offset:40960
    ds_read_b64_tr_b16 v[154:155], v88 offset:41472
    ds_read_b64_tr_b16 v[156:157], v88 offset:45056
    ds_read_b64_tr_b16 v[158:159], v88 offset:45568
    s_waitcnt lgkmcnt(0)
    ds_bpermute_b32 v144, v90, v144
    ds_bpermute_b32 v145, v90, v145
    ds_bpermute_b32 v146, v90, v146
    ds_bpermute_b32 v147, v90, v147
    ds_bpermute_b32 v148, v90, v148
    ds_bpermute_b32 v149, v90, v149
    ds_bpermute_b32 v150, v90, v150
    ds_bpermute_b32 v151, v90, v151
    s_waitcnt lgkmcnt(6)
    ds_bpermute_b32 v152, v90, v152
    ds_bpermute_b32 v153, v90, v153
    ds_bpermute_b32 v154, v90, v154
    ds_bpermute_b32 v155, v90, v155
    ds_bpermute_b32 v156, v90, v156
    ds_bpermute_b32 v157, v90, v157
    ds_bpermute_b32 v158, v90, v158
    ds_bpermute_b32 v159, v90, v159
    s_waitcnt lgkmcnt(6)
    s_waitcnt lgkmcnt(0)
    s_waitcnt vmcnt(10)
    s_barrier
    v_add_u32 v88, 49152, v95
    ds_read_b64_tr_b16 v[160:161], v88 offset:32768
    ds_read_b64_tr_b16 v[162:163], v88 offset:33280
    ds_read_b64_tr_b16 v[164:165], v88 offset:36864
    ds_read_b64_tr_b16 v[166:167], v88 offset:37376
    ds_read_b64_tr_b16 v[168:169], v88 offset:40960
    ds_read_b64_tr_b16 v[170:171], v88 offset:41472
    ds_read_b64_tr_b16 v[172:173], v88 offset:45056
    ds_read_b64_tr_b16 v[174:175], v88 offset:45568
    s_waitcnt lgkmcnt(0)
    ds_bpermute_b32 v160, v90, v160
    ds_bpermute_b32 v161, v90, v161
    ds_bpermute_b32 v162, v90, v162
    ds_bpermute_b32 v163, v90, v163
    ds_bpermute_b32 v164, v90, v164
    ds_bpermute_b32 v165, v90, v165
    ds_bpermute_b32 v166, v90, v166
    ds_bpermute_b32 v167, v90, v167
    s_waitcnt lgkmcnt(6)
    ds_bpermute_b32 v168, v90, v168
    ds_bpermute_b32 v169, v90, v169
    ds_bpermute_b32 v170, v90, v170
    ds_bpermute_b32 v171, v90, v171
    ds_bpermute_b32 v172, v90, v172
    ds_bpermute_b32 v173, v90, v173
    ds_bpermute_b32 v174, v90, v174
    ds_bpermute_b32 v175, v90, v175
    s_waitcnt lgkmcnt(6)
    s_waitcnt lgkmcnt(0)
    s_waitcnt vmcnt(0)
    s_barrier
    s_mov_b32 s42, 0x8000
    s_mov_b32 s43, 0x20000
    s_mov_b32 s46, 0x8000
    s_mov_b32 s47, 0x20000
    s_xor_b32 s67, s64, 32768
    s_add_u32 s44, s32, s67
    s_addc_u32 s45, s33, 0
    s_xor_b32 s67, s67, 32768
    s_add_u32 s40, s32, s67
    s_addc_u32 s41, s33, 0
    s_mov_b32 s66, 0x3000000
    s_mov_b32 s70, 0x6600000
    s_mul_i32 s61, s57, 10240
    s_add_u32 s61, s61, 4294926336
    s_mov_b32 s59, -1
    s_lshl_b32 s62, s58, 7
    s_add_u32 s62, s62, s64
    s_add_u32 s62, s62, 69632
    v_min_u32 v76, 9, v0
    v_lshl_add_u32 v76, v76, 2, s62
    v_mov_b32 v76, v80
    v_mov_b32 v77, 0
L_pv_loop:
    s_setprio 2
    s_add_u32 s69, s69, 40960
    s_mov_b32 m0, s61
    s_xor_b32 s61, s61, 98304
    buffer_load_dword v79, v78, s[32:35], 0 offen sc1
    ds_read_b128 v[16:19], v1 offset:0
    ds_read_b128 v[20:23], v1 offset:20480
    ds_read_b128 v[24:27], v2 offset:0
    ds_read_b128 v[28:31], v2 offset:20480
    ds_read_b128 v[32:35], v1 offset:1024
    ds_read_b128 v[36:39], v1 offset:21504
    ds_read_b128 v[40:43], v2 offset:1024
    ds_read_b128 v[44:47], v2 offset:21504
    s_waitcnt lgkmcnt(6)
    v_mfma_f32_16x16x32_bf16 v[56:59], v[96:99], v[16:19], 0
    ds_read_b128 v[48:51], v1 offset:2048
    ds_read_b128 v[52:55], v1 offset:22528
    v_mfma_f32_16x16x32_bf16 v[60:63], v[96:99], v[20:23], 0
    s_waitcnt lgkmcnt(6)
    v_mfma_f32_16x16x32_bf16 v[56:59], v[100:103], v[24:27], v[56:59]
    ds_read_b128 v[16:19], v2 offset:2048
    ds_read_b128 v[20:23], v2 offset:22528
    v_mfma_f32_16x16x32_bf16 v[60:63], v[100:103], v[28:31], v[60:63]
    s_waitcnt lgkmcnt(6)
    v_mfma_f32_16x16x32_bf16 v[56:59], v[104:107], v[32:35], v[56:59]
    ds_read_b128 v[24:27], v1 offset:3072
    ds_read_b128 v[28:31], v1 offset:23552
    v_mfma_f32_16x16x32_bf16 v[60:63], v[104:107], v[36:39], v[60:63]
    s_waitcnt lgkmcnt(6)
    v_mfma_f32_16x16x32_bf16 v[56:59], v[108:111], v[40:43], v[56:59]
    ds_read_b128 v[32:35], v2 offset:3072
    ds_read_b128 v[36:39], v2 offset:23552
    v_mfma_f32_16x16x32_bf16 v[60:63], v[108:111], v[44:47], v[60:63]
    s_waitcnt lgkmcnt(6)
    v_mfma_f32_16x16x32_bf16 v[56:59], v[112:115], v[48:51], v[56:59]
    ds_read_b128 v[40:43], v1 offset:4096
    ds_read_b128 v[44:47], v1 offset:24576
    v_mfma_f32_16x16x32_bf16 v[60:63], v[112:115], v[52:55], v[60:63]
    s_waitcnt lgkmcnt(6)
    v_mfma_f32_16x16x32_bf16 v[56:59], v[116:119], v[16:19], v[56:59]
    ds_read_b128 v[48:51], v2 offset:4096
    ds_read_b128 v[52:55], v2 offset:24576
    v_mfma_f32_16x16x32_bf16 v[60:63], v[116:119], v[20:23], v[60:63]
    s_waitcnt lgkmcnt(6)
    v_mfma_f32_16x16x32_bf16 v[56:59], v[120:123], v[24:27], v[56:59]
    ds_read_b128 v[16:19], v1 offset:5120
    ds_read_b128 v[20:23], v1 offset:25600
    v_mfma_f32_16x16x32_bf16 v[60:63], v[120:123], v[28:31], v[60:63]
    buffer_load_dwordx4 v7, s[52:55], s69 offen offset:0 lds
    s_waitcnt lgkmcnt(6)
    v_mfma_f32_16x16x32_bf16 v[56:59], v[124:127], v[32:35], v[56:59]
    ds_read_b128 v[24:27], v2 offset:5120
    ds_read_b128 v[28:31], v2 offset:25600
    v_mfma_f32_16x16x32_bf16 v[60:63], v[124:127], v[36:39], v[60:63]
    s_add_u32 m0, m0, 896
    s_nop 0
    buffer_load_dwordx4 v7, s[52:55], s69 offen offset:128 lds
    s_waitcnt lgkmcnt(6)
    v_mfma_f32_16x16x32_bf16 v[56:59], v[128:131], v[40:43], v[56:59]
    ds_read_b128 v[32:35], v1 offset:6144
    ds_read_b128 v[36:39], v1 offset:26624
    v_mfma_f32_16x16x32_bf16 v[60:63], v[128:131], v[44:47], v[60:63]
    s_add_u32 m0, m0, 896
    s_nop 0
    buffer_load_dwordx4 v7, s[52:55], s69 offen offset:256 lds
    s_waitcnt lgkmcnt(6)
    v_mfma_f32_16x16x32_bf16 v[56:59], v[132:135], v[48:51], v[56:59]
    ds_read_b128 v[40:43], v2 offset:6144
    ds_read_b128 v[44:47], v2 offset:26624
    v_mfma_f32_16x16x32_bf16 v[60:63], v[132:135], v[52:55], v[60:63]
    s_add_u32 m0, m0, 896
    s_nop 0
    buffer_load_dwordx4 v7, s[52:55], s69 offen offset:384 lds
    s_waitcnt lgkmcnt(6)
    v_mfma_f32_16x16x32_bf16 v[56:59], v[136:139], v[16:19], v[56:59]
    ds_read_b128 v[48:51], v1 offset:7168
    ds_read_b128 v[52:55], v1 offset:27648
    v_mfma_f32_16x16x32_bf16 v[60:63], v[136:139], v[20:23], v[60:63]
    s_add_u32 m0, m0, 896
    s_nop 0
    buffer_load_dwordx4 v7, s[52:55], s69 offen offset:512 lds
    s_waitcnt lgkmcnt(6)
    v_mfma_f32_16x16x32_bf16 v[56:59], v[140:143], v[24:27], v[56:59]
    ds_read_b128 v[16:19], v2 offset:7168
    ds_read_b128 v[20:23], v2 offset:27648
    v_mfma_f32_16x16x32_bf16 v[60:63], v[140:143], v[28:31], v[60:63]
    s_add_u32 m0, m0, 896
    s_nop 0
    buffer_load_dwordx4 v7, s[52:55], s69 offen offset:640 lds
    s_waitcnt lgkmcnt(6)
    v_mfma_f32_16x16x32_bf16 v[56:59], v[144:147], v[32:35], v[56:59]
    ds_read_b128 v[24:27], v1 offset:8192
    ds_read_b128 v[28:31], v1 offset:28672
    v_mfma_f32_16x16x32_bf16 v[60:63], v[144:147], v[36:39], v[60:63]
    s_add_u32 m0, m0, 896
    s_nop 0
    buffer_load_dwordx4 v7, s[52:55], s69 offen offset:768 lds
    s_waitcnt lgkmcnt(6)
    v_mfma_f32_16x16x32_bf16 v[56:59], v[148:151], v[40:43], v[56:59]
    ds_read_b128 v[32:35], v2 offset:8192
    ds_read_b128 v[36:39], v2 offset:28672
    v_mfma_f32_16x16x32_bf16 v[60:63], v[148:151], v[44:47], v[60:63]
    s_add_u32 m0, m0, 896
    s_nop 0
    buffer_load_dwordx4 v7, s[52:55], s69 offen offset:896 lds
    s_waitcnt lgkmcnt(6)
    v_mfma_f32_16x16x32_bf16 v[56:59], v[152:155], v[48:51], v[56:59]
    ds_read_b128 v[40:43], v1 offset:9216
    ds_read_b128 v[44:47], v1 offset:29696
    v_mfma_f32_16x16x32_bf16 v[60:63], v[152:155], v[52:55], v[60:63]
    s_add_u32 m0, m0, 896
    s_nop 0
    buffer_load_dwordx4 v7, s[52:55], s69 offen offset:1024 lds
    s_waitcnt lgkmcnt(6)
    v_mfma_f32_16x16x32_bf16 v[56:59], v[156:159], v[16:19], v[56:59]
    ds_read_b128 v[48:51], v2 offset:9216
    ds_read_b128 v[52:55], v2 offset:29696
    v_mfma_f32_16x16x32_bf16 v[60:63], v[156:159], v[20:23], v[60:63]
    s_add_u32 m0, m0, 896
    s_nop 0
    buffer_load_dwordx4 v7, s[52:55], s69 offen offset:1152 lds
    s_waitcnt lgkmcnt(6)
    v_mfma_f32_16x16x32_bf16 v[56:59], v[160:163], v[24:27], v[56:59]
    v_mfma_f32_16x16x32_bf16 v[60:63], v[160:163], v[28:31], v[60:63]
    s_waitcnt lgkmcnt(4)
    v_mfma_f32_16x16x32_bf16 v[56:59], v[164:167], v[32:35], v[56:59]
    v_mfma_f32_16x16x32_bf16 v[60:63], v[164:167], v[36:39], v[60:63]
    s_waitcnt lgkmcnt(2)
    v_mfma_f32_16x16x32_bf16 v[56:59], v[168:171], v[40:43], v[56:59]
    v_mfma_f32_16x16x32_bf16 v[60:63], v[168:171], v[44:47], v[60:63]
    s_waitcnt lgkmcnt(0)
    v_mfma_f32_16x16x32_bf16 v[56:59], v[172:175], v[48:51], v[56:59]
    v_mfma_f32_16x16x32_bf16 v[60:63], v[172:175], v[52:55], v[60:63]
L_pv_out:
    v_add_u32 v75, 1, v75
    s_nop 5
    v_cvt_pk_bf16_f32 v88, v56, v57
    v_cvt_pk_bf16_f32 v90, v58, v59
    v_cvt_pk_bf16_f32 v89, v60, v61
    v_cvt_pk_bf16_f32 v91, v62, v63
    v_xor_b32 v1, 98304, v1
    v_xor_b32 v2, 98304, v2
    v_permlane32_swap_b32 v88, v89
    v_permlane32_swap_b32 v90, v91
    s_sub_u32 s71, s59, 5
    s_waitcnt vmcnt(10)
    v_cmp_gt_i32 vcc, s71, v79
    s_cbranch_vccz L_pv_free
L_pv_wfree:
    buffer_load_dword v79, v78, s[32:35], 0 offen sc1
    s_waitcnt vmcnt(0)
    v_cmp_gt_i32 vcc, s71, v79
    s_cbranch_vccnz L_retry_8
L_ok_9:
L_pv_free:
    buffer_store_dwordx4 v[88:91], v6, s[32:35], s66 offen
    s_add_u32 s66, s66, 393216
    s_cmp_ge_u32 s66, 0x3180000
    s_cselect_b32 vcc_lo, 1572864, 0
    s_sub_u32 s66, s66, vcc_lo
    s_waitcnt vmcnt(0)
    buffer_store_dword v75, v14, s[32:35], 0 offen
    s_cmp_eq_u32 s59, -1
    s_cbranch_scc1 L_pv_first
L_pv_crit:
    v_mov_b32 v56, 0
    v_mov_b32 v57, 0
    v_mov_b32 v58, 0
    v_mov_b32 v59, 0
    v_add_u32 v77, 1, v77
    s_setprio 3
    s_mov_b32 m0, s65
    buffer_load_dword v190, v76, s[32:35], 0 offen sc1
    buffer_load_dword v191, v76, s[32:35], 0 offen sc1
    buffer_load_dword v192, v76, s[32:35], 0 offen sc1
.p2align 6
L_pv_hint:
    buffer_load_dword v193, v76, s[32:35], 0 offen sc1
    s_waitcnt vmcnt(3)
    v_cmp_gt_u32 vcc, s59, v190
    s_cbranch_vccz L_pv_hint_ok
    buffer_load_dword v190, v76, s[32:35], 0 offen sc1
    s_waitcnt vmcnt(3)
    v_cmp_gt_u32 vcc, s59, v191
    s_cbranch_vccz L_pv_hint_ok
    buffer_load_dword v191, v76, s[32:35], 0 offen sc1
    s_waitcnt vmcnt(3)
    v_cmp_gt_u32 vcc, s59, v192
    s_cbranch_vccz L_pv_hint_ok
    buffer_load_dword v192, v76, s[32:35], 0 offen sc1
    s_waitcnt vmcnt(3)
    v_cmp_gt_u32 vcc, s59, v193
    s_cbranch_vccnz L_retry_10
L_ok_11:
L_pv_hint_ok:
L_pv_shot:
    buffer_load_dwordx4 v8, s[40:43], 0 offen sc1 lds
    buffer_load_dwordx4 v8, s[40:43], 0 offen offset:1024 sc1 lds
    buffer_load_dword v9, s[40:43], 0 offen offset:2048 sc1 lds
    buffer_load_dword v9, s[40:43], 0 offen offset:2304 sc1 lds
    s_waitcnt vmcnt(0)
L_pv_a:
    s_barrier
    ds_read_b128 v[16:19], v3 offset:0
    ds_read_b128 v[20:23], v3 offset:1024
    ds_read_b128 v[24:27], v3 offset:2048
    ds_read_b128 v[28:31], v3 offset:3072
    ds_read_b128 v[32:35], v3 offset:4096
    ds_read_b128 v[36:39], v3 offset:5120
    s_waitcnt lgkmcnt(5)
    v_smfmac_f32_16x16x64_bf16 v[56:59], v[16:19], v[96:103], v4
    ds_read_b128 v[40:43], v3 offset:6144
    s_waitcnt lgkmcnt(5)
    v_smfmac_f32_16x16x64_bf16 v[56:59], v[20:23], v[104:111], v4
    ds_read_b128 v[44:47], v3 offset:7168
    s_waitcnt lgkmcnt(5)
    v_smfmac_f32_16x16x64_bf16 v[56:59], v[24:27], v[112:119], v4
    ds_read_b128 v[48:51], v3 offset:8192
    s_waitcnt lgkmcnt(5)
    v_smfmac_f32_16x16x64_bf16 v[56:59], v[28:31], v[120:127], v4
    ds_read_b128 v[52:55], v3 offset:9216
    s_waitcnt lgkmcnt(5)
    v_smfmac_f32_16x16x64_bf16 v[56:59], v[32:35], v[128:135], v4
    s_waitcnt lgkmcnt(4)
    v_smfmac_f32_16x16x64_bf16 v[56:59], v[36:39], v[136:143], v4
    s_waitcnt lgkmcnt(3)
    v_smfmac_f32_16x16x64_bf16 v[56:59], v[40:43], v[144:151], v4
    s_waitcnt lgkmcnt(2)
    v_smfmac_f32_16x16x64_bf16 v[56:59], v[44:47], v[152:159], v4
    s_waitcnt lgkmcnt(1)
    v_smfmac_f32_16x16x64_bf16 v[56:59], v[48:51], v[160:167], v4
    s_waitcnt lgkmcnt(0)
    v_smfmac_f32_16x16x64_bf16 v[56:59], v[52:55], v[168:175], v4
    buffer_store_dword v77, v74, s[32:35], 0 offen
    s_nop 7
    v_add_f32 v56, v56, v58
    v_add_f32 v57, v57, v59
    v_cmp_u_f32 vcc, v56, v57
    v_cvt_pk_bf16_f32 v88, v56, v57
    s_cbranch_vccnz L_pv_nan
L_pv_ok:
    buffer_store_short v88, v12, s[40:43], 0 offen
    buffer_store_short_d16_hi v88, v12, s[40:43], 0 offen offset:32
    buffer_store_dword v5, v15, s[44:47], 0 offen
    s_add_u32 s44, s32, s67
    s_addc_u32 s45, s33, 0
    s_xor_b32 s67, s67, 32768
    s_add_u32 s40, s32, s67
    s_addc_u32 s41, s33, 0
    s_add_u32 s59, s59, 1
    buffer_store_short v88, v13, s[32:35], s70 offen
    buffer_store_short_d16_hi v88, v13, s[32:35], s70 offen offset:384
    s_add_u32 s70, s70, 98304
    s_cmp_ge_u32 s70, 0x6660000
    s_cselect_b32 vcc_lo, 393216, 0
    s_sub_u32 s70, s70, vcc_lo
    s_setprio 0
    s_barrier
    s_waitcnt vmcnt(0)
    s_barrier
    s_cmp_lt_u32 s59, 63
    s_cbranch_scc1 L_pv_loop
    s_cmp_eq_u32 s59, 63
    s_cbranch_scc1 L_pv_crit
    s_endpgm
L_pv_first:
    s_mov_b32 s59, 0
    s_barrier
    s_branch L_pv_loop
L_role_o:
    s_sub_u32 s62, s58, 12
    s_lshl_b32 s63, s56, 17
    s_add_u32 s63, s63, 0xa000000
    s_mov_b32 s40, s22
    s_and_b32 s41, s23, 0xffff
    s_mov_b32 s42, 0x780000
    s_mov_b32 s43, 0x20000
    s_mov_b32 s44, s14
    s_and_b32 s45, s15, 0xffff
    s_mov_b32 s46, 0x2800
    s_mov_b32 s47, 0x20000
    v_lshrrev_b32 v20, 3, v0
    v_and_b32 v21, 2, v20
    s_and_b32 s64, s57, 1
    s_lshl_b32 s64, s64, 2
    v_or_b32 v21, s64, v21
    v_and_b32 v22, 7, v0
    v_xor_b32 v21, v21, v22
    v_lshlrev_b32 v21, 4, v21
    s_mul_i32 s65, s56, 768
    s_lshl_b32 s64, s57, 3
    s_add_u32 s64, s64, s65
    v_add_u32 v20, s64, v20
    v_mul_u32_u24 v20, 1280, v20
    s_lshl_b32 s64, s62, 7
    v_add3_u32 v26, v20, v21, s64
    v_lshrrev_b32 v20, 4, v0
    v_and_b32 v21, 15, v0
    v_lshrrev_b32 v22, 2, v21
    v_and_b32 v23, 1, v21
    v_lshl_add_u32 v24, v22, 1, v23
    v_bfe_u32 v25, v0, 1, 1
    s_mov_b32 s59, 0
    s_cmp_ge_u32 s57, 4
    s_cbranch_scc1 L_o_u
    v_mov_b32 v1, -1
    v_lshlrev_b32 v2, 4, v0
    s_and_b32 s65, s57, 3
    s_mul_i32 s65, s65, 12
    s_add_u32 s65, s65, s63
    s_lshl_b32 s64, s62, 7
    s_add_u32 s65, s65, s64
    s_add_u32 s65, s65, 67712
    v_min_u32 v22, 2, v0
    v_lshl_add_u32 v3, v22, 2, s65
    v_and_b32 v22, 60, v0
    v_and_b32 v23, 1, v0
    v_lshl_or_b32 v22, v23, 1, v22
    v_or_b32 v22, v22, v25
    s_mul_i32 s65, s57, 3072
    s_add_u32 s65, s65, 19456
    v_lshl_add_u32 v11, v22, 4, s65
    s_lshr_b32 s65, s57, 1
    s_lshl_b32 s65, s65, 10
    s_and_b32 s64, s57, 1
    s_lshl_b32 s64, s64, 3
    s_add_u32 s65, s65, s64
    s_add_u32 s65, s65, 98304
    v_lshl_add_u32 v12, v0, 4, s65
    v_mul_u32_u24 v13, 0xaaaa, v25
    v_add_u32 v13, 0x4444, v13
    v_bfe_u32 v27, v0, 2, 2
    v_and_b32 v22, 2, v27
    v_and_b32 v23, 1, v20
    v_lshl_or_b32 v22, v23, 2, v22
    v_or_b32 v22, v22, v25
    v_lshlrev_b32 v22, 4, v22
    v_lshl_add_u32 v22, v20, 10, v22
    v_lshl_add_u32 v22, v27, 7, v22
    v_and_b32 v23, 1, v0
    v_lshl_add_u32 v14, v23, 3, v22
    s_mul_i32 s65, s57, 24576
    v_add_u32 v14, s65, v14
    s_lshl_b32 s65, s62, 14
    s_lshl_b32 s64, s57, 11
    s_add_u32 s65, s65, s64
    s_lshl_b32 s64, s56, 8
    s_add_u32 s65, s65, s64
    v_xor_b32 v22, s65, v2
    v_xor_b32 v33, 1024, v22
    v_cmp_lt_u32 vcc, 15, v0
    v_mov_b32 v23, 0x40000000
    s_lshl_b32 s64, s57, 8
    v_cndmask_b32 v32, v23, v22, vcc
    v_cndmask_b32 v30, 0, 1, vcc
    s_add_u32 s64, s64, 114688
    v_lshl_add_u32 v8, v21, 4, s64
    v_bfe_u32 v22, v0, 3, 1
    v_lshlrev_b32 v22, 4, v22
    v_mov_b32 v23, 0x3f80
    v_lshlrev_b32 v23, v22, v23
    v_and_b32 v22, 7, v0
    v_cmp_eq_u32 s[48:49], 0, v22
    s_nop 1
    v_cndmask_b32 v44, 0, v23, s[48:49]
    v_cndmask_b32 v48, v44, 0, vcc
    v_cmp_eq_u32 s[48:49], 1, v22
    s_nop 1
    v_cndmask_b32 v45, 0, v23, s[48:49]
    v_cndmask_b32 v49, v45, 0, vcc
    v_cmp_eq_u32 s[48:49], 4, v22
    s_nop 1
    v_cndmask_b32 v46, 0, v23, s[48:49]
    v_cndmask_b32 v50, v46, 0, vcc
    v_cmp_eq_u32 s[48:49], 5, v22
    s_nop 1
    v_cndmask_b32 v47, 0, v23, s[48:49]
    v_cndmask_b32 v51, v47, 0, vcc
    s_lshl_b32 s65, s62, 2
    s_add_u32 s65, s65, s57
    s_lshl_b32 s64, s65, 5
    s_lshl_b32 s65, s65, 8
    v_lshl_add_u32 v10, v0, 2, s65
    v_bfe_u32 v22, v0, 2, 2
    v_and_b32 v23, 3, v0
    v_lshl_add_u32 v9, v22, 6, s65
    v_lshl_add_u32 v9, v20, 4, v9
    v_lshl_add_u32 v9, v23, 2, v9
    v_lshrrev_b32 v28, 1, v20
    v_lshl_add_u32 v22, v22, 1, v28
    v_mul_u32_u24 v22, 1280, v22
    v_lshl_add_u32 v22, v23, 3, v22
    v_and_b32 v23, 1, v20
    v_lshl_add_u32 v22, v23, 2, v22
    buffer_load_dword v28, v22, s[44:47], s64 offen
    s_add_u32 s68, s63, 32768
    buffer_store_dword v1, v10, s[32:35], s68 offen
    s_lshr_b32 s65, s65, 6
    s_add_u32 s65, s65, s63
    s_add_u32 s65, s65, 71680
    v_cmp_gt_u32 vcc, 3, v0
    v_mov_b32 v22, 0x40000000
    v_lshl_add_u32 v23, v0, 8, s65
    v_cndmask_b32 v31, v22, v23, vcc
    v_mov_b32 v34, 0
    buffer_store_dword v34, v31, s[32:35], 0 offen
    s_waitcnt vmcnt(2)
    buffer_store_dword v28, v9, s[32:35], s63 offen
    s_waitcnt vmcnt(0) lgkmcnt(0)
    s_barrier
    s_cmp_lg_u32 s57, 0
    s_cbranch_scc1 L_rdy_12
    s_lshl_b32 s61, s56, 4
    v_mov_b32 v20, 1
    v_mov_b32 v21, 8
    s_mov_b64 exec, 1
    buffer_atomic_add v20, v21, s[36:39], s61 offen
    s_mov_b64 exec, -1
L_rdy_12:
    s_barrier
    s_lshl_b32 s64, s62, 2
    s_add_u32 s64, s64, s57
    s_lshl_b32 s64, s64, 11
    s_add_u32 s64, s64, s63
    v_lshrrev_b32 v23, 2, v0
    v_lshlrev_b32 v23, 7, v23
    buffer_load_dword v24, v23, s[32:35], s64 offen sc1
    s_lshl_b32 s64, s57, 10
    s_add_u32 m0, s64, 0
    s_mov_b32 s65, 0
    buffer_load_dwordx4 v26, s[40:43], s65 offen nt lds
    s_add_u32 m0, s64, 8192
    s_mov_b32 s65, 81920
    buffer_load_dwordx4 v26, s[40:43], s65 offen nt lds
    s_add_u32 m0, s64, 16384
    s_mov_b32 s65, 163840
    buffer_load_dwordx4 v26, s[40:43], s65 offen nt lds
    s_add_u32 m0, s64, 24576
    s_mov_b32 s65, 245760
    buffer_load_dwordx4 v26, s[40:43], s65 offen nt lds
    s_add_u32 m0, s64, 32768
    s_mov_b32 s65, 327680
    buffer_load_dwordx4 v26, s[40:43], s65 offen nt lds
    s_add_u32 m0, s64, 40960
    s_mov_b32 s65, 409600
    buffer_load_dwordx4 v26, s[40:43], s65 offen nt lds
    s_add_u32 m0, s64, 49152
    s_mov_b32 s65, 491520
    buffer_load_dwordx4 v26, s[40:43], s65 offen nt lds
    s_add_u32 m0, s64, 57344
    s_mov_b32 s65, 573440
    buffer_load_dwordx4 v26, s[40:43], s65 offen nt lds
    s_add_u32 m0, s64, 65536
    s_mov_b32 s65, 655360
    buffer_load_dwordx4 v26, s[40:43], s65 offen nt lds
    s_add_u32 m0, s64, 73728
    s_mov_b32 s65, 737280
    buffer_load_dwordx4 v26, s[40:43], s65 offen nt lds
    s_add_u32 m0, s64, 81920
    s_mov_b32 s65, 819200
    buffer_load_dwordx4 v26, s[40:43], s65 offen nt lds
    s_add_u32 m0, s64, 90112
    s_mov_b32 s65, 901120
    buffer_load_dwordx4 v26, s[40:43], s65 offen nt lds
    s_waitcnt vmcnt(0)
    s_barrier
    v_xor_b32 v22, 0, v14
    ds_read_b64_tr_b16 v[160:161], v22 offset:0
    ds_read_b64_tr_b16 v[162:163], v22 offset:512
    ds_read_b64_tr_b16 v[164:165], v22 offset:4096
    ds_read_b64_tr_b16 v[166:167], v22 offset:4608
    ds_read_b64_tr_b16 v[168:169], v22 offset:8192
    ds_read_b64_tr_b16 v[170:171], v22 offset:8704
    ds_read_b64_tr_b16 v[172:173], v22 offset:12288
    ds_read_b64_tr_b16 v[174:175], v22 offset:12800
    ds_read_b64_tr_b16 v[176:177], v22 offset:16384
    ds_read_b64_tr_b16 v[178:179], v22 offset:16896
    ds_read_b64_tr_b16 v[180:181], v22 offset:20480
    ds_read_b64_tr_b16 v[182:183], v22 offset:20992
    s_waitcnt lgkmcnt(0)
    v_xor_b32 v22, 32, v14
    ds_read_b64_tr_b16 v[184:185], v22 offset:0
    ds_read_b64_tr_b16 v[186:187], v22 offset:512
    ds_read_b64_tr_b16 v[188:189], v22 offset:4096
    ds_read_b64_tr_b16 v[190:191], v22 offset:4608
    ds_read_b64_tr_b16 v[192:193], v22 offset:8192
    ds_read_b64_tr_b16 v[194:195], v22 offset:8704
    ds_read_b64_tr_b16 v[196:197], v22 offset:12288
    ds_read_b64_tr_b16 v[198:199], v22 offset:12800
    ds_read_b64_tr_b16 v[200:201], v22 offset:16384
    ds_read_b64_tr_b16 v[202:203], v22 offset:16896
    ds_read_b64_tr_b16 v[204:205], v22 offset:20480
    ds_read_b64_tr_b16 v[206:207], v22 offset:20992
    s_waitcnt lgkmcnt(0)
    v_xor_b32 v22, 64, v14
    ds_read_b64_tr_b16 v[208:209], v22 offset:0
    ds_read_b64_tr_b16 v[210:211], v22 offset:512
    ds_read_b64_tr_b16 v[212:213], v22 offset:4096
    ds_read_b64_tr_b16 v[214:215], v22 offset:4608
    ds_read_b64_tr_b16 v[216:217], v22 offset:8192
    ds_read_b64_tr_b16 v[218:219], v22 offset:8704
    ds_read_b64_tr_b16 v[220:221], v22 offset:12288
    ds_read_b64_tr_b16 v[222:223], v22 offset:12800
    ds_read_b64_tr_b16 v[224:225], v22 offset:16384
    ds_read_b64_tr_b16 v[226:227], v22 offset:16896
    ds_read_b64_tr_b16 v[228:229], v22 offset:20480
    ds_read_b64_tr_b16 v[230:231], v22 offset:20992
    s_waitcnt lgkmcnt(0)
    v_xor_b32 v22, 96, v14
    ds_read_b64_tr_b16 v[232:233], v22 offset:0
    ds_read_b64_tr_b16 v[234:235], v22 offset:512
    ds_read_b64_tr_b16 v[236:237], v22 offset:4096
    ds_read_b64_tr_b16 v[238:239], v22 offset:4608
    ds_read_b64_tr_b16 v[240:241], v22 offset:8192
    ds_read_b64_tr_b16 v[242:243], v22 offset:8704
    ds_read_b64_tr_b16 v[244:245], v22 offset:12288
    ds_read_b64_tr_b16 v[246:247], v22 offset:12800
    ds_read_b64_tr_b16 v[248:249], v22 offset:16384
    ds_read_b64_tr_b16 v[250:251], v22 offset:16896
    ds_read_b64_tr_b16 v[252:253], v22 offset:20480
    ds_read_b64_tr_b16 v[254:255], v22 offset:20992
    s_waitcnt lgkmcnt(0)
    s_mov_b32 s40, 0x3f80
    s_mov_b32 s41, 0x3f800000
    s_mov_b32 s42, 0x3dd53b95
    s_mov_b32 s43, s42
    s_mov_b32 s46, 0x8000
    s_mov_b32 s47, 0x20000
    s_mov_b32 s50, 0x8000
    s_mov_b32 s51, 0x20000
    s_xor_b32 s68, s63, 32768
    s_add_u32 s48, s32, s68
    s_addc_u32 s49, s33, 0
    s_xor_b32 s68, s68, 32768
    s_add_u32 s44, s32, s68
    s_addc_u32 s45, s33, 0
    s_mov_b32 s67, 0
    s_mov_b32 s70, 4
    s_barrier
    s_mul_i32 s66, s56, 49152
    s_and_b32 s65, s57, 3
    s_mul_i32 s65, s65, 0
    s_add_u32 s65, s65, 49152
    s_add_u32 s66, s66, s65
    s_add_u32 s66, s66, 0x3000000
    s_add_u32 s66, s66, 393216
    s_cmp_ge_u32 s66, 0x3180000
    s_cselect_b32 vcc_lo, 1572864, 0
    s_sub_u32 s66, s66, vcc_lo
    v_mov_b32 v22, 115712
    ds_read_b32 v20, v22
    s_waitcnt lgkmcnt(0)
    v_readfirstlane_b32 s71, v20
    s_nop 1
    s_lshl_b32 s71, s71, 12
    s_and_b32 s71, s71, 8192
    s_lshl_b32 s64, s56, 11
    s_and_b32 s64, s64, 8192
    s_xor_b32 s71, s71, s64
    s_add_u32 s64, 0, 1
    s_and_b32 s64, s64, 0
    s_mul_i32 s64, s64, 163840
    v_add_u32 v152, s64, v32
    v_add_u32 v153, s64, v33
    s_add_u32 s64, 0, 0
    s_and_b32 s64, s64, 0
    s_mul_i32 s64, s64, 163840
    v_add_u32 v150, s64, v32
    v_add_u32 v151, s64, v33
    s_add_u32 s71, s71, 0xa200000
    s_mov_b32 s54, 0x100000
    s_mov_b32 s55, 0x20000
    s_add_u32 s52, s32, s71
    s_addc_u32 s53, s33, 0
    s_waitcnt vmcnt(0)
    s_barrier
    s_barrier
    s_barrier
    s_setprio 3
L_os_loop:
    s_barrier
    v_mov_b32 v124, 0
    v_mov_b32 v125, 0
    v_mov_b32 v126, 0
    v_mov_b32 v127, 0
    v_mov_b32 v128, 0
    v_mov_b32 v129, 0
    v_mov_b32 v130, 0
    v_mov_b32 v131, 0
    v_mov_b32 v132, 0
    v_mov_b32 v133, 0
    v_mov_b32 v134, 0
    v_mov_b32 v135, 0
    v_mov_b32 v136, 0
    v_mov_b32 v137, 0
    v_mov_b32 v138, 0
    v_mov_b32 v139, 0
    v_add_u32 v34, 1, v34
    s_sleep 4
    buffer_load_dword v100, v3, s[32:35], 0 offen sc1
    buffer_load_dword v101, v3, s[32:35], 0 offen sc1
    buffer_load_dword v102, v3, s[32:35], 0 offen sc1
.p2align 6
L_os_hint:
    buffer_load_dword v103, v3, s[32:35], 0 offen sc1
    s_waitcnt vmcnt(3)
    v_cmp_ge_u32 vcc, s59, v100
    s_cbranch_vccz L_os_hint_ok
    buffer_load_dword v100, v3, s[32:35], 0 offen sc1
    s_waitcnt vmcnt(3)
    v_cmp_ge_u32 vcc, s59, v101
    s_cbranch_vccz L_os_hint_ok
    buffer_load_dword v101, v3, s[32:35], 0 offen sc1
    s_waitcnt vmcnt(3)
    v_cmp_ge_u32 vcc, s59, v102
    s_cbranch_vccz L_os_hint_ok
    buffer_load_dword v102, v3, s[32:35], 0 offen sc1
    s_waitcnt vmcnt(3)
    v_cmp_ge_u32 vcc, s59, v103
    s_cbranch_vccnz L_retry_13
L_ok_14:
L_os_hint_ok:
    buffer_load_dwordx4 v[112:115], v11, s[44:47], 0 offen offset:0 sc1
    buffer_load_dwordx4 v[116:119], v11, s[44:47], 0 offen offset:1024 sc1
    buffer_load_dwordx4 v[120:123], v11, s[44:47], 0 offen offset:2048 sc1
    s_barrier
L_os_pollv:
    s_waitcnt vmcnt(2)
    v_smfmac_f32_16x16x64_bf16 v[124:127], v[112:115], v[160:167], v13
    v_max3_u32 v28, v112, v113, 0
    v_smfmac_f32_16x16x64_bf16 v[128:131], v[112:115], v[184:191], v13
    v_max3_u32 v28, v114, v115, v28
    v_smfmac_f32_16x16x64_bf16 v[132:135], v[112:115], v[208:215], v13
    v_smfmac_f32_16x16x64_bf16 v[136:139], v[112:115], v[232:239], v13
    s_waitcnt vmcnt(1)
    v_smfmac_f32_16x16x64_bf16 v[124:127], v[116:119], v[168:175], v13
    v_max3_u32 v28, v116, v117, v28
    v_smfmac_f32_16x16x64_bf16 v[128:131], v[116:119], v[192:199], v13
    v_max3_u32 v28, v118, v119, v28
    v_smfmac_f32_16x16x64_bf16 v[132:135], v[116:119], v[216:223], v13
    v_smfmac_f32_16x16x64_bf16 v[136:139], v[116:119], v[240:247], v13
    s_waitcnt vmcnt(0)
    v_smfmac_f32_16x16x64_bf16 v[124:127], v[120:123], v[176:183], v13
    v_max3_u32 v28, v120, v121, v28
    v_smfmac_f32_16x16x64_bf16 v[128:131], v[120:123], v[200:207], v13
    v_max3_u32 v28, v122, v123, v28
    v_smfmac_f32_16x16x64_bf16 v[132:135], v[120:123], v[224:231], v13
    v_cmp_eq_u32 vcc, -1, v28
    v_smfmac_f32_16x16x64_bf16 v[136:139], v[120:123], v[248:255], v13
    s_cbranch_vccnz L_retry_15
L_ok_16:
    s_nop 1
    s_setprio 0
    v_cvt_pk_bf16_f32 v140, v124, v125
    v_cvt_pk_bf16_f32 v141, v126, v127
    ds_write_b64 v12, v[140:141] offset:0
    v_cvt_pk_bf16_f32 v142, v128, v129
    v_cvt_pk_bf16_f32 v143, v130, v131
    ds_write_b64 v12, v[142:143] offset:2048
    v_cvt_pk_bf16_f32 v144, v132, v133
    v_cvt_pk_bf16_f32 v145, v134, v135
    ds_write_b64 v12, v[144:145] offset:4096
    v_cvt_pk_bf16_f32 v146, v136, v137
    v_cvt_pk_bf16_f32 v147, v138, v139
    ds_write_b64 v12, v[146:147] offset:6144
    s_waitcnt lgkmcnt(0)
    s_setprio 3
    s_barrier
    buffer_store_dword v1, v10, s[44:47], 0 offen
    s_barrier
    buffer_load_dwordx4 v[64:67], v150, s[52:55], 0 offen sc1
    buffer_load_dwordx4 v[68:71], v151, s[52:55], 0 offen sc1
    ds_read_b128 v[60:63], v8
    s_waitcnt lgkmcnt(0)
    v_mfma_f32_16x16x32_bf16 v[40:43], v[48:51], v[60:63], 0
    s_barrier
    buffer_load_dwordx4 v[72:75], v152, s[52:55], 0 offen sc1
    buffer_load_dwordx4 v[76:79], v153, s[52:55], 0 offen sc1
    s_add_u32 s59, s59, 1
    s_nop 1
L_os_c0:
    s_waitcnt vmcnt(3)
    v_mfma_f32_16x16x32_bf16 v[56:59], v[44:47], v[64:67], v[40:43]
    v_bitop3_b32 v60, v64, v65, s67 bitop3:0x7e
    v_bitop3_b32 v61, v66, v67, s67 bitop3:0x7e
    s_waitcnt vmcnt(2)
    v_mfma_f32_16x16x32_bf16 v[56:59], v[44:47], v[68:71], v[56:59]
    v_bitop3_b32 v62, v68, v69, s67 bitop3:0x7e
    v_bitop3_b32 v63, v70, v71, s67 bitop3:0x7e
    v_bitop3_b32 v60, v60, v61, v30 bitop3:0xa8
    v_bitop3_b32 v62, v62, v63, 1 bitop3:0x02
    v_cmp_ge_u32 vcc, v60, v62
    s_nop 2
    v_cvt_pk_bf16_f32 v28, v56, v57
    s_cbranch_vccnz L_os_r0
L_os_g0:
    buffer_store_dword v34, v31, s[32:35], 0 offen
    buffer_store_dword v28, v9, s[48:51], 0 offen
    s_branch L_os_csum
L_os_c1:
    s_waitcnt vmcnt(3)
    v_mfma_f32_16x16x32_bf16 v[56:59], v[44:47], v[72:75], v[40:43]
    v_bitop3_b32 v60, v72, v73, s67 bitop3:0x7e
    v_bitop3_b32 v61, v74, v75, s67 bitop3:0x7e
    s_waitcnt vmcnt(2)
    v_mfma_f32_16x16x32_bf16 v[56:59], v[44:47], v[76:79], v[56:59]
    v_bitop3_b32 v62, v76, v77, s67 bitop3:0x7e
    v_bitop3_b32 v63, v78, v79, s67 bitop3:0x7e
    v_bitop3_b32 v60, v60, v61, v30 bitop3:0xa8
    v_bitop3_b32 v62, v62, v63, 1 bitop3:0x02
    v_cmp_ge_u32 vcc, v60, v62
    s_nop 2
    v_cvt_pk_bf16_f32 v28, v56, v57
    s_cbranch_vccnz L_os_r1
L_os_g1:
    buffer_store_dword v34, v31, s[32:35], 0 offen
    buffer_store_dword v28, v9, s[48:51], 0 offen
L_os_csum:
    s_xor_b32 s71, s71, 1048576
    s_bfe_u32 s67, s59, 0x10001
    s_add_u32 s48, s32, s68
    s_addc_u32 s49, s33, 0
    s_xor_b32 s68, s68, 32768
    s_add_u32 s44, s32, s68
    s_addc_u32 s45, s33, 0
    s_add_u32 s52, s32, s71
    s_addc_u32 s53, s33, 0
    s_cmp_lt_u32 s59, 63
    s_cbranch_scc1 L_os_loop
    s_cmp_lg_u32 s57, 0
    s_cbranch_scc1 L_os_lw_ok
    s_add_u32 s65, s63, 66608
    v_and_b32 v22, 3, v0
    v_lshl_add_u32 v22, v22, 2, s65
    s_sleep 40
    buffer_load_dword v100, v22, s[32:35], 0 offen sc1
.p2align 6
L_os_lw:
    buffer_load_dword v101, v22, s[32:35], 0 offen sc1
    s_waitcnt vmcnt(1)
    v_cmp_ge_u32 vcc, s59, v100
    s_cbranch_vccz L_os_lw_ok
    buffer_load_dword v100, v22, s[32:35], 0 offen sc1
    s_waitcnt vmcnt(1)
    v_cmp_ge_u32 vcc, s59, v101
    s_cbranch_vccnz L_retry_17
L_ok_18:
L_os_lw_ok:
    s_mul_i32 s65, s57, 3072
    s_mul_i32 s66, s56, 49152
    s_add_u32 s66, s66, s65
    s_barrier
    s_add_u32 m0, s65, 0
    s_add_u32 s64, s66, 0x4920000
    buffer_load_dwordx4 v2, s[32:35], s64 offen offset:0 sc1 lds
    buffer_load_dwordx4 v2, s[32:35], s64 offen offset:1024 sc1 lds
    buffer_load_dwordx4 v2, s[32:35], s64 offen offset:2048 sc1 lds
    s_add_u32 m0, s65, 24576
    s_add_u32 s64, s66, 0x4926000
    buffer_load_dwordx4 v2, s[32:35], s64 offen offset:0 sc1 lds
    buffer_load_dwordx4 v2, s[32:35], s64 offen offset:1024 sc1 lds
    buffer_load_dwordx4 v2, s[32:35], s64 offen offset:2048 sc1 lds
    s_waitcnt vmcnt(3)
    s_barrier
    s_waitcnt vmcnt(0)
    s_barrier
    s_endpgm
L_o_u:
    v_mov_b32 v1, -1
    v_lshlrev_b32 v2, 4, v0
    s_lshl_b32 s65, s57, 11
    s_add_u32 s65, s65, 90112
    v_lshl_add_u32 v3, v0, 4, s65
    s_lshl_b32 s65, s62, 2
    s_add_u32 s65, s65, s63
    s_add_u32 s65, s65, 69632
    s_and_b32 s64, s57, 3
    s_cselect_b32 s65, 0x40000000, s65
    v_cmp_gt_u32 vcc, 12, v0
    v_mov_b32 v22, 0x40000000
    v_lshl_add_u32 v23, v0, 7, s65
    v_cndmask_b32 v11, v22, v23, vcc
    v_mov_b32 v12, 0
    buffer_store_dword v12, v11, s[32:35], 0 offen
    v_and_b32 v22, 1, v20
    v_lshlrev_b32 v23, 1, v22
    v_xor_b32 v23, v23, v21
    v_lshlrev_b32 v23, 3, v23
    v_lshl_add_u32 v23, v22, 7, v23
    v_lshrrev_b32 v22, 1, v20
    v_lshl_add_u32 v23, v22, 9, v23
    v_add_u32 v4, 110592, v23
    v_mul_u32_u24 v5, 0xaaaa, v25
    v_add_u32 v5, 0x4444, v5
    s_and_b32 s70, s57, 3
    s_lshl_b32 s65, s62, 14
    s_lshl_b32 s64, s70, 11
    s_add_u32 s65, s65, s64
    s_lshl_b32 s64, s56, 8
    s_add_u32 s65, s65, s64
    v_lshl_add_u32 v6, v0, 2, s65
    v_min_u32 v22, 47, v0
    s_add_u32 s65, s63, 65536
    v_lshl_add_u32 v7, v22, 2, s65
    s_lshl_b32 s64, s70, 8
    s_add_u32 s64, s64, 114688
    v_lshl_add_u32 v9, v0, 2, s64
    s_mov_b32 s65, 0xa200000
    buffer_store_dword v1, v6, s[32:35], s65 offen sc1
    s_mov_b32 s65, 0xa202000
    buffer_store_dword v1, v6, s[32:35], s65 offen sc1
    s_mov_b32 s65, 0xa300000
    buffer_store_dword v1, v6, s[32:35], s65 offen sc1
    s_mov_b32 s65, 0xa302000
    buffer_store_dword v1, v6, s[32:35], s65 offen sc1
    s_mul_i32 s65, s70, 2304
    s_add_u32 s65, s65, 10240
    v_lshl_add_u32 v14, v0, 2, s65
    v_or_b32 v15, 8, v14
    v_bfe_u32 v22, v0, 2, 1
    v_bfe_u32 v23, v0, 3, 1
    v_lshlrev_b32 v28, 1, v23
    v_xor_b32 v28, v28, v20
    v_lshlrev_b32 v28, 3, v28
    v_lshl_add_u32 v28, v23, 7, v28
    v_lshl_add_u32 v28, v22, 8, v28
    v_and_b32 v22, 1, v0
    v_lshl_add_u32 v28, v22, 5, v28
    v_lshl_add_u32 v28, v25, 2, v28
    s_lshl_b32 s64, s70, 9
    s_add_u32 s64, s64, 110592
    v_add_u32 v16, s64, v28
    s_lshr_b32 s64, s70, 1
    s_lshl_b32 s64, s64, 9
    s_and_b32 s65, s70, 1
    s_lshl_b32 s65, s65, 6
    s_add_u32 s64, s64, s65
    s_add_u32 s64, s64, 112640
    v_add_u32 v17, s64, v28
    s_and_b32 s65, s57, 3
    s_mul_i32 s65, s65, 12
    s_add_u32 s65, s65, s63
    s_lshl_b32 s64, s62, 7
    s_add_u32 s65, s65, s64
    s_add_u32 s65, s65, 67712
    v_min_u32 v22, 2, v0
    v_lshl_add_u32 v18, v22, 2, s65
    v_add_u32 v18, 64, v18
    v_bfe_u32 v27, v0, 2, 2
    v_and_b32 v22, 2, v27
    v_and_b32 v23, 1, v20
    v_lshl_or_b32 v22, v23, 2, v22
    v_or_b32 v22, v22, v25
    v_lshlrev_b32 v22, 4, v22
    v_lshl_add_u32 v22, v20, 10, v22
    v_lshl_add_u32 v22, v27, 7, v22
    v_and_b32 v23, 1, v0
    v_lshl_add_u32 v8, v23, 3, v22
    s_lshl_b32 s64, s70, 5
    v_xor_b32 v8, s64, v8
    s_waitcnt vmcnt(0)
    s_barrier
    s_cmp_lg_u32 s57, 0
    s_cbranch_scc1 L_rdy_19
    s_lshl_b32 s61, s56, 4
    v_mov_b32 v20, 1
    v_mov_b32 v21, 8
    s_mov_b64 exec, 1
    buffer_atomic_add v20, v21, s[36:39], s61 offen
    s_mov_b64 exec, -1
L_rdy_19:
    s_cmp_lg_u32 s57, 4
    s_cbranch_scc1 L_nrdy_20
    v_mov_b32 v20, 0
    s_sleep 64
L_wrdy_21:
    buffer_load_dword v21, v20, s[36:39], 0 offen offset:252 sc1
    s_waitcnt vmcnt(0)
    v_cmp_gt_u32 vcc, 1, v21
    s_cbranch_vccnz L_retry_22
L_ok_23:
    v_mov_b32 v20, 115712
    ds_write_b32 v20, v21
    s_waitcnt lgkmcnt(0)
L_nrdy_20:
    s_barrier
    s_lshl_b32 s64, s57, 10
    s_add_u32 m0, s64, 0
    s_mov_b32 s65, 0
    buffer_load_dwordx4 v26, s[40:43], s65 offen nt lds
    s_add_u32 m0, s64, 8192
    s_mov_b32 s65, 81920
    buffer_load_dwordx4 v26, s[40:43], s65 offen nt lds
    s_add_u32 m0, s64, 16384
    s_mov_b32 s65, 163840
    buffer_load_dwordx4 v26, s[40:43], s65 offen nt lds
    s_add_u32 m0, s64, 24576
    s_mov_b32 s65, 245760
    buffer_load_dwordx4 v26, s[40:43], s65 offen nt lds
    s_add_u32 m0, s64, 32768
    s_mov_b32 s65, 327680
    buffer_load_dwordx4 v26, s[40:43], s65 offen nt lds
    s_add_u32 m0, s64, 40960
    s_mov_b32 s65, 409600
    buffer_load_dwordx4 v26, s[40:43], s65 offen nt lds
    s_add_u32 m0, s64, 49152
    s_mov_b32 s65, 491520
    buffer_load_dwordx4 v26, s[40:43], s65 offen nt lds
    s_add_u32 m0, s64, 57344
    s_mov_b32 s65, 573440
    buffer_load_dwordx4 v26, s[40:43], s65 offen nt lds
    s_add_u32 m0, s64, 65536
    s_mov_b32 s65, 655360
    buffer_load_dwordx4 v26, s[40:43], s65 offen nt lds
    s_add_u32 m0, s64, 73728
    s_mov_b32 s65, 737280
    buffer_load_dwordx4 v26, s[40:43], s65 offen nt lds
    s_add_u32 m0, s64, 81920
    s_mov_b32 s65, 819200
    buffer_load_dwordx4 v26, s[40:43], s65 offen nt lds
    s_add_u32 m0, s64, 90112
    s_mov_b32 s65, 901120
    buffer_load_dwordx4 v26, s[40:43], s65 offen nt lds
    s_waitcnt vmcnt(0)
    s_barrier
    ds_read_b64_tr_b16 v[132:133], v8 offset:0
    ds_read_b64_tr_b16 v[134:135], v8 offset:512
    ds_read_b64_tr_b16 v[136:137], v8 offset:4096
    ds_read_b64_tr_b16 v[138:139], v8 offset:4608
    ds_read_b64_tr_b16 v[140:141], v8 offset:8192
    ds_read_b64_tr_b16 v[142:143], v8 offset:8704
    ds_read_b64_tr_b16 v[144:145], v8 offset:12288
    ds_read_b64_tr_b16 v[146:147], v8 offset:12800
    s_waitcnt lgkmcnt(4)
    ds_read_b64_tr_b16 v[148:149], v8 offset:16384
    ds_read_b64_tr_b16 v[150:151], v8 offset:16896
    ds_read_b64_tr_b16 v[152:153], v8 offset:20480
    ds_read_b64_tr_b16 v[154:155], v8 offset:20992
    ds_read_b64_tr_b16 v[156:157], v8 offset:24576
    ds_read_b64_tr_b16 v[158:159], v8 offset:25088
    ds_read_b64_tr_b16 v[160:161], v8 offset:28672
    ds_read_b64_tr_b16 v[162:163], v8 offset:29184
    s_waitcnt lgkmcnt(4)
    ds_read_b64_tr_b16 v[164:165], v8 offset:32768
    ds_read_b64_tr_b16 v[166:167], v8 offset:33280
    ds_read_b64_tr_b16 v[168:169], v8 offset:36864
    ds_read_b64_tr_b16 v[170:171], v8 offset:37376
    ds_read_b64_tr_b16 v[172:173], v8 offset:40960
    ds_read_b64_tr_b16 v[174:175], v8 offset:41472
    ds_read_b64_tr_b16 v[176:177], v8 offset:45056
    ds_read_b64_tr_b16 v[178:179], v8 offset:45568
    s_waitcnt lgkmcnt(4)
    v_add_u32 v8, 49152, v8
    ds_read_b64_tr_b16 v[180:181], v8 offset:0
    ds_read_b64_tr_b16 v[182:183], v8 offset:512
    ds_read_b64_tr_b16 v[184:185], v8 offset:4096
    ds_read_b64_tr_b16 v[186:187], v8 offset:4608
    ds_read_b64_tr_b16 v[188:189], v8 offset:8192
    ds_read_b64_tr_b16 v[190:191], v8 offset:8704
    ds_read_b64_tr_b16 v[192:193], v8 offset:12288
    ds_read_b64_tr_b16 v[194:195], v8 offset:12800
    s_waitcnt lgkmcnt(4)
    ds_read_b64_tr_b16 v[196:197], v8 offset:16384
    ds_read_b64_tr_b16 v[198:199], v8 offset:16896
    ds_read_b64_tr_b16 v[200:201], v8 offset:20480
    ds_read_b64_tr_b16 v[202:203], v8 offset:20992
    ds_read_b64_tr_b16 v[204:205], v8 offset:24576
    ds_read_b64_tr_b16 v[206:207], v8 offset:25088
    ds_read_b64_tr_b16 v[208:209], v8 offset:28672
    ds_read_b64_tr_b16 v[210:211], v8 offset:29184
    s_waitcnt lgkmcnt(4)
    ds_read_b64_tr_b16 v[212:213], v8 offset:32768
    ds_read_b64_tr_b16 v[214:215], v8 offset:33280
    ds_read_b64_tr_b16 v[216:217], v8 offset:36864
    ds_read_b64_tr_b16 v[218:219], v8 offset:37376
    ds_read_b64_tr_b16 v[220:221], v8 offset:40960
    ds_read_b64_tr_b16 v[222:223], v8 offset:41472
    ds_read_b64_tr_b16 v[224:225], v8 offset:45056
    ds_read_b64_tr_b16 v[226:227], v8 offset:45568
    s_waitcnt lgkmcnt(4)
    s_waitcnt lgkmcnt(0)
    s_cmp_lg_u32 s57, 4
    s_cbranch_scc1 L_nrdy_24
    v_mov_b32 v20, 0
    s_lshl_b32 s61, s56, 17
    s_add_u32 s61, s61, 0xa010000
    v_min_u32 v20, 47, v0
    v_lshl_add_u32 v20, v20, 2, s61
L_wrdy_25v:
    buffer_load_dword v21, v20, s[32:35], 0 offen sc1
    s_waitcnt vmcnt(0)
    v_cmp_gt_u32 vcc, 1, v21
    s_cbranch_vccnz L_retry_26
L_ok_27:
L_nrdy_24:
    s_setprio 2
    s_mov_b32 s40, 0x3f80
    s_mov_b32 s41, 0x3f800000
    s_mov_b32 s42, 0x3dd53b95
    s_mov_b32 s43, s42
    s_mov_b32 s46, 0x8000
    s_mov_b32 s47, 0x20000
    s_mov_b32 s71, s63
    s_add_u32 s44, s32, s71
    s_addc_u32 s45, s33, 0
    s_mul_i32 s69, s56, 49152
    s_and_b32 s65, s57, 3
    s_mul_i32 s65, s65, 12288
    s_add_u32 s65, s65, 0
    s_add_u32 s69, s69, s65
    s_add_u32 s69, s69, 0x3000000
    s_barrier
    s_add_u32 m0, s65, 0
    s_add_u32 s64, s69, 0
    buffer_load_dwordx4 v2, s[32:35], s64 offen offset:0 sc1 lds
    buffer_load_dwordx4 v2, s[32:35], s64 offen offset:1024 sc1 lds
    buffer_load_dwordx4 v2, s[32:35], s64 offen offset:2048 sc1 lds
    buffer_load_dwordx4 v2, s[32:35], s64 offen offset:3072 sc1 lds
    s_add_u32 m0, s65, 4096
    s_add_u32 s64, s69, 4096
    buffer_load_dwordx4 v2, s[32:35], s64 offen offset:0 sc1 lds
    buffer_load_dwordx4 v2, s[32:35], s64 offen offset:1024 sc1 lds
    buffer_load_dwordx4 v2, s[32:35], s64 offen offset:2048 sc1 lds
    buffer_load_dwordx4 v2, s[32:35], s64 offen offset:3072 sc1 lds
    s_add_u32 m0, s65, 8192
    s_add_u32 s64, s69, 8192
    buffer_load_dwordx4 v2, s[32:35], s64 offen offset:0 sc1 lds
    buffer_load_dwordx4 v2, s[32:35], s64 offen offset:1024 sc1 lds
    buffer_load_dwordx4 v2, s[32:35], s64 offen offset:2048 sc1 lds
    buffer_load_dwordx4 v2, s[32:35], s64 offen offset:3072 sc1 lds
    s_add_u32 s69, s69, 393216
    s_cmp_ge_u32 s69, 0x3180000
    s_cselect_b32 vcc_lo, 1572864, 0
    s_sub_u32 s69, s69, vcc_lo
    v_mov_b32 v22, 115712
    ds_read_b32 v20, v22
    s_waitcnt lgkmcnt(0)
    v_readfirstlane_b32 s67, v20
    s_nop 1
    s_lshl_b32 s67, s67, 12
    s_and_b32 s67, s67, 8192
    s_lshl_b32 s64, s56, 11
    s_and_b32 s64, s64, 8192
    s_xor_b32 s67, s67, s64
    v_add_u32 v13, s67, v6
    v_xor_b32 v6, 8192, v13
    s_mov_b32 s66, 0xa200000
    s_mov_b32 s54, 0x100000
    s_mov_b32 s55, 0x20000
    s_add_u32 s52, s32, s66
    s_addc_u32 s53, s33, 0
    s_waitcnt vmcnt(0)
    s_barrier
L_ou_loop:
    ds_read_b128 v[32:35], v2 offset:0
    ds_read_b128 v[36:39], v2 offset:1024
    ds_read_b128 v[40:43], v2 offset:2048
    ds_read_b128 v[44:47], v2 offset:3072
    ds_read_b128 v[48:51], v2 offset:4096
    ds_read_b128 v[52:55], v2 offset:5120
    ds_read_b128 v[56:59], v2 offset:6144
    ds_read_b128 v[60:63], v2 offset:7168
    ds_read_b128 v[64:67], v2 offset:8192
    ds_read_b128 v[68:71], v2 offset:9216
    s_waitcnt lgkmcnt(8)
    v_mfma_f32_16x16x32_bf16 v[80:83], v[32:35], v[132:135], 0
    ds_read_b128 v[72:75], v2 offset:10240
    v_mfma_f32_16x16x32_bf16 v[84:87], v[36:39], v[132:135], 0
    ds_read_b128 v[76:79], v2 offset:11264
    s_waitcnt lgkmcnt(8)
    v_mfma_f32_16x16x32_bf16 v[80:83], v[40:43], v[136:139], v[80:83]
    ds_read_b128 v[32:35], v2 offset:12288
    v_mfma_f32_16x16x32_bf16 v[84:87], v[44:47], v[136:139], v[84:87]
    ds_read_b128 v[36:39], v2 offset:13312
    s_waitcnt lgkmcnt(8)
    v_mfma_f32_16x16x32_bf16 v[80:83], v[48:51], v[140:143], v[80:83]
    ds_read_b128 v[40:43], v2 offset:14336
    v_mfma_f32_16x16x32_bf16 v[84:87], v[52:55], v[140:143], v[84:87]
    ds_read_b128 v[44:47], v2 offset:15360
    s_waitcnt lgkmcnt(8)
    v_mfma_f32_16x16x32_bf16 v[80:83], v[56:59], v[144:147], v[80:83]
    ds_read_b128 v[48:51], v2 offset:16384
    v_mfma_f32_16x16x32_bf16 v[84:87], v[60:63], v[144:147], v[84:87]
    ds_read_b128 v[52:55], v2 offset:17408
    s_waitcnt lgkmcnt(8)
    v_mfma_f32_16x16x32_bf16 v[80:83], v[64:67], v[148:151], v[80:83]
    ds_read_b128 v[56:59], v2 offset:18432
    v_mfma_f32_16x16x32_bf16 v[84:87], v[68:71], v[148:151], v[84:87]
    ds_read_b128 v[60:63], v2 offset:19456
    s_waitcnt lgkmcnt(8)
    v_mfma_f32_16x16x32_bf16 v[80:83], v[72:75], v[152:155], v[80:83]
    ds_read_b128 v[64:67], v2 offset:20480
    v_mfma_f32_16x16x32_bf16 v[84:87], v[76:79], v[152:155], v[84:87]
    ds_read_b128 v[68:71], v2 offset:21504
    s_barrier
    s_waitcnt lgkmcnt(8)
    v_mfma_f32_16x16x32_bf16 v[88:91], v[32:35], v[156:159], 0
    ds_read_b128 v[72:75], v2 offset:22528
    v_mfma_f32_16x16x32_bf16 v[92:95], v[36:39], v[156:159], 0
    ds_read_b128 v[76:79], v2 offset:23552
    s_waitcnt lgkmcnt(8)
    v_mfma_f32_16x16x32_bf16 v[88:91], v[40:43], v[160:163], v[88:91]
    ds_read_b128 v[32:35], v2 offset:24576
    v_mfma_f32_16x16x32_bf16 v[92:95], v[44:47], v[160:163], v[92:95]
    ds_read_b128 v[36:39], v2 offset:25600
    s_waitcnt lgkmcnt(8)
    v_mfma_f32_16x16x32_bf16 v[88:91], v[48:51], v[164:167], v[88:91]
    ds_read_b128 v[40:43], v2 offset:26624
    v_mfma_f32_16x16x32_bf16 v[92:95], v[52:55], v[164:167], v[92:95]
    ds_read_b128 v[44:47], v2 offset:27648
    v_cvt_pk_bf16_f32 v100, v80, v81
    s_waitcnt lgkmcnt(8)
    v_mfma_f32_16x16x32_bf16 v[88:91], v[56:59], v[168:171], v[88:91]
    ds_read_b128 v[48:51], v2 offset:28672
    v_mfma_f32_16x16x32_bf16 v[92:95], v[60:63], v[168:171], v[92:95]
    ds_read_b128 v[52:55], v2 offset:29696
    v_cvt_pk_bf16_f32 v101, v82, v83
    s_waitcnt lgkmcnt(8)
    v_mfma_f32_16x16x32_bf16 v[88:91], v[64:67], v[172:175], v[88:91]
    ds_read_b128 v[56:59], v2 offset:30720
    v_mfma_f32_16x16x32_bf16 v[92:95], v[68:71], v[172:175], v[92:95]
    ds_read_b128 v[60:63], v2 offset:31744
    v_cvt_pk_bf16_f32 v102, v84, v85
    s_waitcnt lgkmcnt(8)
    v_mfma_f32_16x16x32_bf16 v[88:91], v[72:75], v[176:179], v[88:91]
    ds_read_b128 v[64:67], v2 offset:32768
    v_mfma_f32_16x16x32_bf16 v[92:95], v[76:79], v[176:179], v[92:95]
    ds_read_b128 v[68:71], v2 offset:33792
    v_cvt_pk_bf16_f32 v103, v86, v87
    s_waitcnt lgkmcnt(8)
    v_mfma_f32_16x16x32_bf16 v[80:83], v[32:35], v[180:183], 0
    ds_read_b128 v[72:75], v2 offset:34816
    s_barrier
    v_mfma_f32_16x16x32_bf16 v[84:87], v[36:39], v[180:183], 0
    ds_read_b128 v[76:79], v2 offset:35840
    s_waitcnt lgkmcnt(8)
    v_mfma_f32_16x16x32_bf16 v[80:83], v[40:43], v[184:187], v[80:83]
    ds_read_b128 v[32:35], v2 offset:36864
    v_mfma_f32_16x16x32_bf16 v[84:87], v[44:47], v[184:187], v[84:87]
    ds_read_b128 v[36:39], v2 offset:37888
    s_waitcnt lgkmcnt(8)
    v_mfma_f32_16x16x32_bf16 v[80:83], v[48:51], v[188:191], v[80:83]
    ds_read_b128 v[40:43], v2 offset:38912
    v_mfma_f32_16x16x32_bf16 v[84:87], v[52:55], v[188:191], v[84:87]
    ds_read_b128 v[44:47], v2 offset:39936
    v_cvt_pk_bf16_f32 v104, v88, v89
    s_waitcnt lgkmcnt(8)
    v_mfma_f32_16x16x32_bf16 v[80:83], v[56:59], v[192:195], v[80:83]
    ds_read_b128 v[48:51], v2 offset:40960
    v_mfma_f32_16x16x32_bf16 v[84:87], v[60:63], v[192:195], v[84:87]
    ds_read_b128 v[52:55], v2 offset:41984
    v_cvt_pk_bf16_f32 v105, v90, v91
    s_waitcnt lgkmcnt(8)
    v_mfma_f32_16x16x32_bf16 v[80:83], v[64:67], v[196:199], v[80:83]
    ds_read_b128 v[56:59], v2 offset:43008
    v_mfma_f32_16x16x32_bf16 v[84:87], v[68:71], v[196:199], v[84:87]
    ds_read_b128 v[60:63], v2 offset:44032
    v_cvt_pk_bf16_f32 v106, v92, v93
    s_waitcnt lgkmcnt(8)
    v_mfma_f32_16x16x32_bf16 v[80:83], v[72:75], v[200:203], v[80:83]
    ds_read_b128 v[64:67], v2 offset:45056
    buffer_load_dword v228, v7, s[32:35], 0 offen sc1
    v_mfma_f32_16x16x32_bf16 v[84:87], v[76:79], v[200:203], v[84:87]
    ds_read_b128 v[68:71], v2 offset:46080
    v_cvt_pk_bf16_f32 v107, v94, v95
    ds_read_b128 v[72:75], v2 offset:47104
    ds_read_b128 v[76:79], v2 offset:48128
    s_nop 3
    v_cvt_pk_bf16_f32 v108, v80, v81
    v_cvt_pk_bf16_f32 v109, v82, v83
    v_cvt_pk_bf16_f32 v110, v84, v85
    v_cvt_pk_bf16_f32 v111, v86, v87
    s_add_u32 s64, s59, 2
    s_waitcnt vmcnt(0) lgkmcnt(0)
    v_cmp_gt_u32 vcc, s64, v228
    s_cbranch_vccnz L_ou_vwait
L_ou_vok:
    s_barrier
    s_add_u32 m0, s65, 0
    s_add_u32 s64, s69, 0
    buffer_load_dwordx4 v2, s[32:35], s64 offen offset:0 sc1 lds
    v_mfma_f32_16x16x32_bf16 v[88:91], v[32:35], v[204:207], 0
    v_mfma_f32_16x16x32_bf16 v[92:95], v[36:39], v[204:207], 0
    v_mfma_f32_16x16x32_bf16 v[88:91], v[40:43], v[208:211], v[88:91]
    buffer_load_dwordx4 v2, s[32:35], s64 offen offset:1024 sc1 lds
    v_mfma_f32_16x16x32_bf16 v[92:95], v[44:47], v[208:211], v[92:95]
    v_mfma_f32_16x16x32_bf16 v[88:91], v[48:51], v[212:215], v[88:91]
    v_mfma_f32_16x16x32_bf16 v[92:95], v[52:55], v[212:215], v[92:95]
    buffer_load_dwordx4 v2, s[32:35], s64 offen offset:2048 sc1 lds
    v_mfma_f32_16x16x32_bf16 v[88:91], v[56:59], v[216:219], v[88:91]
    v_mfma_f32_16x16x32_bf16 v[92:95], v[60:63], v[216:219], v[92:95]
    v_mfma_f32_16x16x32_bf16 v[88:91], v[64:67], v[220:223], v[88:91]
    buffer_load_dwordx4 v2, s[32:35], s64 offen offset:3072 sc1 lds
    v_mfma_f32_16x16x32_bf16 v[92:95], v[68:71], v[220:223], v[92:95]
    v_mfma_f32_16x16x32_bf16 v[88:91], v[72:75], v[224:227], v[88:91]
    v_mfma_f32_16x16x32_bf16 v[92:95], v[76:79], v[224:227], v[92:95]
    s_add_u32 m0, s65, 4096
    s_add_u32 s64, s69, 4096
    buffer_load_dwordx4 v2, s[32:35], s64 offen offset:0 sc1 lds
    buffer_load_dwordx4 v2, s[32:35], s64 offen offset:1024 sc1 lds
    buffer_load_dwordx4 v2, s[32:35], s64 offen offset:2048 sc1 lds
    buffer_load_dwordx4 v2, s[32:35], s64 offen offset:3072 sc1 lds
    s_add_u32 m0, s65, 8192
    s_add_u32 s64, s69, 8192
    buffer_load_dwordx4 v2, s[32:35], s64 offen offset:0 sc1 lds
    buffer_load_dwordx4 v2, s[32:35], s64 offen offset:1024 sc1 lds
    buffer_load_dwordx4 v2, s[32:35], s64 offen offset:2048 sc1 lds
    buffer_load_dwordx4 v2, s[32:35], s64 offen offset:3072 sc1 lds
    s_add_u32 s69, s69, 393216
    s_cmp_ge_u32 s69, 0x3180000
    s_cselect_b32 vcc_lo, 1572864, 0
    s_sub_u32 s69, s69, vcc_lo
    s_nop 1
    v_mov_b32 v96, 0
    v_mov_b32 v97, 0
    v_mov_b32 v98, 0
    v_mov_b32 v99, 0
    v_add_u32 v12, 1, v12
    s_bfe_u32 s68, s59, 0x10001
    v_cvt_pk_bf16_f32 v112, v88, v89
    v_cvt_pk_bf16_f32 v113, v90, v91
    v_cvt_pk_bf16_f32 v114, v92, v93
    v_cvt_pk_bf16_f32 v115, v94, v95
.p2align 6
    s_barrier
    s_nop 15
    s_nop 15
    s_nop 15
    s_nop 15
    s_nop 15
    buffer_load_dword v48, v14, s[44:47], 0 offen offset:0 sc1
    buffer_load_dword v49, v14, s[44:47], 0 offen offset:256 sc1
    buffer_load_dword v50, v15, s[44:47], 0 offen offset:512 sc1
    buffer_load_dword v51, v14, s[44:47], 0 offen offset:768 sc1
    buffer_load_dword v52, v14, s[44:47], 0 offen offset:1024 sc1
    buffer_load_dword v53, v15, s[44:47], 0 offen offset:1280 sc1
    buffer_load_dword v54, v14, s[44:47], 0 offen offset:1536 sc1
    buffer_load_dword v55, v14, s[44:47], 0 offen offset:1792 sc1
    buffer_load_dword v56, v15, s[44:47], 0 offen offset:2048 sc1
L_os_polls:
    s_waitcnt vmcnt(6)
    v_max3_u32 v28, v48, v49, v50
    v_dot2_f32_bf16 v58, v48, s40, 0
    v_dot2_f32_bf16 v59, v48, s41, 0
    v_dot2_f32_bf16 v60, v49, s40, 0
    v_dot2_f32_bf16 v61, v49, s41, 0
    v_dot2_f32_bf16 v62, v50, s40, 0
    v_dot2_f32_bf16 v63, v50, s41, 0
    s_waitcnt vmcnt(3)
    v_max3_u32 v28, v28, v51, v52
    v_max_u32 v28, v28, v53
    v_dot2_f32_bf16 v58, v51, s40, v58
    v_dot2_f32_bf16 v59, v51, s41, v59
    v_dot2_f32_bf16 v60, v52, s40, v60
    v_dot2_f32_bf16 v61, v52, s41, v61
    v_dot2_f32_bf16 v62, v53, s40, v62
    v_dot2_f32_bf16 v63, v53, s41, v63
    s_waitcnt vmcnt(0)
    v_max3_u32 v28, v28, v54, v55
    v_max_u32 v28, v28, v56
    v_cmp_eq_u32 vcc, -1, v28
    v_dot2_f32_bf16 v58, v54, s40, v58
    v_dot2_f32_bf16 v59, v54, s41, v59
    v_dot2_f32_bf16 v60, v55, s40, v60
    v_dot2_f32_bf16 v61, v55, s41, v61
    v_dot2_f32_bf16 v62, v56, s40, v62
    v_dot2_f32_bf16 v63, v56, s41, v63
    s_cbranch_vccnz L_retry_28
L_ok_29:
    s_nop 0
    v_max3_f32 v28, v58, v60, v62
    v_max3_f32 v29, v59, v61, v63
    s_nop 0
    v_max_f32_dpp v28, v28, v28 quad_perm:[1,0,3,2] row_mask:0xf bank_mask:0xf
    v_max_f32_dpp v29, v29, v29 quad_perm:[1,0,3,2] row_mask:0xf bank_mask:0xf
    s_nop 0
    v_max_f32_dpp v28, v28, v28 quad_perm:[2,3,0,1] row_mask:0xf bank_mask:0xf
    v_max_f32_dpp v29, v29, v29 quad_perm:[2,3,0,1] row_mask:0xf bank_mask:0xf
    s_nop 0
    v_max_f32_dpp v28, v28, v28 row_half_mirror row_mask:0xf bank_mask:0xf
    v_max_f32_dpp v29, v29, v29 row_half_mirror row_mask:0xf bank_mask:0xf
    s_nop 0
    v_max_f32_dpp v28, v28, v28 row_mirror row_mask:0xf bank_mask:0xf
    v_max_f32_dpp v29, v29, v29 row_mirror row_mask:0xf bank_mask:0xf
    v_pk_mul_f32 v[28:29], v[28:29], s[42:43]
    v_pk_fma_f32 v[58:59], v[58:59], s[42:43], v[28:29] neg_lo:[0,0,1] neg_hi:[0,0,1]
    v_pk_fma_f32 v[60:61], v[60:61], s[42:43], v[28:29] neg_lo:[0,0,1] neg_hi:[0,0,1]
    v_pk_fma_f32 v[62:63], v[62:63], s[42:43], v[28:29] neg_lo:[0,0,1] neg_hi:[0,0,1]
    v_exp_f32 v58, v58
    v_exp_f32 v59, v59
    v_exp_f32 v60, v60
    v_exp_f32 v61, v61
    v_exp_f32 v62, v62
    v_exp_f32 v63, v63
    v_pk_add_f32 v[28:29], v[58:59], v[60:61]
    v_pk_fma_f32 v[28:29], v[62:63], 0.5, v[28:29] op_sel_hi:[1,0,1]
    s_nop 0
    s_nop 0
    v_add_f32_dpp v28, v28, v28 quad_perm:[1,0,3,2] row_mask:0xf bank_mask:0xf
    v_add_f32_dpp v29, v29, v29 quad_perm:[1,0,3,2] row_mask:0xf bank_mask:0xf
    s_nop 0
    v_add_f32_dpp v28, v28, v28 quad_perm:[2,3,0,1] row_mask:0xf bank_mask:0xf
    v_add_f32_dpp v29, v29, v29 quad_perm:[2,3,0,1] row_mask:0xf bank_mask:0xf
    s_nop 0
    v_add_f32_dpp v28, v28, v28 row_half_mirror row_mask:0xf bank_mask:0xf
    v_add_f32_dpp v29, v29, v29 row_half_mirror row_mask:0xf bank_mask:0xf
    s_nop 0
    v_add_f32_dpp v28, v28, v28 row_mirror row_mask:0xf bank_mask:0xf
    v_add_f32_dpp v29, v29, v29 row_mirror row_mask:0xf bank_mask:0xf
    v_rcp_f32 v28, v28
    v_rcp_f32 v29, v29
    s_nop 0
    v_pk_mul_f32 v[58:59], v[58:59], v[28:29]
    v_pk_mul_f32 v[60:61], v[60:61], v[28:29]
    v_cvt_pk_bf16_f32 v64, v58, v59
    v_cvt_pk_bf16_f32 v65, v60, v61
    ds_write2_b32 v16, v64, v65 offset1:16
    v_pk_mul_f32 v[62:63], v[62:63], v[28:29]
    v_cvt_pk_bf16_f32 v66, v62, v63
    ds_write_b32 v17, v66
    s_waitcnt lgkmcnt(0)
    s_barrier
    ds_read_b64_tr_b16 v[32:33], v4 offset:0
    ds_read_b64_tr_b16 v[34:35], v4 offset:256
    ds_read_b64_tr_b16 v[36:37], v4 offset:1024
    ds_read_b64_tr_b16 v[38:39], v4 offset:1280
    ds_read_b64_tr_b16 v[40:41], v4 offset:2048
    ds_read_b64_tr_b16 v[42:43], v4 offset:2304
    ds_read_b128 v[116:119], v3 offset:0
    ds_read_b128 v[120:123], v3 offset:1024
    s_waitcnt lgkmcnt(6)
    v_smfmac_f32_16x16x64_bf16 v[96:99], v[32:35], v[100:107], v5
    s_waitcnt lgkmcnt(4)
    v_smfmac_f32_16x16x64_bf16 v[96:99], v[36:39], v[108:115], v5
    s_waitcnt lgkmcnt(0)
    v_smfmac_f32_16x16x64_bf16 v[96:99], v[40:43], v[116:123], v5
    s_add_u32 s59, s59, 1
    s_nop 6
    v_pk_add_f32 v[96:97], v[96:97], v[98:99]
    v_cvt_pk_bf16_f32 v29, v96, v97
    v_and_or_b32 v28, v29, -2, s68
    buffer_store_dword v28, v6, s[52:55], 0 offen sc1
    buffer_store_dword v28, v13, s[52:55], 0 offen sc1
    ds_write_b32 v9, v28
    s_xor_b32 s66, s66, 1048576
    s_add_u32 s52, s32, s66
    s_addc_u32 s53, s33, 0
    s_xor_b32 s71, s71, 32768
    s_add_u32 s44, s32, s71
    s_addc_u32 s45, s33, 0
    s_cmp_lt_u32 s59, 63
    s_cbranch_scc1 L_ou_loop
    s_waitcnt lgkmcnt(0)
    s_sleep 6
    s_barrier
    s_sleep 3
    s_barrier
    s_lshl_b32 s65, s62, 2
    s_add_u32 s65, s65, s70
    s_mul_i32 s64, s65, 13
    s_lshr_b32 s64, s64, 7
    s_lshl_b32 s65, s65, 7
    s_mul_i32 s64, s64, 80640
    s_add_u32 s65, s65, s64
    s_mul_i32 s64, s56, 1280
    s_add_u32 s65, s65, s64
    s_add_u32 s65, s65, 0x7fb0000
    v_bfe_u32 v22, v0, 2, 3
    v_mul_u32_u24 v22, 10240, v22
    v_lshrrev_b32 v23, 5, v0
    v_lshl_add_u32 v22, v23, 6, v22
    v_and_b32 v23, 3, v0
    v_lshl_add_u32 v22, v23, 4, v22
    v_add_u32 v22, s65, v22
    s_mul_i32 s65, s57, 3072
    s_mul_i32 s66, s56, 49152
    s_add_u32 s66, s66, s65
    s_barrier
    s_add_u32 m0, s65, 0
    s_add_u32 s64, s66, 0x4920000
    buffer_load_dwordx4 v2, s[32:35], s64 offen offset:0 sc1 lds
    buffer_load_dwordx4 v2, s[32:35], s64 offen offset:1024 sc1 lds
    buffer_load_dwordx4 v2, s[32:35], s64 offen offset:2048 sc1 lds
    s_add_u32 m0, s65, 24576
    s_add_u32 s64, s66, 0x4926000
    buffer_load_dwordx4 v2, s[32:35], s64 offen offset:0 sc1 lds
    buffer_load_dwordx4 v2, s[32:35], s64 offen offset:1024 sc1 lds
    buffer_load_dwordx4 v2, s[32:35], s64 offen offset:2048 sc1 lds
    s_waitcnt vmcnt(3)
    s_barrier
    ds_read_b128 v[32:35], v2 offset:0
    ds_read_b128 v[36:39], v2 offset:1024
    ds_read_b128 v[40:43], v2 offset:2048
    ds_read_b128 v[44:47], v2 offset:3072
    ds_read_b128 v[48:51], v2 offset:4096
    ds_read_b128 v[52:55], v2 offset:5120
    s_waitcnt lgkmcnt(4)
    v_mfma_f32_16x16x32_bf16 v[80:83], v[132:135], v[32:35], 0
    ds_read_b128 v[56:59], v2 offset:6144
    v_mfma_f32_16x16x32_bf16 v[84:87], v[132:135], v[36:39], 0
    ds_read_b128 v[60:63], v2 offset:7168
    s_waitcnt lgkmcnt(4)
    v_mfma_f32_16x16x32_bf16 v[80:83], v[136:139], v[40:43], v[80:83]
    ds_read_b128 v[64:67], v2 offset:8192
    v_mfma_f32_16x16x32_bf16 v[84:87], v[136:139], v[44:47], v[84:87]
    ds_read_b128 v[68:71], v2 offset:9216
    s_waitcnt lgkmcnt(4)
    v_mfma_f32_16x16x32_bf16 v[80:83], v[140:143], v[48:51], v[80:83]
    ds_read_b128 v[72:75], v2 offset:10240
    v_mfma_f32_16x16x32_bf16 v[84:87], v[140:143], v[52:55], v[84:87]
    ds_read_b128 v[76:79], v2 offset:11264
    s_waitcnt lgkmcnt(4)
    v_mfma_f32_16x16x32_bf16 v[80:83], v[144:147], v[56:59], v[80:83]
    ds_read_b128 v[32:35], v2 offset:12288
    v_mfma_f32_16x16x32_bf16 v[84:87], v[144:147], v[60:63], v[84:87]
    ds_read_b128 v[36:39], v2 offset:13312
    s_waitcnt lgkmcnt(4)
    v_mfma_f32_16x16x32_bf16 v[80:83], v[148:151], v[64:67], v[80:83]
    ds_read_b128 v[40:43], v2 offset:14336
    v_mfma_f32_16x16x32_bf16 v[84:87], v[148:151], v[68:71], v[84:87]
    ds_read_b128 v[44:47], v2 offset:15360
    s_waitcnt lgkmcnt(4)
    v_mfma_f32_16x16x32_bf16 v[80:83], v[152:155], v[72:75], v[80:83]
    ds_read_b128 v[48:51], v2 offset:16384
    v_mfma_f32_16x16x32_bf16 v[84:87], v[152:155], v[76:79], v[84:87]
    ds_read_b128 v[52:55], v2 offset:17408
    s_waitcnt lgkmcnt(4)
    v_mfma_f32_16x16x32_bf16 v[80:83], v[156:159], v[32:35], v[80:83]
    ds_read_b128 v[56:59], v2 offset:18432
    v_mfma_f32_16x16x32_bf16 v[84:87], v[156:159], v[36:39], v[84:87]
    ds_read_b128 v[60:63], v2 offset:19456
    s_waitcnt lgkmcnt(4)
    v_mfma_f32_16x16x32_bf16 v[80:83], v[160:163], v[40:43], v[80:83]
    ds_read_b128 v[64:67], v2 offset:20480
    v_mfma_f32_16x16x32_bf16 v[84:87], v[160:163], v[44:47], v[84:87]
    ds_read_b128 v[68:71], v2 offset:21504
    s_waitcnt lgkmcnt(4)
    v_mfma_f32_16x16x32_bf16 v[80:83], v[164:167], v[48:51], v[80:83]
    ds_read_b128 v[72:75], v2 offset:22528
    v_mfma_f32_16x16x32_bf16 v[84:87], v[164:167], v[52:55], v[84:87]
    ds_read_b128 v[76:79], v2 offset:23552
    s_waitcnt lgkmcnt(4)
    v_mfma_f32_16x16x32_bf16 v[80:83], v[168:171], v[56:59], v[80:83]
    v_mfma_f32_16x16x32_bf16 v[84:87], v[168:171], v[60:63], v[84:87]
    s_waitcnt lgkmcnt(2)
    v_mfma_f32_16x16x32_bf16 v[80:83], v[172:175], v[64:67], v[80:83]
    v_mfma_f32_16x16x32_bf16 v[84:87], v[172:175], v[68:71], v[84:87]
    s_waitcnt lgkmcnt(0)
    v_mfma_f32_16x16x32_bf16 v[80:83], v[176:179], v[72:75], v[80:83]
    v_mfma_f32_16x16x32_bf16 v[84:87], v[176:179], v[76:79], v[84:87]
    s_waitcnt vmcnt(0)
    s_barrier
    ds_read_b128 v[32:35], v2 offset:24576
    ds_read_b128 v[36:39], v2 offset:25600
    ds_read_b128 v[40:43], v2 offset:26624
    ds_read_b128 v[44:47], v2 offset:27648
    ds_read_b128 v[48:51], v2 offset:28672
    ds_read_b128 v[52:55], v2 offset:29696
    s_waitcnt lgkmcnt(4)
    v_mfma_f32_16x16x32_bf16 v[80:83], v[180:183], v[32:35], v[80:83]
    ds_read_b128 v[56:59], v2 offset:30720
    v_mfma_f32_16x16x32_bf16 v[84:87], v[180:183], v[36:39], v[84:87]
    ds_read_b128 v[60:63], v2 offset:31744
    s_waitcnt lgkmcnt(4)
    v_mfma_f32_16x16x32_bf16 v[80:83], v[184:187], v[40:43], v[80:83]
    ds_read_b128 v[64:67], v2 offset:32768
    v_mfma_f32_16x16x32_bf16 v[84:87], v[184:187], v[44:47], v[84:87]
    ds_read_b128 v[68:71], v2 offset:33792
    s_waitcnt lgkmcnt(4)
    v_mfma_f32_16x16x32_bf16 v[80:83], v[188:191], v[48:51], v[80:83]
    ds_read_b128 v[72:75], v2 offset:34816
    v_mfma_f32_16x16x32_bf16 v[84:87], v[188:191], v[52:55], v[84:87]
    ds_read_b128 v[76:79], v2 offset:35840
    s_waitcnt lgkmcnt(4)
    v_mfma_f32_16x16x32_bf16 v[80:83], v[192:195], v[56:59], v[80:83]
    ds_read_b128 v[32:35], v2 offset:36864
    v_mfma_f32_16x16x32_bf16 v[84:87], v[192:195], v[60:63], v[84:87]
    ds_read_b128 v[36:39], v2 offset:37888
    s_waitcnt lgkmcnt(4)
    v_mfma_f32_16x16x32_bf16 v[80:83], v[196:199], v[64:67], v[80:83]
    ds_read_b128 v[40:43], v2 offset:38912
    v_mfma_f32_16x16x32_bf16 v[84:87], v[196:199], v[68:71], v[84:87]
    ds_read_b128 v[44:47], v2 offset:39936
    s_waitcnt lgkmcnt(4)
    v_mfma_f32_16x16x32_bf16 v[80:83], v[200:203], v[72:75], v[80:83]
    ds_read_b128 v[48:51], v2 offset:40960
    v_mfma_f32_16x16x32_bf16 v[84:87], v[200:203], v[76:79], v[84:87]
    ds_read_b128 v[52:55], v2 offset:41984
    s_waitcnt lgkmcnt(4)
    v_mfma_f32_16x16x32_bf16 v[80:83], v[204:207], v[32:35], v[80:83]
    ds_read_b128 v[56:59], v2 offset:43008
    v_mfma_f32_16x16x32_bf16 v[84:87], v[204:207], v[36:39], v[84:87]
    ds_read_b128 v[60:63], v2 offset:44032
    s_waitcnt lgkmcnt(4)
    v_mfma_f32_16x16x32_bf16 v[80:83], v[208:211], v[40:43], v[80:83]
    ds_read_b128 v[64:67], v2 offset:45056
    v_mfma_f32_16x16x32_bf16 v[84:87], v[208:211], v[44:47], v[84:87]
    ds_read_b128 v[68:71], v2 offset:46080
    s_waitcnt lgkmcnt(4)
    v_mfma_f32_16x16x32_bf16 v[80:83], v[212:215], v[48:51], v[80:83]
    ds_read_b128 v[72:75], v2 offset:47104
    v_mfma_f32_16x16x32_bf16 v[84:87], v[212:215], v[52:55], v[84:87]
    ds_read_b128 v[76:79], v2 offset:48128
    s_waitcnt lgkmcnt(4)
    v_mfma_f32_16x16x32_bf16 v[80:83], v[216:219], v[56:59], v[80:83]
    v_mfma_f32_16x16x32_bf16 v[84:87], v[216:219], v[60:63], v[84:87]
    s_waitcnt lgkmcnt(2)
    v_mfma_f32_16x16x32_bf16 v[80:83], v[220:223], v[64:67], v[80:83]
    v_mfma_f32_16x16x32_bf16 v[84:87], v[220:223], v[68:71], v[84:87]
    s_waitcnt lgkmcnt(0)
    v_mfma_f32_16x16x32_bf16 v[80:83], v[224:227], v[72:75], v[80:83]
    v_mfma_f32_16x16x32_bf16 v[84:87], v[224:227], v[76:79], v[84:87]
    s_nop 6
    v_cvt_pk_bf16_f32 v96, v80, v81
    v_cvt_pk_bf16_f32 v97, v82, v83
    v_cvt_pk_bf16_f32 v98, v84, v85
    v_cvt_pk_bf16_f32 v99, v86, v87
    s_nop 0
    v_permlane16_swap_b32 v96, v98
    v_permlane16_swap_b32 v97, v99
    buffer_store_dwordx4 v[96:99], v22, s[32:35], 0 offen sc1
    buffer_store_dword v12, v11, s[32:35], 0 offen
    s_endpgm
L_ou_vwait:
    s_add_u32 s64, s59, 2
L_ou_vf:
    buffer_load_dword v28, v7, s[32:35], 0 offen sc1
    s_waitcnt vmcnt(0)
    v_cmp_gt_u32 vcc, s64, v28
    s_cbranch_vccnz L_retry_30
L_ok_31:
    s_branch L_ou_vok
L_role_ax:
    s_sub_u32 s61, s58, 22
    s_and_b32 s62, s57, 3
    s_lshr_b32 s63, s57, 2
    s_lshl_b32 s63, s63, 1
    s_add_u32 s63, s63, s61
    s_lshl_b32 s64, s56, 17
    s_add_u32 s64, s64, 0xa000000
    s_mov_b32 s40, s12
    s_and_b32 s41, s13, 0xffff
    s_mov_b32 s42, 0x280000
    s_mov_b32 s43, 0x20000
    v_lshlrev_b32 v1, 4, v0
    v_lshrrev_b32 v14, 4, v0
    v_and_b32 v15, 15, v0
    s_mul_i32 s66, s62, 48
    s_add_u32 s66, s66, s64
    s_add_u32 s66, s66, 65792
    v_min_u32 v16, 11, v0
    v_lshl_add_u32 v2, v16, 2, s66
    s_add_u32 s66, s64, 66816
    v_and_b32 v16, 3, v0
    v_lshl_add_u32 v3, v16, 2, s66
    s_lshl_b32 s66, s63, 2
    s_add_u32 s66, s66, s62
    s_lshl_b32 s66, s66, 2
    s_add_u32 s66, s66, s64
    s_add_u32 s66, s66, 66304
    v_cmp_eq_u32 vcc, 0, v0
    v_mov_b32 v16, 0x40000000
    v_mov_b32 v17, s66
    v_cndmask_b32 v4, v16, v17, vcc
    v_add_u32 v5, 256, v4
    s_sub_u32 s66, s63, 3
    v_mov_b32 v12, s66
    buffer_store_dword v12, v4, s[32:35], 0 offen
    buffer_store_dword v12, v5, s[32:35], 0 offen
    v_and_b32 v16, 7, v0
    v_lshlrev_b32 v16, 4, v16
    v_lshl_add_u32 v6, v14, 7, v16
    s_mul_i32 s70, s57, 15360
    v_bfe_u32 v16, v0, 1, 1
    v_lshlrev_b32 v16, 8, v16
    v_lshrrev_b32 v17, 2, v0
    v_lshl_add_u32 v16, v17, 4, v16
    v_and_b32 v17, 1, v0
    v_lshl_add_u32 v16, v17, 3, v16
    v_add_u32 v7, s70, v16
    v_bfe_u32 v16, v0, 2, 3
    v_mul_u32_u24 v16, 384, v16
    v_and_b32 v17, 3, v0
    v_lshl_add_u32 v16, v17, 3, v16
    v_add_u32 v16, 12288, v16
    v_add_u32 v8, s70, v16
    v_and_b32 v16, 1, v14
    v_lshlrev_b32 v16, 10, v16
    v_lshrrev_b32 v17, 1, v14
    v_lshl_add_u32 v16, v17, 8, v16
    v_lshl_add_u32 v9, v15, 4, v16
    s_mul_i32 s66, s62, 10240
    v_lshl_add_u32 v10, v0, 7, s66
    s_add_u32 s66, s66, 8192
    v_lshrrev_b32 v16, 2, v0
    v_lshl_add_u32 v11, v16, 7, s66
    v_mov_b32 v58, 0
    v_mov_b32 v59, 0
    v_mov_b32 v66, 0
    v_mov_b32 v67, 0
    v_mov_b32 v72, 0
    v_mov_b32 v73, 0
    v_mov_b32 v78, 0
    v_mov_b32 v79, 0
    v_mov_b32 v17, 0xff800000
    v_lshl_add_u32 v16, v14, 2, 0
    v_cmp_gt_u32 vcc, v16, v15
    s_nop 1
    v_cndmask_b32 v20, 0, v17, vcc
    v_lshl_add_u32 v16, v14, 2, 1
    v_cmp_gt_u32 vcc, v16, v15
    s_nop 1
    v_cndmask_b32 v21, 0, v17, vcc
    v_lshl_add_u32 v16, v14, 2, 2
    v_cmp_gt_u32 vcc, v16, v15
    s_nop 1
    v_cndmask_b32 v22, 0, v17, vcc
    v_lshl_add_u32 v16, v14, 2, 3
    v_cmp_gt_u32 vcc, v16, v15
    s_nop 1
    v_cndmask_b32 v23, 0, v17, vcc
    v_cmp_lt_u32 vcc, 1, v14
    s_nop 1
    v_cndmask_b32 v24, 0, v17, vcc
    v_cndmask_b32 v25, 0, v17, vcc
    v_cndmask_b32 v26, 0, v17, vcc
    v_cndmask_b32 v27, 0, v17, vcc
    s_mov_b32 s52, 0x3dd53b95
    s_lshl_b32 s66, s56, 2
    s_add_u32 s66, s66, s62
    s_lshl_b32 s65, s63, 5
    s_add_u32 s66, s66, s65
    s_mul_i32 s67, s66, 12288
    s_mul_i32 s68, s66, 3072
    s_mul_i32 s69, s63, 40960
    s_mov_b32 s59, s63
    s_waitcnt vmcnt(0)
    s_barrier
    s_cmp_lg_u32 s57, 0
    s_cbranch_scc1 L_rdy_32
    s_lshl_b32 s61, s56, 4
    v_mov_b32 v16, 1
    v_mov_b32 v17, 8
    s_mov_b64 exec, 1
    buffer_atomic_add v16, v17, s[36:39], s61 offen
    s_mov_b64 exec, -1
L_rdy_32:
    s_sub_u32 s44, s58, 22
    s_mul_i32 s45, s57, 10
    s_add_u32 s44, s44, s45
    s_mul_i32 s44, s44, 98304
    s_mul_i32 s45, s56, 1536
    s_add_u32 s44, s44, s45
    s_add_u32 s44, s44, 3932160
    v_lshrrev_b32 v250, 3, v0
    v_mul_u32_u24 v250, 12288, v250
    v_bfe_u32 v251, v0, 2, 1
    s_mov_b32 s48, s16
    s_and_b32 s49, s17, 0xffff
    s_mov_b32 s50, 0x780000
    s_mov_b32 s51, 0x20000
    s_add_u32 s46, s16, s45
    s_sub_u32 s46, 0x180, s46
    s_and_b32 s46, s46, 0x380
    s_cmp_lt_u32 s46, 0x200
    s_cselect_b32 s47, 0x400, 0
    v_mad_u32_u24 v252, v251, s47, v250
    s_add_u32 s46, s46, s44
    buffer_load_dword v253, v252, s[48:51], s46 offen
    s_mov_b32 s48, s18
    s_and_b32 s49, s19, 0xffff
    s_mov_b32 s50, 0x780000
    s_mov_b32 s51, 0x20000
    s_add_u32 s46, s18, s45
    s_sub_u32 s46, 0x180, s46
    s_and_b32 s46, s46, 0x380
    s_cmp_lt_u32 s46, 0x200
    s_cselect_b32 s47, 0x400, 0
    v_mad_u32_u24 v252, v251, s47, v250
    s_add_u32 s46, s46, s44
    buffer_load_dword v253, v252, s[48:51], s46 offen
    s_mov_b32 s48, s20
    s_and_b32 s49, s21, 0xffff
    s_mov_b32 s50, 0x780000
    s_mov_b32 s51, 0x20000
    s_add_u32 s46, s20, s45
    s_sub_u32 s46, 0x180, s46
    s_and_b32 s46, s46, 0x380
    s_cmp_lt_u32 s46, 0x200
    s_cselect_b32 s47, 0x400, 0
    v_mad_u32_u24 v252, v251, s47, v250
    s_add_u32 s46, s46, s44
    buffer_load_dword v253, v252, s[48:51], s46 offen
    buffer_load_dword v16, v10, s[40:43], s69 offen
    buffer_load_dword v16, v11, s[40:43], s69 offen
    v_lshlrev_b32 v17, 7, v0
    v_lshrrev_b32 v15, 1, v0
    v_lshlrev_b32 v15, 7, v15
    s_add_u32 s65, s67, 0x3000000
    buffer_load_dword v16, v17, s[32:35], s65 offen sc1
    s_add_u32 s65, s65, 8192
    buffer_load_dword v16, v15, s[32:35], s65 offen sc1
    s_add_u32 s65, s67, 0x1800000
    buffer_load_dword v16, v17, s[32:35], s65 offen sc1
    s_add_u32 s65, s65, 8192
    buffer_load_dword v16, v15, s[32:35], s65 offen sc1
    s_add_u32 s65, s67, 0x0
    buffer_load_dword v16, v17, s[32:35], s65 offen sc1
    s_add_u32 s65, s65, 8192
    buffer_load_dword v16, v15, s[32:35], s65 offen sc1
    s_add_u32 s65, s67, 0x4800000
    buffer_load_dword v16, v17, s[32:35], s65 offen sc1
    s_add_u32 s65, s65, 8192
    buffer_load_dword v16, v15, s[32:35], s65 offen sc1
    v_cmp_gt_u32 vcc, 24, v0
    v_mov_b32 v15, 0x40000000
    s_nop 0
    v_cndmask_b32 v15, v15, v17, vcc
    s_add_u32 s65, s68, 0x6000000
    buffer_load_dword v16, v15, s[32:35], s65 offen sc1
    s_add_u32 s65, s68, 0x6600000
    buffer_load_dword v16, v15, s[32:35], s65 offen sc1
    s_cmp_lg_u32 s57, 0
    s_cbranch_scc1 L_nrdy_33
    v_mov_b32 v18, 0
    s_sleep 64
L_wrdy_34:
    buffer_load_dword v19, v18, s[36:39], 0 offen offset:252 sc1
    s_waitcnt vmcnt(0)
    v_cmp_gt_u32 vcc, 1, v19
    s_cbranch_vccnz L_retry_35
L_ok_36:
L_nrdy_33:
    s_barrier
    s_add_u32 s69, s69, 163840
    buffer_load_dword v16, v10, s[40:43], s69 offen
    buffer_load_dword v16, v11, s[40:43], s69 offen
L_ax_loop:
    s_add_u32 s66, s59, 1
    s_add_u32 s69, s69, 163840
    v_mov_b32 v12, s66
L_ax_w1:
    buffer_load_dword v16, v2, s[32:35], 0 offen sc1
    s_waitcnt vmcnt(0)
    v_cmp_gt_i32 vcc, s59, v16
    s_cbranch_vccnz L_retry_37
L_ok_38:
    s_add_u32 s65, s67, 0x0
    buffer_load_dwordx4 v[100:103], v1, s[32:35], s65 offen offset:0 sc1
    buffer_load_dwordx4 v[104:107], v1, s[32:35], s65 offen offset:1024 sc1
    buffer_load_dwordx4 v[108:111], v1, s[32:35], s65 offen offset:2048 sc1
    buffer_load_dwordx4 v[112:115], v1, s[32:35], s65 offen offset:3072 sc1
    s_add_u32 s65, s67, 0x1000
    buffer_load_dwordx4 v[116:119], v1, s[32:35], s65 offen offset:0 sc1
    buffer_load_dwordx4 v[120:123], v1, s[32:35], s65 offen offset:1024 sc1
    buffer_load_dwordx4 v[124:127], v1, s[32:35], s65 offen offset:2048 sc1
    buffer_load_dwordx4 v[128:131], v1, s[32:35], s65 offen offset:3072 sc1
    s_add_u32 s65, s67, 0x2000
    buffer_load_dwordx4 v[132:135], v1, s[32:35], s65 offen offset:0 sc1
    buffer_load_dwordx4 v[136:139], v1, s[32:35], s65 offen offset:1024 sc1
    buffer_load_dwordx4 v[140:143], v1, s[32:35], s65 offen offset:2048 sc1
    buffer_load_dwordx4 v[144:147], v1, s[32:35], s65 offen offset:3072 sc1
    s_add_u32 s65, s67, 0x1800000
    buffer_load_dwordx4 v[148:151], v1, s[32:35], s65 offen offset:0 sc1
    buffer_load_dwordx4 v[152:155], v1, s[32:35], s65 offen offset:1024 sc1
    buffer_load_dwordx4 v[156:159], v1, s[32:35], s65 offen offset:2048 sc1
    buffer_load_dwordx4 v[160:163], v1, s[32:35], s65 offen offset:3072 sc1
    s_add_u32 s65, s67, 0x1801000
    buffer_load_dwordx4 v[164:167], v1, s[32:35], s65 offen offset:0 sc1
    buffer_load_dwordx4 v[168:171], v1, s[32:35], s65 offen offset:1024 sc1
    buffer_load_dwordx4 v[172:175], v1, s[32:35], s65 offen offset:2048 sc1
    buffer_load_dwordx4 v[176:179], v1, s[32:35], s65 offen offset:3072 sc1
    s_add_u32 s65, s67, 0x1802000
    buffer_load_dwordx4 v[180:183], v1, s[32:35], s65 offen offset:0 sc1
    buffer_load_dwordx4 v[184:187], v1, s[32:35], s65 offen offset:1024 sc1
    buffer_load_dwordx4 v[188:191], v1, s[32:35], s65 offen offset:2048 sc1
    buffer_load_dwordx4 v[192:195], v1, s[32:35], s65 offen offset:3072 sc1
    s_add_u32 s65, s67, 0x3000000
    s_add_u32 m0, s70, 0
    s_nop 0
    buffer_load_dwordx4 v1, s[32:35], s65 offen offset:0 sc1 lds
    buffer_load_dwordx4 v1, s[32:35], s65 offen offset:1024 sc1 lds
    buffer_load_dwordx4 v1, s[32:35], s65 offen offset:2048 sc1 lds
    buffer_load_dwordx4 v1, s[32:35], s65 offen offset:3072 sc1 lds
    s_add_u32 s65, s67, 0x3001000
    s_add_u32 m0, s70, 4096
    s_nop 0
    buffer_load_dwordx4 v1, s[32:35], s65 offen offset:0 sc1 lds
    buffer_load_dwordx4 v1, s[32:35], s65 offen offset:1024 sc1 lds
    buffer_load_dwordx4 v1, s[32:35], s65 offen offset:2048 sc1 lds
    buffer_load_dwordx4 v1, s[32:35], s65 offen offset:3072 sc1 lds
    s_add_u32 s65, s67, 0x3002000
    s_add_u32 m0, s70, 8192
    s_nop 0
    buffer_load_dwordx4 v1, s[32:35], s65 offen offset:0 sc1 lds
    buffer_load_dwordx4 v1, s[32:35], s65 offen offset:1024 sc1 lds
    buffer_load_dwordx4 v1, s[32:35], s65 offen offset:2048 sc1 lds
    buffer_load_dwordx4 v1, s[32:35], s65 offen offset:3072 sc1 lds
    s_waitcnt vmcnt(12)
    v_mfma_f32_16x16x32_bf16 v[28:31], v[148:151], v[100:103], v[20:23]
    v_mfma_f32_16x16x32_bf16 v[36:39], v[148:151], v[104:107], 0
    v_mfma_f32_16x16x32_bf16 v[40:43], v[152:155], v[104:107], v[20:23]
    v_mfma_f32_16x16x32_bf16 v[28:31], v[156:159], v[108:111], v[28:31]
    v_mfma_f32_16x16x32_bf16 v[36:39], v[156:159], v[112:115], v[36:39]
    v_mfma_f32_16x16x32_bf16 v[40:43], v[160:163], v[112:115], v[40:43]
    v_mfma_f32_16x16x32_bf16 v[28:31], v[164:167], v[116:119], v[28:31]
    v_mfma_f32_16x16x32_bf16 v[36:39], v[164:167], v[120:123], v[36:39]
    v_mfma_f32_16x16x32_bf16 v[40:43], v[168:171], v[120:123], v[40:43]
    v_mfma_f32_16x16x32_bf16 v[28:31], v[172:175], v[124:127], v[28:31]
    v_mfma_f32_16x16x32_bf16 v[36:39], v[172:175], v[128:131], v[36:39]
    v_mfma_f32_16x16x32_bf16 v[40:43], v[176:179], v[128:131], v[40:43]
    v_mfma_f32_16x16x32_bf16 v[28:31], v[180:183], v[132:135], v[28:31]
    v_mfma_f32_16x16x32_bf16 v[36:39], v[180:183], v[136:139], v[36:39]
    v_mfma_f32_16x16x32_bf16 v[40:43], v[184:187], v[136:139], v[40:43]
    v_mfma_f32_16x16x32_bf16 v[28:31], v[188:191], v[140:143], v[28:31]
    v_mfma_f32_16x16x32_bf16 v[36:39], v[188:191], v[144:147], v[36:39]
    v_mfma_f32_16x16x32_bf16 v[40:43], v[192:195], v[144:147], v[40:43]
L_ax_w2:
    buffer_load_dword v16, v2, s[32:35], 0 offen sc1
    s_waitcnt vmcnt(0)
    v_cmp_gt_i32 vcc, s66, v16
    s_cbranch_vccnz L_retry_39
L_ok_40:
    s_add_u32 s65, s68, 0x6000000
    buffer_load_dwordx4 v[148:151], v6, s[32:35], s65 offen offset:0 sc1
    buffer_load_dwordx4 v[152:155], v6, s[32:35], s65 offen offset:512 sc1
    buffer_load_dwordx4 v[156:159], v6, s[32:35], s65 offen offset:1024 sc1
    buffer_load_dwordx4 v[160:163], v6, s[32:35], s65 offen offset:1536 sc1
    buffer_load_dwordx4 v[164:167], v6, s[32:35], s65 offen offset:2048 sc1
    buffer_load_dwordx4 v[168:171], v6, s[32:35], s65 offen offset:2560 sc1
    s_add_u32 m0, s70, 12288
    s_add_u32 s65, s68, 0x6600000
    buffer_load_dwordx4 v1, s[32:35], s65 offen offset:0 sc1 lds
    buffer_load_dwordx4 v1, s[32:35], s65 offen offset:1024 sc1 lds
    buffer_load_dwordx4 v1, s[32:35], s65 offen offset:2048 sc1 lds
    buffer_load_dword v17, v3, s[32:35], 0 offen sc1
    s_waitcnt vmcnt(9)
    v_mfma_f32_16x16x32_bf16 v[32:35], v[148:151], v[100:103], v[24:27]
    v_mfma_f32_16x16x32_bf16 v[44:47], v[148:151], v[104:107], v[24:27]
    s_waitcnt vmcnt(8)
    v_mfma_f32_16x16x32_bf16 v[32:35], v[152:155], v[108:111], v[32:35]
    v_mfma_f32_16x16x32_bf16 v[44:47], v[152:155], v[112:115], v[44:47]
    s_waitcnt vmcnt(7)
    v_mfma_f32_16x16x32_bf16 v[32:35], v[156:159], v[116:119], v[32:35]
    v_mfma_f32_16x16x32_bf16 v[44:47], v[156:159], v[120:123], v[44:47]
    s_waitcnt vmcnt(6)
    v_mfma_f32_16x16x32_bf16 v[32:35], v[160:163], v[124:127], v[32:35]
    v_mfma_f32_16x16x32_bf16 v[44:47], v[160:163], v[128:131], v[44:47]
    s_waitcnt vmcnt(5)
    v_mfma_f32_16x16x32_bf16 v[32:35], v[164:167], v[132:135], v[32:35]
    v_mfma_f32_16x16x32_bf16 v[44:47], v[164:167], v[136:139], v[44:47]
    s_waitcnt vmcnt(4)
    v_mfma_f32_16x16x32_bf16 v[32:35], v[168:171], v[140:143], v[32:35]
    v_mfma_f32_16x16x32_bf16 v[44:47], v[168:171], v[144:147], v[44:47]
    s_waitcnt vmcnt(0)
    buffer_store_dword v12, v4, s[32:35], 0 offen
    ds_read_b64_tr_b16 v[60:61], v8 offset:0
    ds_read_b64_tr_b16 v[62:63], v7 offset:0
    ds_read_b64_tr_b16 v[64:65], v7 offset:1024
    v_max3_f32 v15, v36, v37, v38
    v_max3_f32 v15, v15, v39, v40
    v_max3_f32 v15, v15, v41, v42
    v_max3_f32 v15, v15, v43, v44
    v_max3_f32 v15, v15, v45, v46
    v_max_f32 v15, v15, v47
    v_max3_f32 v14, v28, v29, v30
    v_max3_f32 v14, v14, v31, v32
    v_max3_f32 v14, v14, v33, v34
    v_max_f32 v14, v14, v35
    s_nop 1
    v_permlane32_swap_b32 v14, v15
    v_max_f32 v14, v14, v15
    v_mov_b32 v15, v14
    s_nop 1
    v_permlane16_swap_b32 v14, v15
    v_max_f32 v14, v14, v15
    v_mov_b32 v15, v14
    s_nop 1
    v_permlane32_swap_b32 v14, v15
    v_mul_f32 v14, s52, v14
    v_mul_f32 v15, s52, v15
    v_fma_f32 v28, v28, s52, -v14
    v_fma_f32 v29, v29, s52, -v14
    v_fma_f32 v30, v30, s52, -v14
    v_fma_f32 v31, v31, s52, -v14
    v_fma_f32 v32, v32, s52, -v14
    v_fma_f32 v33, v33, s52, -v14
    v_fma_f32 v34, v34, s52, -v14
    v_fma_f32 v35, v35, s52, -v14
    v_fma_f32 v36, v36, s52, -v15
    v_fma_f32 v37, v37, s52, -v15
    v_fma_f32 v38, v38, s52, -v15
    v_fma_f32 v39, v39, s52, -v15
    v_fma_f32 v40, v40, s52, -v15
    v_fma_f32 v41, v41, s52, -v15
    v_fma_f32 v42, v42, s52, -v15
    v_fma_f32 v43, v43, s52, -v15
    v_fma_f32 v44, v44, s52, -v15
    v_fma_f32 v45, v45, s52, -v15
    v_fma_f32 v46, v46, s52, -v15
    v_fma_f32 v47, v47, s52, -v15
    v_exp_f32 v28, v28
    v_exp_f32 v29, v29
    v_exp_f32 v30, v30
    v_exp_f32 v31, v31
    v_exp_f32 v32, v32
    v_exp_f32 v33, v33
    v_exp_f32 v34, v34
    v_exp_f32 v35, v35
    v_exp_f32 v36, v36
    v_exp_f32 v37, v37
    v_exp_f32 v38, v38
    v_exp_f32 v39, v39
    v_exp_f32 v40, v40
    v_exp_f32 v41, v41
    v_exp_f32 v42, v42
    v_exp_f32 v43, v43
    v_exp_f32 v44, v44
    v_exp_f32 v45, v45
    v_exp_f32 v46, v46
    v_exp_f32 v47, v47
    v_add_f32 v14, v28, v29
    v_add_f32 v14, v14, v30
    v_add_f32 v14, v14, v31
    v_add_f32 v14, v14, v32
    v_add_f32 v14, v14, v33
    v_add_f32 v14, v14, v34
    v_add_f32 v14, v14, v35
    v_add_f32 v15, v36, v37
    v_add_f32 v15, v15, v38
    v_add_f32 v15, v15, v39
    v_add_f32 v15, v15, v40
    v_add_f32 v15, v15, v41
    v_add_f32 v15, v15, v42
    v_add_f32 v15, v15, v43
    v_add_f32 v15, v15, v44
    v_add_f32 v15, v15, v45
    v_add_f32 v15, v15, v46
    v_add_f32 v15, v15, v47
    s_nop 1
    v_permlane32_swap_b32 v14, v15
    v_add_f32 v14, v14, v15
    v_mov_b32 v15, v14
    s_nop 1
    v_permlane16_swap_b32 v14, v15
    v_add_f32 v14, v14, v15
    v_mov_b32 v15, v14
    s_nop 1
    v_permlane32_swap_b32 v14, v15
    v_rcp_f32 v14, v14
    v_rcp_f32 v15, v15
    v_mul_f32 v28, v28, v14
    v_mul_f32 v29, v29, v14
    v_mul_f32 v30, v30, v14
    v_mul_f32 v31, v31, v14
    v_mul_f32 v32, v32, v14
    v_mul_f32 v33, v33, v14
    v_mul_f32 v34, v34, v14
    v_mul_f32 v35, v35, v14
    v_mul_f32 v36, v36, v15
    v_mul_f32 v37, v37, v15
    v_mul_f32 v38, v38, v15
    v_mul_f32 v39, v39, v15
    v_mul_f32 v40, v40, v15
    v_mul_f32 v41, v41, v15
    v_mul_f32 v42, v42, v15
    v_mul_f32 v43, v43, v15
    v_mul_f32 v44, v44, v15
    v_mul_f32 v45, v45, v15
    v_mul_f32 v46, v46, v15
    v_mul_f32 v47, v47, v15
    v_cvt_pk_bf16_f32 v48, v32, v33
    v_cvt_pk_bf16_f32 v49, v34, v35
    v_cvt_pk_bf16_f32 v50, v28, v29
    v_cvt_pk_bf16_f32 v51, v30, v31
    v_cvt_pk_bf16_f32 v52, v44, v45
    v_cvt_pk_bf16_f32 v53, v46, v47
    v_cvt_pk_bf16_f32 v54, v36, v37
    v_cvt_pk_bf16_f32 v55, v38, v39
    v_cvt_pk_bf16_f32 v56, v40, v41
    v_cvt_pk_bf16_f32 v57, v42, v43
    s_sub_u32 s66, s59, 3
    v_cmp_gt_i32 vcc, s66, v17
    s_cbranch_vccz L_ax_free
L_ax_w3:
    buffer_load_dword v17, v3, s[32:35], 0 offen sc1
    s_waitcnt vmcnt(0)
    v_cmp_gt_i32 vcc, s66, v17
    s_cbranch_vccnz L_retry_41
L_ok_42:
L_ax_free:
    ds_read_b64_tr_b16 v[66:67], v8 offset:32
    ds_read_b64_tr_b16 v[68:69], v7 offset:512
    ds_read_b64_tr_b16 v[70:71], v7 offset:1536
    ds_read_b64_tr_b16 v[72:73], v8 offset:64
    ds_read_b64_tr_b16 v[74:75], v7 offset:2048
    ds_read_b64_tr_b16 v[76:77], v7 offset:3072
    s_waitcnt lgkmcnt(6)
    v_mfma_f32_16x16x32_bf16 v[204:207], v[60:63], v[52:55], 0
    v_mfma_f32_16x16x32_bf16 v[200:203], v[60:63], v[48:51], 0
    v_mfma_f32_16x16x32_bf16 v[204:207], v[64:67], v[56:59], v[204:207]
    ds_read_b64_tr_b16 v[60:61], v8 offset:96
    ds_read_b64_tr_b16 v[62:63], v7 offset:2560
    ds_read_b64_tr_b16 v[64:65], v7 offset:3584
    s_waitcnt lgkmcnt(6)
    v_mfma_f32_16x16x32_bf16 v[212:215], v[66:69], v[52:55], 0
    v_mfma_f32_16x16x32_bf16 v[208:211], v[66:69], v[48:51], 0
    v_mfma_f32_16x16x32_bf16 v[212:215], v[70:73], v[56:59], v[212:215]
    ds_read_b64_tr_b16 v[66:67], v8 offset:128
    ds_read_b64_tr_b16 v[68:69], v7 offset:4096
    ds_read_b64_tr_b16 v[70:71], v7 offset:5120
    s_waitcnt lgkmcnt(6)
    v_mfma_f32_16x16x32_bf16 v[220:223], v[72:75], v[52:55], 0
    v_cvt_pk_bf16_f32 v92, v200, v201
    v_cvt_pk_bf16_f32 v94, v204, v205
    v_mfma_f32_16x16x32_bf16 v[216:219], v[72:75], v[48:51], 0
    v_cvt_pk_bf16_f32 v93, v202, v203
    v_cvt_pk_bf16_f32 v95, v206, v207
    s_add_u32 s65, s67, 0x4800000
    v_mfma_f32_16x16x32_bf16 v[220:223], v[76:79], v[56:59], v[220:223]
    v_permlane16_swap_b32 v92, v94
    v_permlane16_swap_b32 v93, v95
    buffer_store_dwordx4 v[92:95], v9, s[32:35], s65 offen offset:0
    ds_read_b64_tr_b16 v[72:73], v8 offset:160
    ds_read_b64_tr_b16 v[74:75], v7 offset:4608
    ds_read_b64_tr_b16 v[76:77], v7 offset:5632
    s_waitcnt lgkmcnt(6)
    v_mfma_f32_16x16x32_bf16 v[204:207], v[60:63], v[52:55], 0
    v_cvt_pk_bf16_f32 v96, v208, v209
    v_cvt_pk_bf16_f32 v98, v212, v213
    v_mfma_f32_16x16x32_bf16 v[200:203], v[60:63], v[48:51], 0
    v_cvt_pk_bf16_f32 v97, v210, v211
    v_cvt_pk_bf16_f32 v99, v214, v215
    s_add_u32 s65, s67, 0x4800000
    v_mfma_f32_16x16x32_bf16 v[204:207], v[64:67], v[56:59], v[204:207]
    v_permlane16_swap_b32 v96, v98
    v_permlane16_swap_b32 v97, v99
    buffer_store_dwordx4 v[96:99], v9, s[32:35], s65 offen offset:512
    ds_read_b64_tr_b16 v[60:61], v8 offset:192
    ds_read_b64_tr_b16 v[62:63], v7 offset:6144
    ds_read_b64_tr_b16 v[64:65], v7 offset:7168
    s_waitcnt lgkmcnt(6)
    v_mfma_f32_16x16x32_bf16 v[212:215], v[66:69], v[52:55], 0
    v_cvt_pk_bf16_f32 v92, v216, v217
    v_cvt_pk_bf16_f32 v94, v220, v221
    v_mfma_f32_16x16x32_bf16 v[208:211], v[66:69], v[48:51], 0
    v_cvt_pk_bf16_f32 v93, v218, v219
    v_cvt_pk_bf16_f32 v95, v222, v223
    s_add_u32 s65, s67, 0x4800000
    v_mfma_f32_16x16x32_bf16 v[212:215], v[70:73], v[56:59], v[212:215]
    v_permlane16_swap_b32 v92, v94
    v_permlane16_swap_b32 v93, v95
    buffer_store_dwordx4 v[92:95], v9, s[32:35], s65 offen offset:2048
    ds_read_b64_tr_b16 v[66:67], v8 offset:224
    ds_read_b64_tr_b16 v[68:69], v7 offset:6656
    ds_read_b64_tr_b16 v[70:71], v7 offset:7680
    s_waitcnt lgkmcnt(6)
    v_mfma_f32_16x16x32_bf16 v[220:223], v[72:75], v[52:55], 0
    v_cvt_pk_bf16_f32 v96, v200, v201
    v_cvt_pk_bf16_f32 v98, v204, v205
    v_mfma_f32_16x16x32_bf16 v[216:219], v[72:75], v[48:51], 0
    v_cvt_pk_bf16_f32 v97, v202, v203
    v_cvt_pk_bf16_f32 v99, v206, v207
    s_add_u32 s65, s67, 0x4800000
    v_mfma_f32_16x16x32_bf16 v[220:223], v[76:79], v[56:59], v[220:223]
    v_permlane16_swap_b32 v96, v98
    v_permlane16_swap_b32 v97, v99
    buffer_store_dwordx4 v[96:99], v9, s[32:35], s65 offen offset:2560
    ds_read_b64_tr_b16 v[72:73], v8 offset:256
    ds_read_b64_tr_b16 v[74:75], v7 offset:8192
    ds_read_b64_tr_b16 v[76:77], v7 offset:9216
    s_waitcnt lgkmcnt(6)
    v_mfma_f32_16x16x32_bf16 v[204:207], v[60:63], v[52:55], 0
    v_cvt_pk_bf16_f32 v92, v208, v209
    v_cvt_pk_bf16_f32 v94, v212, v213
    v_mfma_f32_16x16x32_bf16 v[200:203], v[60:63], v[48:51], 0
    v_cvt_pk_bf16_f32 v93, v210, v211
    v_cvt_pk_bf16_f32 v95, v214, v215
    s_add_u32 s65, s67, 0x4801000
    v_mfma_f32_16x16x32_bf16 v[204:207], v[64:67], v[56:59], v[204:207]
    v_permlane16_swap_b32 v92, v94
    v_permlane16_swap_b32 v93, v95
    buffer_store_dwordx4 v[92:95], v9, s[32:35], s65 offen offset:0
    ds_read_b64_tr_b16 v[60:61], v8 offset:288
    ds_read_b64_tr_b16 v[62:63], v7 offset:8704
    ds_read_b64_tr_b16 v[64:65], v7 offset:9728
    s_waitcnt lgkmcnt(6)
    v_mfma_f32_16x16x32_bf16 v[212:215], v[66:69], v[52:55], 0
    v_cvt_pk_bf16_f32 v96, v216, v217
    v_cvt_pk_bf16_f32 v98, v220, v221
    v_mfma_f32_16x16x32_bf16 v[208:211], v[66:69], v[48:51], 0
    v_cvt_pk_bf16_f32 v97, v218, v219
    v_cvt_pk_bf16_f32 v99, v222, v223
    s_add_u32 s65, s67, 0x4801000
    v_mfma_f32_16x16x32_bf16 v[212:215], v[70:73], v[56:59], v[212:215]
    v_permlane16_swap_b32 v96, v98
    v_permlane16_swap_b32 v97, v99
    buffer_store_dwordx4 v[96:99], v9, s[32:35], s65 offen offset:512
    ds_read_b64_tr_b16 v[66:67], v8 offset:320
    ds_read_b64_tr_b16 v[68:69], v7 offset:10240
    ds_read_b64_tr_b16 v[70:71], v7 offset:11264
    s_waitcnt lgkmcnt(6)
    v_mfma_f32_16x16x32_bf16 v[220:223], v[72:75], v[52:55], 0
    v_cvt_pk_bf16_f32 v92, v200, v201
    v_cvt_pk_bf16_f32 v94, v204, v205
    v_mfma_f32_16x16x32_bf16 v[216:219], v[72:75], v[48:51], 0
    v_cvt_pk_bf16_f32 v93, v202, v203
    v_cvt_pk_bf16_f32 v95, v206, v207
    s_add_u32 s65, s67, 0x4801000
    v_mfma_f32_16x16x32_bf16 v[220:223], v[76:79], v[56:59], v[220:223]
    v_permlane16_swap_b32 v92, v94
    v_permlane16_swap_b32 v93, v95
    buffer_store_dwordx4 v[92:95], v9, s[32:35], s65 offen offset:2048
    ds_read_b64_tr_b16 v[72:73], v8 offset:352
    ds_read_b64_tr_b16 v[74:75], v7 offset:10752
    ds_read_b64_tr_b16 v[76:77], v7 offset:11776
    s_waitcnt lgkmcnt(6)
    v_mfma_f32_16x16x32_bf16 v[204:207], v[60:63], v[52:55], 0
    v_cvt_pk_bf16_f32 v96, v208, v209
    v_cvt_pk_bf16_f32 v98, v212, v213
    v_mfma_f32_16x16x32_bf16 v[200:203], v[60:63], v[48:51], 0
    v_cvt_pk_bf16_f32 v97, v210, v211
    v_cvt_pk_bf16_f32 v99, v214, v215
    s_add_u32 s65, s67, 0x4801000
    v_mfma_f32_16x16x32_bf16 v[204:207], v[64:67], v[56:59], v[204:207]
    v_permlane16_swap_b32 v96, v98
    v_permlane16_swap_b32 v97, v99
    buffer_store_dwordx4 v[96:99], v9, s[32:35], s65 offen offset:2560
    s_waitcnt lgkmcnt(3)
    v_mfma_f32_16x16x32_bf16 v[212:215], v[66:69], v[52:55], 0
    v_cvt_pk_bf16_f32 v92, v216, v217
    v_cvt_pk_bf16_f32 v94, v220, v221
    v_mfma_f32_16x16x32_bf16 v[208:211], v[66:69], v[48:51], 0
    v_cvt_pk_bf16_f32 v93, v218, v219
    v_cvt_pk_bf16_f32 v95, v222, v223
    s_add_u32 s65, s67, 0x4802000
    v_mfma_f32_16x16x32_bf16 v[212:215], v[70:73], v[56:59], v[212:215]
    v_permlane16_swap_b32 v92, v94
    v_permlane16_swap_b32 v93, v95
    buffer_store_dwordx4 v[92:95], v9, s[32:35], s65 offen offset:0
    s_waitcnt lgkmcnt(0)
    v_mfma_f32_16x16x32_bf16 v[220:223], v[72:75], v[52:55], 0
    v_cvt_pk_bf16_f32 v96, v200, v201
    v_cvt_pk_bf16_f32 v98, v204, v205
    v_mfma_f32_16x16x32_bf16 v[216:219], v[72:75], v[48:51], 0
    v_cvt_pk_bf16_f32 v97, v202, v203
    v_cvt_pk_bf16_f32 v99, v206, v207
    s_add_u32 s65, s67, 0x4802000
    v_mfma_f32_16x16x32_bf16 v[220:223], v[76:79], v[56:59], v[220:223]
    v_permlane16_swap_b32 v96, v98
    v_permlane16_swap_b32 v97, v99
    buffer_store_dwordx4 v[96:99], v9, s[32:35], s65 offen offset:512
    v_cvt_pk_bf16_f32 v92, v208, v209
    v_cvt_pk_bf16_f32 v94, v212, v213
    v_cvt_pk_bf16_f32 v93, v210, v211
    v_cvt_pk_bf16_f32 v95, v214, v215
    s_add_u32 s65, s67, 0x4802000
    v_permlane16_swap_b32 v92, v94
    v_permlane16_swap_b32 v93, v95
    buffer_store_dwordx4 v[92:95], v9, s[32:35], s65 offen offset:2048
    v_cvt_pk_bf16_f32 v96, v216, v217
    v_cvt_pk_bf16_f32 v98, v220, v221
    v_cvt_pk_bf16_f32 v97, v218, v219
    v_cvt_pk_bf16_f32 v99, v222, v223
    s_add_u32 s65, s67, 0x4802000
    v_permlane16_swap_b32 v96, v98
    v_permlane16_swap_b32 v97, v99
    buffer_store_dwordx4 v[96:99], v9, s[32:35], s65 offen offset:2560
    s_add_u32 s59, s59, 4
    s_waitcnt vmcnt(0)
    buffer_store_dword v12, v5, s[32:35], 0 offen
    buffer_load_dword v16, v10, s[40:43], s69 offen
    buffer_load_dword v16, v11, s[40:43], s69 offen
    s_cmp_lt_u32 s59, 64
    s_cbranch_scc1 L_ax_loop
    s_endpgm
L_role_ox:
    s_sub_u32 s62, s58, 24
    s_lshl_b32 s63, s56, 17
    s_add_u32 s63, s63, 0xa000000
    s_mov_b32 s40, s22
    s_and_b32 s41, s23, 0xffff
    s_mov_b32 s42, 0x780000
    s_mov_b32 s43, 0x20000
    v_lshlrev_b32 v1, 4, v0
    s_add_u32 s65, s63, 66560
    v_and_b32 v15, 3, v0
    v_lshl_add_u32 v2, v15, 2, s65
    s_lshl_b32 s65, s62, 2
    s_add_u32 s65, s65, s63
    s_add_u32 s65, s65, 66816
    s_cmp_eq_u32 s57, 4
    s_cselect_b32 s65, s65, 0x40000000
    v_cmp_eq_u32 vcc, 0, v0
    v_mov_b32 v15, 0x40000000
    v_mov_b32 v16, s65
    v_cndmask_b32 v3, v15, v16, vcc
    s_lshl_b32 s65, s62, 10
    s_add_u32 s65, s65, 0xa100000
    s_lshl_b32 s64, s56, 7
    s_add_u32 s65, s65, s64
    s_cmp_eq_u32 s57, 4
    s_cselect_b32 s65, s65, 0x40000000
    v_cmp_eq_u32 vcc, 0, v0
    v_mov_b32 v15, 0x40000000
    v_mov_b32 v16, s65
    v_cndmask_b32 v4, v15, v16, vcc
    v_mov_b32 v10, 0
    buffer_store_dword v10, v3, s[32:35], 0 offen
    buffer_store_dword v10, v3, s[32:35], 0 offen offset:16
    buffer_store_dword v10, v4, s[32:35], 0 offen sc1
    v_lshrrev_b32 v13, 4, v0
    v_bfe_u32 v15, v0, 2, 2
    v_mul_u32_u24 v15, 10240, v15
    v_lshrrev_b32 v16, 1, v13
    v_lshl_add_u32 v15, v16, 6, v15
    v_and_b32 v16, 3, v0
    v_lshl_add_u32 v15, v16, 4, v15
    v_and_b32 v16, 1, v13
    v_mul_u32_u24 v14, 40960, v16
    s_mul_i32 s65, s56, 1280
    s_lshl_b32 s64, s57, 7
    s_add_u32 s64, s64, s65
    v_add3_u32 v6, s64, v15, v14
    s_lshr_b32 s64, s57, 1
    s_lshl_b32 s64, s64, 7
    s_add_u32 s65, s65, s64
    s_and_b32 s64, s57, 1
    s_mul_i32 s64, s64, 40960
    s_add_u32 s65, s65, s64
    s_add_u32 s65, s65, 1024
    v_lshl_add_u32 v15, v16, 3, v15
    v_add_u32 v7, s65, v15
    s_mul_i32 s64, s62, 320
    v_lshrrev_b32 v14, 3, v0
    v_and_b32 v15, 2, v14
    s_and_b32 s65, s57, 1
    s_lshl_b32 s65, s65, 2
    v_or_b32 v15, s65, v15
    v_and_b32 v16, 7, v0
    v_xor_b32 v15, v15, v16
    v_lshlrev_b32 v15, 4, v15
    s_mul_i32 s65, s56, 768
    s_lshl_b32 s70, s57, 3
    s_add_u32 s65, s65, s70
    v_add_u32 v14, s65, v14
    v_mul_u32_u24 v14, 1280, v14
    v_add3_u32 v11, v14, v15, s64
    v_bfe_u32 v14, v0, 2, 2
    v_and_b32 v15, 2, v14
    v_and_b32 v16, 1, v13
    v_lshl_or_b32 v15, v16, 2, v15
    v_bfe_u32 v16, v0, 1, 1
    v_or_b32 v15, v15, v16
    v_lshlrev_b32 v15, 4, v15
    v_lshl_add_u32 v15, v13, 10, v15
    v_lshl_add_u32 v15, v14, 7, v15
    v_and_b32 v16, 1, v0
    v_lshl_add_u32 v12, v16, 3, v15
    s_waitcnt vmcnt(0)
    s_barrier
    s_cmp_lg_u32 s57, 0
    s_cbranch_scc1 L_rdy_43
    s_lshl_b32 s61, s56, 4
    v_mov_b32 v13, 1
    v_mov_b32 v14, 8
    s_mov_b64 exec, 1
    buffer_atomic_add v13, v14, s[36:39], s61 offen
    s_mov_b64 exec, -1
L_rdy_43:
    s_sub_u32 s44, s58, 22
    s_mul_i32 s45, s57, 10
    s_add_u32 s44, s44, s45
    s_mul_i32 s44, s44, 98304
    s_mul_i32 s45, s56, 1536
    s_add_u32 s44, s44, s45
    s_add_u32 s44, s44, 3932160
    v_lshrrev_b32 v250, 3, v0
    v_mul_u32_u24 v250, 12288, v250
    v_bfe_u32 v251, v0, 2, 1
    s_mov_b32 s48, s16
    s_and_b32 s49, s17, 0xffff
    s_mov_b32 s50, 0x780000
    s_mov_b32 s51, 0x20000
    s_add_u32 s46, s16, s45
    s_sub_u32 s46, 0x180, s46
    s_and_b32 s46, s46, 0x380
    s_cmp_lt_u32 s46, 0x200
    s_cselect_b32 s47, 0x400, 0
    v_mad_u32_u24 v252, v251, s47, v250
    s_add_u32 s46, s46, s44
    buffer_load_dword v253, v252, s[48:51], s46 offen
    s_mov_b32 s48, s18
    s_and_b32 s49, s19, 0xffff
    s_mov_b32 s50, 0x780000
    s_mov_b32 s51, 0x20000
    s_add_u32 s46, s18, s45
    s_sub_u32 s46, 0x180, s46
    s_and_b32 s46, s46, 0x380
    s_cmp_lt_u32 s46, 0x200
    s_cselect_b32 s47, 0x400, 0
    v_mad_u32_u24 v252, v251, s47, v250
    s_add_u32 s46, s46, s44
    buffer_load_dword v253, v252, s[48:51], s46 offen
    s_mov_b32 s48, s20
    s_and_b32 s49, s21, 0xffff
    s_mov_b32 s50, 0x780000
    s_mov_b32 s51, 0x20000
    s_add_u32 s46, s20, s45
    s_sub_u32 s46, 0x180, s46
    s_and_b32 s46, s46, 0x380
    s_cmp_lt_u32 s46, 0x200
    s_cselect_b32 s47, 0x400, 0
    v_mad_u32_u24 v252, v251, s47, v250
    s_add_u32 s46, s46, s44
    buffer_load_dword v253, v252, s[48:51], s46 offen
    s_cmp_lg_u32 s57, 0
    s_cbranch_scc1 L_nrdy_44
    v_mov_b32 v13, 0
    s_sleep 64
L_wrdy_45:
    buffer_load_dword v14, v13, s[36:39], 0 offen offset:252 sc1
    s_waitcnt vmcnt(0)
    v_cmp_gt_u32 vcc, 1, v14
    s_cbranch_vccnz L_retry_46
L_ok_47:
    s_lshl_b32 s61, s56, 17
    s_add_u32 s61, s61, 0xa010000
    v_min_u32 v13, 47, v0
    v_lshl_add_u32 v13, v13, 2, s61
L_wrdy_45v:
    buffer_load_dword v14, v13, s[32:35], 0 offen sc1
    s_waitcnt vmcnt(0)
    v_cmp_gt_u32 vcc, 1, v14
    s_cbranch_vccnz L_retry_48
L_ok_49:
L_nrdy_44:
    s_barrier
    s_lshl_b32 s70, s57, 10
    s_add_u32 m0, s70, 0
    s_mov_b32 s65, 0
    buffer_load_dwordx4 v11, s[40:43], s65 offen nt lds
    s_add_u32 m0, s70, 8192
    s_mov_b32 s65, 81920
    buffer_load_dwordx4 v11, s[40:43], s65 offen nt lds
    s_add_u32 m0, s70, 16384
    s_mov_b32 s65, 163840
    buffer_load_dwordx4 v11, s[40:43], s65 offen nt lds
    s_add_u32 m0, s70, 24576
    s_mov_b32 s65, 245760
    buffer_load_dwordx4 v11, s[40:43], s65 offen nt lds
    s_add_u32 m0, s70, 32768
    s_mov_b32 s65, 327680
    buffer_load_dwordx4 v11, s[40:43], s65 offen nt lds
    s_add_u32 m0, s70, 40960
    s_mov_b32 s65, 409600
    buffer_load_dwordx4 v11, s[40:43], s65 offen nt lds
    s_add_u32 m0, s70, 49152
    s_mov_b32 s65, 491520
    buffer_load_dwordx4 v11, s[40:43], s65 offen nt lds
    s_add_u32 m0, s70, 57344
    s_mov_b32 s65, 573440
    buffer_load_dwordx4 v11, s[40:43], s65 offen nt lds
    s_add_u32 m0, s70, 65536
    s_mov_b32 s65, 655360
    buffer_load_dwordx4 v11, s[40:43], s65 offen nt lds
    s_add_u32 m0, s70, 73728
    s_mov_b32 s65, 737280
    buffer_load_dwordx4 v11, s[40:43], s65 offen nt lds
    s_add_u32 m0, s70, 81920
    s_mov_b32 s65, 819200
    buffer_load_dwordx4 v11, s[40:43], s65 offen nt lds
    s_add_u32 m0, s70, 90112
    s_mov_b32 s65, 901120
    buffer_load_dwordx4 v11, s[40:43], s65 offen nt lds
    s_waitcnt vmcnt(0)
    s_barrier
    s_cmp_ge_u32 s57, 4
    s_cbranch_scc1 L_ox_p0
    s_and_b32 s65, s57, 3
    s_lshl_b32 s65, s65, 5
    v_xor_b32 v13, s65, v12
    ds_read_b64_tr_b16 v[64:65], v13 offset:0
    ds_read_b64_tr_b16 v[66:67], v13 offset:512
    ds_read_b64_tr_b16 v[68:69], v13 offset:4096
    ds_read_b64_tr_b16 v[70:71], v13 offset:4608
    ds_read_b64_tr_b16 v[72:73], v13 offset:8192
    ds_read_b64_tr_b16 v[74:75], v13 offset:8704
    ds_read_b64_tr_b16 v[76:77], v13 offset:12288
    ds_read_b64_tr_b16 v[78:79], v13 offset:12800
    s_waitcnt lgkmcnt(4)
    ds_read_b64_tr_b16 v[80:81], v13 offset:16384
    ds_read_b64_tr_b16 v[82:83], v13 offset:16896
    ds_read_b64_tr_b16 v[84:85], v13 offset:20480
    ds_read_b64_tr_b16 v[86:87], v13 offset:20992
    ds_read_b64_tr_b16 v[88:89], v13 offset:24576
    ds_read_b64_tr_b16 v[90:91], v13 offset:25088
    ds_read_b64_tr_b16 v[92:93], v13 offset:28672
    ds_read_b64_tr_b16 v[94:95], v13 offset:29184
    s_waitcnt lgkmcnt(4)
    ds_read_b64_tr_b16 v[96:97], v13 offset:32768
    ds_read_b64_tr_b16 v[98:99], v13 offset:33280
    ds_read_b64_tr_b16 v[100:101], v13 offset:36864
    ds_read_b64_tr_b16 v[102:103], v13 offset:37376
    ds_read_b64_tr_b16 v[104:105], v13 offset:40960
    ds_read_b64_tr_b16 v[106:107], v13 offset:41472
    ds_read_b64_tr_b16 v[108:109], v13 offset:45056
    ds_read_b64_tr_b16 v[110:111], v13 offset:45568
    s_waitcnt lgkmcnt(4)
    v_add_u32 v13, 49152, v13
    ds_read_b64_tr_b16 v[112:113], v13 offset:0
    ds_read_b64_tr_b16 v[114:115], v13 offset:512
    ds_read_b64_tr_b16 v[116:117], v13 offset:4096
    ds_read_b64_tr_b16 v[118:119], v13 offset:4608
    ds_read_b64_tr_b16 v[120:121], v13 offset:8192
    ds_read_b64_tr_b16 v[122:123], v13 offset:8704
    ds_read_b64_tr_b16 v[124:125], v13 offset:12288
    ds_read_b64_tr_b16 v[126:127], v13 offset:12800
    s_waitcnt lgkmcnt(4)
    ds_read_b64_tr_b16 v[128:129], v13 offset:16384
    ds_read_b64_tr_b16 v[130:131], v13 offset:16896
    ds_read_b64_tr_b16 v[132:133], v13 offset:20480
    ds_read_b64_tr_b16 v[134:135], v13 offset:20992
    ds_read_b64_tr_b16 v[136:137], v13 offset:24576
    ds_read_b64_tr_b16 v[138:139], v13 offset:25088
    ds_read_b64_tr_b16 v[140:141], v13 offset:28672
    ds_read_b64_tr_b16 v[142:143], v13 offset:29184
    s_waitcnt lgkmcnt(4)
    ds_read_b64_tr_b16 v[144:145], v13 offset:32768
    ds_read_b64_tr_b16 v[146:147], v13 offset:33280
    ds_read_b64_tr_b16 v[148:149], v13 offset:36864
    ds_read_b64_tr_b16 v[150:151], v13 offset:37376
    ds_read_b64_tr_b16 v[152:153], v13 offset:40960
    ds_read_b64_tr_b16 v[154:155], v13 offset:41472
    ds_read_b64_tr_b16 v[156:157], v13 offset:45056
    ds_read_b64_tr_b16 v[158:159], v13 offset:45568
    s_waitcnt lgkmcnt(4)
    s_waitcnt lgkmcnt(0)
L_ox_p0:
    s_barrier
    s_add_u32 m0, s70, 0
    s_mov_b32 s65, 128
    buffer_load_dwordx4 v11, s[40:43], s65 offen nt lds
    s_add_u32 m0, s70, 8192
    s_mov_b32 s65, 82048
    buffer_load_dwordx4 v11, s[40:43], s65 offen nt lds
    s_add_u32 m0, s70, 16384
    s_mov_b32 s65, 163968
    buffer_load_dwordx4 v11, s[40:43], s65 offen nt lds
    s_add_u32 m0, s70, 24576
    s_mov_b32 s65, 245888
    buffer_load_dwordx4 v11, s[40:43], s65 offen nt lds
    s_add_u32 m0, s70, 32768
    s_mov_b32 s65, 327808
    buffer_load_dwordx4 v11, s[40:43], s65 offen nt lds
    s_add_u32 m0, s70, 40960
    s_mov_b32 s65, 409728
    buffer_load_dwordx4 v11, s[40:43], s65 offen nt lds
    s_add_u32 m0, s70, 49152
    s_mov_b32 s65, 491648
    buffer_load_dwordx4 v11, s[40:43], s65 offen nt lds
    s_add_u32 m0, s70, 57344
    s_mov_b32 s65, 573568
    buffer_load_dwordx4 v11, s[40:43], s65 offen nt lds
    s_add_u32 m0, s70, 65536
    s_mov_b32 s65, 655488
    buffer_load_dwordx4 v11, s[40:43], s65 offen nt lds
    s_add_u32 m0, s70, 73728
    s_mov_b32 s65, 737408
    buffer_load_dwordx4 v11, s[40:43], s65 offen nt lds
    s_add_u32 m0, s70, 81920
    s_mov_b32 s65, 819328
    buffer_load_dwordx4 v11, s[40:43], s65 offen nt lds
    s_add_u32 m0, s70, 90112
    s_mov_b32 s65, 901248
    buffer_load_dwordx4 v11, s[40:43], s65 offen nt lds
    s_waitcnt vmcnt(0)
    s_barrier
    s_cmp_lt_u32 s57, 4
    s_cbranch_scc1 L_ox_p1
    s_and_b32 s65, s57, 3
    s_lshl_b32 s65, s65, 5
    v_xor_b32 v13, s65, v12
    ds_read_b64_tr_b16 v[64:65], v13 offset:0
    ds_read_b64_tr_b16 v[66:67], v13 offset:512
    ds_read_b64_tr_b16 v[68:69], v13 offset:4096
    ds_read_b64_tr_b16 v[70:71], v13 offset:4608
    ds_read_b64_tr_b16 v[72:73], v13 offset:8192
    ds_read_b64_tr_b16 v[74:75], v13 offset:8704
    ds_read_b64_tr_b16 v[76:77], v13 offset:12288
    ds_read_b64_tr_b16 v[78:79], v13 offset:12800
    s_waitcnt lgkmcnt(4)
    ds_read_b64_tr_b16 v[80:81], v13 offset:16384
    ds_read_b64_tr_b16 v[82:83], v13 offset:16896
    ds_read_b64_tr_b16 v[84:85], v13 offset:20480
    ds_read_b64_tr_b16 v[86:87], v13 offset:20992
    ds_read_b64_tr_b16 v[88:89], v13 offset:24576
    ds_read_b64_tr_b16 v[90:91], v13 offset:25088
    ds_read_b64_tr_b16 v[92:93], v13 offset:28672
    ds_read_b64_tr_b16 v[94:95], v13 offset:29184
    s_waitcnt lgkmcnt(4)
    ds_read_b64_tr_b16 v[96:97], v13 offset:32768
    ds_read_b64_tr_b16 v[98:99], v13 offset:33280
    ds_read_b64_tr_b16 v[100:101], v13 offset:36864
    ds_read_b64_tr_b16 v[102:103], v13 offset:37376
    ds_read_b64_tr_b16 v[104:105], v13 offset:40960
    ds_read_b64_tr_b16 v[106:107], v13 offset:41472
    ds_read_b64_tr_b16 v[108:109], v13 offset:45056
    ds_read_b64_tr_b16 v[110:111], v13 offset:45568
    s_waitcnt lgkmcnt(4)
    v_add_u32 v13, 49152, v13
    ds_read_b64_tr_b16 v[112:113], v13 offset:0
    ds_read_b64_tr_b16 v[114:115], v13 offset:512
    ds_read_b64_tr_b16 v[116:117], v13 offset:4096
    ds_read_b64_tr_b16 v[118:119], v13 offset:4608
    ds_read_b64_tr_b16 v[120:121], v13 offset:8192
    ds_read_b64_tr_b16 v[122:123], v13 offset:8704
    ds_read_b64_tr_b16 v[124:125], v13 offset:12288
    ds_read_b64_tr_b16 v[126:127], v13 offset:12800
    s_waitcnt lgkmcnt(4)
    ds_read_b64_tr_b16 v[128:129], v13 offset:16384
    ds_read_b64_tr_b16 v[130:131], v13 offset:16896
    ds_read_b64_tr_b16 v[132:133], v13 offset:20480
    ds_read_b64_tr_b16 v[134:135], v13 offset:20992
    ds_read_b64_tr_b16 v[136:137], v13 offset:24576
    ds_read_b64_tr_b16 v[138:139], v13 offset:25088
    ds_read_b64_tr_b16 v[140:141], v13 offset:28672
    ds_read_b64_tr_b16 v[142:143], v13 offset:29184
    s_waitcnt lgkmcnt(4)
    ds_read_b64_tr_b16 v[144:145], v13 offset:32768
    ds_read_b64_tr_b16 v[146:147], v13 offset:33280
    ds_read_b64_tr_b16 v[148:149], v13 offset:36864
    ds_read_b64_tr_b16 v[150:151], v13 offset:37376
    ds_read_b64_tr_b16 v[152:153], v13 offset:40960
    ds_read_b64_tr_b16 v[154:155], v13 offset:41472
    ds_read_b64_tr_b16 v[156:157], v13 offset:45056
    ds_read_b64_tr_b16 v[158:159], v13 offset:45568
    s_waitcnt lgkmcnt(4)
    s_waitcnt lgkmcnt(0)
L_ox_p1:
    s_barrier
    s_add_u32 m0, s70, 0
    s_mov_b32 s65, 192
    buffer_load_dwordx4 v11, s[40:43], s65 offen nt lds
    s_add_u32 m0, s70, 8192
    s_mov_b32 s65, 82112
    buffer_load_dwordx4 v11, s[40:43], s65 offen nt lds
    s_add_u32 m0, s70, 16384
    s_mov_b32 s65, 164032
    buffer_load_dwordx4 v11, s[40:43], s65 offen nt lds
    s_add_u32 m0, s70, 24576
    s_mov_b32 s65, 245952
    buffer_load_dwordx4 v11, s[40:43], s65 offen nt lds
    s_add_u32 m0, s70, 32768
    s_mov_b32 s65, 327872
    buffer_load_dwordx4 v11, s[40:43], s65 offen nt lds
    s_add_u32 m0, s70, 40960
    s_mov_b32 s65, 409792
    buffer_load_dwordx4 v11, s[40:43], s65 offen nt lds
    s_add_u32 m0, s70, 49152
    s_mov_b32 s65, 491712
    buffer_load_dwordx4 v11, s[40:43], s65 offen nt lds
    s_add_u32 m0, s70, 57344
    s_mov_b32 s65, 573632
    buffer_load_dwordx4 v11, s[40:43], s65 offen nt lds
    s_add_u32 m0, s70, 65536
    s_mov_b32 s65, 655552
    buffer_load_dwordx4 v11, s[40:43], s65 offen nt lds
    s_add_u32 m0, s70, 73728
    s_mov_b32 s65, 737472
    buffer_load_dwordx4 v11, s[40:43], s65 offen nt lds
    s_add_u32 m0, s70, 81920
    s_mov_b32 s65, 819392
    buffer_load_dwordx4 v11, s[40:43], s65 offen nt lds
    s_add_u32 m0, s70, 90112
    s_mov_b32 s65, 901312
    buffer_load_dwordx4 v11, s[40:43], s65 offen nt lds
    s_waitcnt vmcnt(0)
    s_barrier
    s_cmp_ge_u32 s57, 4
    s_cbranch_scc1 L_ox_p2
    s_lshr_b32 s65, s57, 1
    s_add_u32 s65, s65, 2
    s_lshl_b32 s65, s65, 5
    v_xor_b32 v13, s65, v12
    ds_read_b64_tr_b16 v[160:161], v13 offset:0
    ds_read_b64_tr_b16 v[162:163], v13 offset:512
    ds_read_b64_tr_b16 v[164:165], v13 offset:4096
    ds_read_b64_tr_b16 v[166:167], v13 offset:4608
    ds_read_b64_tr_b16 v[168:169], v13 offset:8192
    ds_read_b64_tr_b16 v[170:171], v13 offset:8704
    ds_read_b64_tr_b16 v[172:173], v13 offset:12288
    ds_read_b64_tr_b16 v[174:175], v13 offset:12800
    s_waitcnt lgkmcnt(4)
    ds_read_b64_tr_b16 v[176:177], v13 offset:16384
    ds_read_b64_tr_b16 v[178:179], v13 offset:16896
    ds_read_b64_tr_b16 v[180:181], v13 offset:20480
    ds_read_b64_tr_b16 v[182:183], v13 offset:20992
    ds_read_b64_tr_b16 v[184:185], v13 offset:24576
    ds_read_b64_tr_b16 v[186:187], v13 offset:25088
    ds_read_b64_tr_b16 v[188:189], v13 offset:28672
    ds_read_b64_tr_b16 v[190:191], v13 offset:29184
    s_waitcnt lgkmcnt(4)
    ds_read_b64_tr_b16 v[192:193], v13 offset:32768
    ds_read_b64_tr_b16 v[194:195], v13 offset:33280
    ds_read_b64_tr_b16 v[196:197], v13 offset:36864
    ds_read_b64_tr_b16 v[198:199], v13 offset:37376
    ds_read_b64_tr_b16 v[200:201], v13 offset:40960
    ds_read_b64_tr_b16 v[202:203], v13 offset:41472
    ds_read_b64_tr_b16 v[204:205], v13 offset:45056
    ds_read_b64_tr_b16 v[206:207], v13 offset:45568
    s_waitcnt lgkmcnt(4)
    v_add_u32 v13, 49152, v13
    ds_read_b64_tr_b16 v[208:209], v13 offset:0
    ds_read_b64_tr_b16 v[210:211], v13 offset:512
    ds_read_b64_tr_b16 v[212:213], v13 offset:4096
    ds_read_b64_tr_b16 v[214:215], v13 offset:4608
    ds_read_b64_tr_b16 v[216:217], v13 offset:8192
    ds_read_b64_tr_b16 v[218:219], v13 offset:8704
    ds_read_b64_tr_b16 v[220:221], v13 offset:12288
    ds_read_b64_tr_b16 v[222:223], v13 offset:12800
    s_waitcnt lgkmcnt(4)
    ds_read_b64_tr_b16 v[224:225], v13 offset:16384
    ds_read_b64_tr_b16 v[226:227], v13 offset:16896
    ds_read_b64_tr_b16 v[228:229], v13 offset:20480
    ds_read_b64_tr_b16 v[230:231], v13 offset:20992
    ds_read_b64_tr_b16 v[232:233], v13 offset:24576
    ds_read_b64_tr_b16 v[234:235], v13 offset:25088
    ds_read_b64_tr_b16 v[236:237], v13 offset:28672
    ds_read_b64_tr_b16 v[238:239], v13 offset:29184
    s_waitcnt lgkmcnt(4)
    ds_read_b64_tr_b16 v[240:241], v13 offset:32768
    ds_read_b64_tr_b16 v[242:243], v13 offset:33280
    ds_read_b64_tr_b16 v[244:245], v13 offset:36864
    ds_read_b64_tr_b16 v[246:247], v13 offset:37376
    ds_read_b64_tr_b16 v[248:249], v13 offset:40960
    ds_read_b64_tr_b16 v[250:251], v13 offset:41472
    ds_read_b64_tr_b16 v[252:253], v13 offset:45056
    ds_read_b64_tr_b16 v[254:255], v13 offset:45568
    s_waitcnt lgkmcnt(4)
    s_waitcnt lgkmcnt(0)
L_ox_p2:
    s_barrier
    s_mul_i32 s70, s57, 3072
    s_mul_i32 s66, s56, 49152
    s_add_u32 s66, s66, s70
    s_add_u32 s66, s66, 0x4800000
    s_mul_i32 s67, s62, 81920
    s_add_u32 s67, s67, 0x6c00000
    s_mov_b32 s59, 0
    s_cmp_ge_u32 s57, 4
    s_cbranch_scc1 L_ox_b
    s_bitcmp1_b32 s57, 0
    s_cbranch_scc1 L_ox_a1
L_ox_loopa0:
    s_barrier
    s_add_u32 m0, s70, 0
    s_add_u32 s64, s66, 0
    buffer_load_dwordx4 v1, s[32:35], s64 offen offset:0 sc1 lds
    buffer_load_dwordx4 v1, s[32:35], s64 offen offset:1024 sc1 lds
    buffer_load_dwordx4 v1, s[32:35], s64 offen offset:2048 sc1 lds
    s_add_u32 m0, s70, 24576
    s_add_u32 s64, s66, 24576
    buffer_load_dwordx4 v1, s[32:35], s64 offen offset:0 sc1 lds
    buffer_load_dwordx4 v1, s[32:35], s64 offen offset:1024 sc1 lds
    buffer_load_dwordx4 v1, s[32:35], s64 offen offset:2048 sc1 lds
    s_add_u32 s66, s66, 393216
    s_cmp_ge_u32 s66, 0x4980000
    s_cselect_b32 vcc_lo, 1572864, 0
    s_sub_u32 s66, s66, vcc_lo
    s_waitcnt vmcnt(3)
    s_barrier
    ds_read_b128 v[20:23], v1 offset:0
    ds_read_b128 v[24:27], v1 offset:1024
    ds_read_b128 v[28:31], v1 offset:2048
    ds_read_b128 v[32:35], v1 offset:3072
    ds_read_b128 v[36:39], v1 offset:4096
    ds_read_b128 v[40:43], v1 offset:5120
    s_cmp_eq_u32 s59, 0
    s_cbranch_scc1 L_ox_nsa0
    buffer_store_dwordx4 v[52:55], v6, s[32:35], s67 offen sc1
    buffer_store_dwordx2 v[56:57], v7, s[32:35], s67 offen sc1
    s_add_u32 s67, s67, 327680
L_ox_nsa0:
    s_waitcnt lgkmcnt(4)
    v_mfma_f32_16x16x32_bf16 v[52:55], v[64:67], v[20:23], 0
    v_mfma_f32_16x16x32_bf16 v[60:63], v[160:163], v[20:23], 0
    ds_read_b128 v[44:47], v1 offset:6144
    v_mfma_f32_16x16x32_bf16 v[56:59], v[64:67], v[24:27], 0
    ds_read_b128 v[48:51], v1 offset:7168
    s_waitcnt lgkmcnt(4)
    v_mfma_f32_16x16x32_bf16 v[52:55], v[68:71], v[28:31], v[52:55]
    v_mfma_f32_16x16x32_bf16 v[60:63], v[164:167], v[28:31], v[60:63]
    ds_read_b128 v[20:23], v1 offset:8192
    v_mfma_f32_16x16x32_bf16 v[56:59], v[68:71], v[32:35], v[56:59]
    ds_read_b128 v[24:27], v1 offset:9216
    s_waitcnt lgkmcnt(4)
    v_mfma_f32_16x16x32_bf16 v[52:55], v[72:75], v[36:39], v[52:55]
    v_mfma_f32_16x16x32_bf16 v[60:63], v[168:171], v[36:39], v[60:63]
    ds_read_b128 v[28:31], v1 offset:10240
    v_mfma_f32_16x16x32_bf16 v[56:59], v[72:75], v[40:43], v[56:59]
    ds_read_b128 v[32:35], v1 offset:11264
    s_waitcnt lgkmcnt(4)
    v_mfma_f32_16x16x32_bf16 v[52:55], v[76:79], v[44:47], v[52:55]
    v_mfma_f32_16x16x32_bf16 v[60:63], v[172:175], v[44:47], v[60:63]
    ds_read_b128 v[36:39], v1 offset:12288
    v_mfma_f32_16x16x32_bf16 v[56:59], v[76:79], v[48:51], v[56:59]
    ds_read_b128 v[40:43], v1 offset:13312
    s_waitcnt lgkmcnt(4)
    v_mfma_f32_16x16x32_bf16 v[52:55], v[80:83], v[20:23], v[52:55]
    v_mfma_f32_16x16x32_bf16 v[60:63], v[176:179], v[20:23], v[60:63]
    ds_read_b128 v[44:47], v1 offset:14336
    v_mfma_f32_16x16x32_bf16 v[56:59], v[80:83], v[24:27], v[56:59]
    ds_read_b128 v[48:51], v1 offset:15360
    s_waitcnt lgkmcnt(4)
    v_mfma_f32_16x16x32_bf16 v[52:55], v[84:87], v[28:31], v[52:55]
    v_mfma_f32_16x16x32_bf16 v[60:63], v[180:183], v[28:31], v[60:63]
    ds_read_b128 v[20:23], v1 offset:16384
    v_mfma_f32_16x16x32_bf16 v[56:59], v[84:87], v[32:35], v[56:59]
    ds_read_b128 v[24:27], v1 offset:17408
    s_waitcnt lgkmcnt(4)
    v_mfma_f32_16x16x32_bf16 v[52:55], v[88:91], v[36:39], v[52:55]
    v_mfma_f32_16x16x32_bf16 v[60:63], v[184:187], v[36:39], v[60:63]
    ds_read_b128 v[28:31], v1 offset:18432
    v_mfma_f32_16x16x32_bf16 v[56:59], v[88:91], v[40:43], v[56:59]
    ds_read_b128 v[32:35], v1 offset:19456
    s_waitcnt lgkmcnt(4)
    v_mfma_f32_16x16x32_bf16 v[52:55], v[92:95], v[44:47], v[52:55]
    v_mfma_f32_16x16x32_bf16 v[60:63], v[188:191], v[44:47], v[60:63]
    ds_read_b128 v[36:39], v1 offset:20480
    v_mfma_f32_16x16x32_bf16 v[56:59], v[92:95], v[48:51], v[56:59]
    ds_read_b128 v[40:43], v1 offset:21504
    s_waitcnt lgkmcnt(4)
    v_mfma_f32_16x16x32_bf16 v[52:55], v[96:99], v[20:23], v[52:55]
    v_mfma_f32_16x16x32_bf16 v[60:63], v[192:195], v[20:23], v[60:63]
    ds_read_b128 v[44:47], v1 offset:22528
    v_mfma_f32_16x16x32_bf16 v[56:59], v[96:99], v[24:27], v[56:59]
    ds_read_b128 v[48:51], v1 offset:23552
    s_waitcnt lgkmcnt(4)
    v_mfma_f32_16x16x32_bf16 v[52:55], v[100:103], v[28:31], v[52:55]
    v_mfma_f32_16x16x32_bf16 v[60:63], v[196:199], v[28:31], v[60:63]
    v_mfma_f32_16x16x32_bf16 v[56:59], v[100:103], v[32:35], v[56:59]
    s_waitcnt lgkmcnt(2)
    v_mfma_f32_16x16x32_bf16 v[52:55], v[104:107], v[36:39], v[52:55]
    v_mfma_f32_16x16x32_bf16 v[60:63], v[200:203], v[36:39], v[60:63]
    v_mfma_f32_16x16x32_bf16 v[56:59], v[104:107], v[40:43], v[56:59]
    s_waitcnt lgkmcnt(0)
    v_mfma_f32_16x16x32_bf16 v[52:55], v[108:111], v[44:47], v[52:55]
    v_mfma_f32_16x16x32_bf16 v[60:63], v[204:207], v[44:47], v[60:63]
    v_mfma_f32_16x16x32_bf16 v[56:59], v[108:111], v[48:51], v[56:59]
    s_waitcnt vmcnt(0)
    s_barrier
    ds_read_b128 v[20:23], v1 offset:24576
    ds_read_b128 v[24:27], v1 offset:25600
    ds_read_b128 v[28:31], v1 offset:26624
    ds_read_b128 v[32:35], v1 offset:27648
    ds_read_b128 v[36:39], v1 offset:28672
    ds_read_b128 v[40:43], v1 offset:29696
    s_waitcnt lgkmcnt(4)
    v_mfma_f32_16x16x32_bf16 v[52:55], v[112:115], v[20:23], v[52:55]
    v_mfma_f32_16x16x32_bf16 v[60:63], v[208:211], v[20:23], v[60:63]
    ds_read_b128 v[44:47], v1 offset:30720
    v_mfma_f32_16x16x32_bf16 v[56:59], v[112:115], v[24:27], v[56:59]
    ds_read_b128 v[48:51], v1 offset:31744
    s_waitcnt lgkmcnt(4)
    v_mfma_f32_16x16x32_bf16 v[52:55], v[116:119], v[28:31], v[52:55]
    v_mfma_f32_16x16x32_bf16 v[60:63], v[212:215], v[28:31], v[60:63]
    ds_read_b128 v[20:23], v1 offset:32768
    v_mfma_f32_16x16x32_bf16 v[56:59], v[116:119], v[32:35], v[56:59]
    ds_read_b128 v[24:27], v1 offset:33792
    s_waitcnt lgkmcnt(4)
    v_mfma_f32_16x16x32_bf16 v[52:55], v[120:123], v[36:39], v[52:55]
    v_mfma_f32_16x16x32_bf16 v[60:63], v[216:219], v[36:39], v[60:63]
    ds_read_b128 v[28:31], v1 offset:34816
    v_mfma_f32_16x16x32_bf16 v[56:59], v[120:123], v[40:43], v[56:59]
    ds_read_b128 v[32:35], v1 offset:35840
    s_waitcnt lgkmcnt(4)
    v_mfma_f32_16x16x32_bf16 v[52:55], v[124:127], v[44:47], v[52:55]
    v_mfma_f32_16x16x32_bf16 v[60:63], v[220:223], v[44:47], v[60:63]
    ds_read_b128 v[36:39], v1 offset:36864
    v_mfma_f32_16x16x32_bf16 v[56:59], v[124:127], v[48:51], v[56:59]
    ds_read_b128 v[40:43], v1 offset:37888
    s_waitcnt lgkmcnt(4)
    v_mfma_f32_16x16x32_bf16 v[52:55], v[128:131], v[20:23], v[52:55]
    v_mfma_f32_16x16x32_bf16 v[60:63], v[224:227], v[20:23], v[60:63]
    ds_read_b128 v[44:47], v1 offset:38912
    v_mfma_f32_16x16x32_bf16 v[56:59], v[128:131], v[24:27], v[56:59]
    ds_read_b128 v[48:51], v1 offset:39936
    s_waitcnt lgkmcnt(4)
    v_mfma_f32_16x16x32_bf16 v[52:55], v[132:135], v[28:31], v[52:55]
    v_mfma_f32_16x16x32_bf16 v[60:63], v[228:231], v[28:31], v[60:63]
    ds_read_b128 v[20:23], v1 offset:40960
    v_mfma_f32_16x16x32_bf16 v[56:59], v[132:135], v[32:35], v[56:59]
    ds_read_b128 v[24:27], v1 offset:41984
    s_waitcnt lgkmcnt(4)
    v_mfma_f32_16x16x32_bf16 v[52:55], v[136:139], v[36:39], v[52:55]
    v_mfma_f32_16x16x32_bf16 v[60:63], v[232:235], v[36:39], v[60:63]
    ds_read_b128 v[28:31], v1 offset:43008
    v_mfma_f32_16x16x32_bf16 v[56:59], v[136:139], v[40:43], v[56:59]
    ds_read_b128 v[32:35], v1 offset:44032
    s_waitcnt lgkmcnt(4)
    v_mfma_f32_16x16x32_bf16 v[52:55], v[140:143], v[44:47], v[52:55]
    v_mfma_f32_16x16x32_bf16 v[60:63], v[236:239], v[44:47], v[60:63]
    ds_read_b128 v[36:39], v1 offset:45056
    v_mfma_f32_16x16x32_bf16 v[56:59], v[140:143], v[48:51], v[56:59]
    ds_read_b128 v[40:43], v1 offset:46080
    s_waitcnt lgkmcnt(4)
    v_mfma_f32_16x16x32_bf16 v[52:55], v[144:147], v[20:23], v[52:55]
    v_mfma_f32_16x16x32_bf16 v[60:63], v[240:243], v[20:23], v[60:63]
    ds_read_b128 v[44:47], v1 offset:47104
    v_mfma_f32_16x16x32_bf16 v[56:59], v[144:147], v[24:27], v[56:59]
    ds_read_b128 v[48:51], v1 offset:48128
    s_waitcnt lgkmcnt(4)
    v_mfma_f32_16x16x32_bf16 v[52:55], v[148:151], v[28:31], v[52:55]
    v_mfma_f32_16x16x32_bf16 v[60:63], v[244:247], v[28:31], v[60:63]
    v_mfma_f32_16x16x32_bf16 v[56:59], v[148:151], v[32:35], v[56:59]
    s_waitcnt lgkmcnt(2)
    v_mfma_f32_16x16x32_bf16 v[52:55], v[152:155], v[36:39], v[52:55]
    v_mfma_f32_16x16x32_bf16 v[60:63], v[248:251], v[36:39], v[60:63]
    v_mfma_f32_16x16x32_bf16 v[56:59], v[152:155], v[40:43], v[56:59]
    s_waitcnt lgkmcnt(0)
    v_mfma_f32_16x16x32_bf16 v[52:55], v[156:159], v[44:47], v[52:55]
    v_mfma_f32_16x16x32_bf16 v[60:63], v[252:255], v[44:47], v[60:63]
    v_mfma_f32_16x16x32_bf16 v[56:59], v[156:159], v[48:51], v[56:59]
    s_nop 7
    v_cvt_pk_bf16_f32 v52, v52, v53
    v_cvt_pk_bf16_f32 v53, v54, v55
    v_cvt_pk_bf16_f32 v54, v56, v57
    v_cvt_pk_bf16_f32 v55, v58, v59
    v_cvt_pk_bf16_f32 v56, v60, v61
    v_cvt_pk_bf16_f32 v57, v62, v63
    s_nop 0
    v_permlane16_swap_b32 v52, v54
    v_permlane16_swap_b32 v53, v55
    s_add_u32 s59, s59, 1
    s_cmp_lt_u32 s59, 63
    s_cbranch_scc1 L_ox_loopa0
    buffer_store_dwordx4 v[52:55], v6, s[32:35], s67 offen sc1
    buffer_store_dwordx2 v[56:57], v7, s[32:35], s67 offen sc1
    s_add_u32 s67, s67, 327680
    s_endpgm
L_ox_a1:
L_ox_loopa1:
    s_barrier
    s_add_u32 m0, s70, 0
    s_add_u32 s64, s66, 0
    buffer_load_dwordx4 v1, s[32:35], s64 offen offset:0 sc1 lds
    buffer_load_dwordx4 v1, s[32:35], s64 offen offset:1024 sc1 lds
    buffer_load_dwordx4 v1, s[32:35], s64 offen offset:2048 sc1 lds
    s_add_u32 m0, s70, 24576
    s_add_u32 s64, s66, 24576
    buffer_load_dwordx4 v1, s[32:35], s64 offen offset:0 sc1 lds
    buffer_load_dwordx4 v1, s[32:35], s64 offen offset:1024 sc1 lds
    buffer_load_dwordx4 v1, s[32:35], s64 offen offset:2048 sc1 lds
    s_add_u32 s66, s66, 393216
    s_cmp_ge_u32 s66, 0x4980000
    s_cselect_b32 vcc_lo, 1572864, 0
    s_sub_u32 s66, s66, vcc_lo
    s_waitcnt vmcnt(3)
    s_barrier
    ds_read_b128 v[20:23], v1 offset:0
    ds_read_b128 v[24:27], v1 offset:1024
    ds_read_b128 v[28:31], v1 offset:2048
    ds_read_b128 v[32:35], v1 offset:3072
    ds_read_b128 v[36:39], v1 offset:4096
    ds_read_b128 v[40:43], v1 offset:5120
    s_cmp_eq_u32 s59, 0
    s_cbranch_scc1 L_ox_nsa1
    buffer_store_dwordx4 v[52:55], v6, s[32:35], s67 offen sc1
    buffer_store_dwordx2 v[56:57], v7, s[32:35], s67 offen sc1
    s_add_u32 s67, s67, 327680
L_ox_nsa1:
    s_waitcnt lgkmcnt(4)
    v_mfma_f32_16x16x32_bf16 v[52:55], v[64:67], v[20:23], 0
    ds_read_b128 v[44:47], v1 offset:6144
    v_mfma_f32_16x16x32_bf16 v[56:59], v[64:67], v[24:27], 0
    v_mfma_f32_16x16x32_bf16 v[60:63], v[160:163], v[24:27], 0
    ds_read_b128 v[48:51], v1 offset:7168
    s_waitcnt lgkmcnt(4)
    v_mfma_f32_16x16x32_bf16 v[52:55], v[68:71], v[28:31], v[52:55]
    ds_read_b128 v[20:23], v1 offset:8192
    v_mfma_f32_16x16x32_bf16 v[56:59], v[68:71], v[32:35], v[56:59]
    v_mfma_f32_16x16x32_bf16 v[60:63], v[164:167], v[32:35], v[60:63]
    ds_read_b128 v[24:27], v1 offset:9216
    s_waitcnt lgkmcnt(4)
    v_mfma_f32_16x16x32_bf16 v[52:55], v[72:75], v[36:39], v[52:55]
    ds_read_b128 v[28:31], v1 offset:10240
    v_mfma_f32_16x16x32_bf16 v[56:59], v[72:75], v[40:43], v[56:59]
    v_mfma_f32_16x16x32_bf16 v[60:63], v[168:171], v[40:43], v[60:63]
    ds_read_b128 v[32:35], v1 offset:11264
    s_waitcnt lgkmcnt(4)
    v_mfma_f32_16x16x32_bf16 v[52:55], v[76:79], v[44:47], v[52:55]
    ds_read_b128 v[36:39], v1 offset:12288
    v_mfma_f32_16x16x32_bf16 v[56:59], v[76:79], v[48:51], v[56:59]
    v_mfma_f32_16x16x32_bf16 v[60:63], v[172:175], v[48:51], v[60:63]
    ds_read_b128 v[40:43], v1 offset:13312
    s_waitcnt lgkmcnt(4)
    v_mfma_f32_16x16x32_bf16 v[52:55], v[80:83], v[20:23], v[52:55]
    ds_read_b128 v[44:47], v1 offset:14336
    v_mfma_f32_16x16x32_bf16 v[56:59], v[80:83], v[24:27], v[56:59]
    v_mfma_f32_16x16x32_bf16 v[60:63], v[176:179], v[24:27], v[60:63]
    ds_read_b128 v[48:51], v1 offset:15360
    s_waitcnt lgkmcnt(4)
    v_mfma_f32_16x16x32_bf16 v[52:55], v[84:87], v[28:31], v[52:55]
    ds_read_b128 v[20:23], v1 offset:16384
    v_mfma_f32_16x16x32_bf16 v[56:59], v[84:87], v[32:35], v[56:59]
    v_mfma_f32_16x16x32_bf16 v[60:63], v[180:183], v[32:35], v[60:63]
    ds_read_b128 v[24:27], v1 offset:17408
    s_waitcnt lgkmcnt(4)
    v_mfma_f32_16x16x32_bf16 v[52:55], v[88:91], v[36:39], v[52:55]
    ds_read_b128 v[28:31], v1 offset:18432
    v_mfma_f32_16x16x32_bf16 v[56:59], v[88:91], v[40:43], v[56:59]
    v_mfma_f32_16x16x32_bf16 v[60:63], v[184:187], v[40:43], v[60:63]
    ds_read_b128 v[32:35], v1 offset:19456
    s_waitcnt lgkmcnt(4)
    v_mfma_f32_16x16x32_bf16 v[52:55], v[92:95], v[44:47], v[52:55]
    ds_read_b128 v[36:39], v1 offset:20480
    v_mfma_f32_16x16x32_bf16 v[56:59], v[92:95], v[48:51], v[56:59]
    v_mfma_f32_16x16x32_bf16 v[60:63], v[188:191], v[48:51], v[60:63]
    ds_read_b128 v[40:43], v1 offset:21504
    s_waitcnt lgkmcnt(4)
    v_mfma_f32_16x16x32_bf16 v[52:55], v[96:99], v[20:23], v[52:55]
    ds_read_b128 v[44:47], v1 offset:22528
    v_mfma_f32_16x16x32_bf16 v[56:59], v[96:99], v[24:27], v[56:59]
    v_mfma_f32_16x16x32_bf16 v[60:63], v[192:195], v[24:27], v[60:63]
    ds_read_b128 v[48:51], v1 offset:23552
    s_waitcnt lgkmcnt(4)
    v_mfma_f32_16x16x32_bf16 v[52:55], v[100:103], v[28:31], v[52:55]
    v_mfma_f32_16x16x32_bf16 v[56:59], v[100:103], v[32:35], v[56:59]
    v_mfma_f32_16x16x32_bf16 v[60:63], v[196:199], v[32:35], v[60:63]
    s_waitcnt lgkmcnt(2)
    v_mfma_f32_16x16x32_bf16 v[52:55], v[104:107], v[36:39], v[52:55]
    v_mfma_f32_16x16x32_bf16 v[56:59], v[104:107], v[40:43], v[56:59]
    v_mfma_f32_16x16x32_bf16 v[60:63], v[200:203], v[40:43], v[60:63]
    s_waitcnt lgkmcnt(0)
    v_mfma_f32_16x16x32_bf16 v[52:55], v[108:111], v[44:47], v[52:55]
    v_mfma_f32_16x16x32_bf16 v[56:59], v[108:111], v[48:51], v[56:59]
    v_mfma_f32_16x16x32_bf16 v[60:63], v[204:207], v[48:51], v[60:63]
    s_waitcnt vmcnt(0)
    s_barrier
    ds_read_b128 v[20:23], v1 offset:24576
    ds_read_b128 v[24:27], v1 offset:25600
    ds_read_b128 v[28:31], v1 offset:26624
    ds_read_b128 v[32:35], v1 offset:27648
    ds_read_b128 v[36:39], v1 offset:28672
    ds_read_b128 v[40:43], v1 offset:29696
    s_waitcnt lgkmcnt(4)
    v_mfma_f32_16x16x32_bf16 v[52:55], v[112:115], v[20:23], v[52:55]
    ds_read_b128 v[44:47], v1 offset:30720
    v_mfma_f32_16x16x32_bf16 v[56:59], v[112:115], v[24:27], v[56:59]
    v_mfma_f32_16x16x32_bf16 v[60:63], v[208:211], v[24:27], v[60:63]
    ds_read_b128 v[48:51], v1 offset:31744
    s_waitcnt lgkmcnt(4)
    v_mfma_f32_16x16x32_bf16 v[52:55], v[116:119], v[28:31], v[52:55]
    ds_read_b128 v[20:23], v1 offset:32768
    v_mfma_f32_16x16x32_bf16 v[56:59], v[116:119], v[32:35], v[56:59]
    v_mfma_f32_16x16x32_bf16 v[60:63], v[212:215], v[32:35], v[60:63]
    ds_read_b128 v[24:27], v1 offset:33792
    s_waitcnt lgkmcnt(4)
    v_mfma_f32_16x16x32_bf16 v[52:55], v[120:123], v[36:39], v[52:55]
    ds_read_b128 v[28:31], v1 offset:34816
    v_mfma_f32_16x16x32_bf16 v[56:59], v[120:123], v[40:43], v[56:59]
    v_mfma_f32_16x16x32_bf16 v[60:63], v[216:219], v[40:43], v[60:63]
    ds_read_b128 v[32:35], v1 offset:35840
    s_waitcnt lgkmcnt(4)
    v_mfma_f32_16x16x32_bf16 v[52:55], v[124:127], v[44:47], v[52:55]
    ds_read_b128 v[36:39], v1 offset:36864
    v_mfma_f32_16x16x32_bf16 v[56:59], v[124:127], v[48:51], v[56:59]
    v_mfma_f32_16x16x32_bf16 v[60:63], v[220:223], v[48:51], v[60:63]
    ds_read_b128 v[40:43], v1 offset:37888
    s_waitcnt lgkmcnt(4)
    v_mfma_f32_16x16x32_bf16 v[52:55], v[128:131], v[20:23], v[52:55]
    ds_read_b128 v[44:47], v1 offset:38912
    v_mfma_f32_16x16x32_bf16 v[56:59], v[128:131], v[24:27], v[56:59]
    v_mfma_f32_16x16x32_bf16 v[60:63], v[224:227], v[24:27], v[60:63]
    ds_read_b128 v[48:51], v1 offset:39936
    s_waitcnt lgkmcnt(4)
    v_mfma_f32_16x16x32_bf16 v[52:55], v[132:135], v[28:31], v[52:55]
    ds_read_b128 v[20:23], v1 offset:40960
    v_mfma_f32_16x16x32_bf16 v[56:59], v[132:135], v[32:35], v[56:59]
    v_mfma_f32_16x16x32_bf16 v[60:63], v[228:231], v[32:35], v[60:63]
    ds_read_b128 v[24:27], v1 offset:41984
    s_waitcnt lgkmcnt(4)
    v_mfma_f32_16x16x32_bf16 v[52:55], v[136:139], v[36:39], v[52:55]
    ds_read_b128 v[28:31], v1 offset:43008
    v_mfma_f32_16x16x32_bf16 v[56:59], v[136:139], v[40:43], v[56:59]
    v_mfma_f32_16x16x32_bf16 v[60:63], v[232:235], v[40:43], v[60:63]
    ds_read_b128 v[32:35], v1 offset:44032
    s_waitcnt lgkmcnt(4)
    v_mfma_f32_16x16x32_bf16 v[52:55], v[140:143], v[44:47], v[52:55]
    ds_read_b128 v[36:39], v1 offset:45056
    v_mfma_f32_16x16x32_bf16 v[56:59], v[140:143], v[48:51], v[56:59]
    v_mfma_f32_16x16x32_bf16 v[60:63], v[236:239], v[48:51], v[60:63]
    ds_read_b128 v[40:43], v1 offset:46080
    s_waitcnt lgkmcnt(4)
    v_mfma_f32_16x16x32_bf16 v[52:55], v[144:147], v[20:23], v[52:55]
    ds_read_b128 v[44:47], v1 offset:47104
    v_mfma_f32_16x16x32_bf16 v[56:59], v[144:147], v[24:27], v[56:59]
    v_mfma_f32_16x16x32_bf16 v[60:63], v[240:243], v[24:27], v[60:63]
    ds_read_b128 v[48:51], v1 offset:48128
    s_waitcnt lgkmcnt(4)
    v_mfma_f32_16x16x32_bf16 v[52:55], v[148:151], v[28:31], v[52:55]
    v_mfma_f32_16x16x32_bf16 v[56:59], v[148:151], v[32:35], v[56:59]
    v_mfma_f32_16x16x32_bf16 v[60:63], v[244:247], v[32:35], v[60:63]
    s_waitcnt lgkmcnt(2)
    v_mfma_f32_16x16x32_bf16 v[52:55], v[152:155], v[36:39], v[52:55]
    v_mfma_f32_16x16x32_bf16 v[56:59], v[152:155], v[40:43], v[56:59]
    v_mfma_f32_16x16x32_bf16 v[60:63], v[248:251], v[40:43], v[60:63]
    s_waitcnt lgkmcnt(0)
    v_mfma_f32_16x16x32_bf16 v[52:55], v[156:159], v[44:47], v[52:55]
    v_mfma_f32_16x16x32_bf16 v[56:59], v[156:159], v[48:51], v[56:59]
    v_mfma_f32_16x16x32_bf16 v[60:63], v[252:255], v[48:51], v[60:63]
    s_nop 7
    v_cvt_pk_bf16_f32 v52, v52, v53
    v_cvt_pk_bf16_f32 v53, v54, v55
    v_cvt_pk_bf16_f32 v54, v56, v57
    v_cvt_pk_bf16_f32 v55, v58, v59
    v_cvt_pk_bf16_f32 v56, v60, v61
    v_cvt_pk_bf16_f32 v57, v62, v63
    s_nop 0
    v_permlane16_swap_b32 v52, v54
    v_permlane16_swap_b32 v53, v55
    s_add_u32 s59, s59, 1
    s_cmp_lt_u32 s59, 63
    s_cbranch_scc1 L_ox_loopa1
    buffer_store_dwordx4 v[52:55], v6, s[32:35], s67 offen sc1
    buffer_store_dwordx2 v[56:57], v7, s[32:35], s67 offen sc1
    s_add_u32 s67, s67, 327680
    s_endpgm
L_ox_b:
    s_add_u32 s64, s59, 0
    s_and_b32 s64, s64, 3
    s_lshl_b32 s64, s64, 4
    v_add_u32 v16, s64, v2
    v_mov_b32 v17, 0
L_ox_loopb:
    s_cmp_lg_u32 s57, 4
    s_cbranch_scc1 L_ox_bok
    s_add_u32 s65, s59, 1
    v_cmp_gt_i32 vcc, s65, v17
    s_cbranch_vccz L_ox_bok
L_ox_wb:
    buffer_load_dword v17, v16, s[32:35], 0 offen sc1
    s_waitcnt vmcnt(0)
    v_cmp_gt_i32 vcc, s65, v17
    s_cbranch_vccnz L_retry_50
L_ok_51:
L_ox_bok:
    s_barrier
    s_add_u32 m0, s70, 0
    s_add_u32 s64, s66, 0
    buffer_load_dwordx4 v1, s[32:35], s64 offen offset:0 sc1 lds
    buffer_load_dwordx4 v1, s[32:35], s64 offen offset:1024 sc1 lds
    buffer_load_dwordx4 v1, s[32:35], s64 offen offset:2048 sc1 lds
    s_add_u32 m0, s70, 24576
    s_add_u32 s64, s66, 24576
    buffer_load_dwordx4 v1, s[32:35], s64 offen offset:0 sc1 lds
    buffer_load_dwordx4 v1, s[32:35], s64 offen offset:1024 sc1 lds
    buffer_load_dwordx4 v1, s[32:35], s64 offen offset:2048 sc1 lds
    s_add_u32 s66, s66, 393216
    s_cmp_ge_u32 s66, 0x4980000
    s_cselect_b32 vcc_lo, 1572864, 0
    s_sub_u32 s66, s66, vcc_lo
    s_waitcnt vmcnt(3)
    s_barrier
    ds_read_b128 v[20:23], v1 offset:0
    ds_read_b128 v[24:27], v1 offset:1024
    ds_read_b128 v[28:31], v1 offset:2048
    ds_read_b128 v[32:35], v1 offset:3072
    ds_read_b128 v[36:39], v1 offset:4096
    ds_read_b128 v[40:43], v1 offset:5120
    s_cmp_eq_u32 s59, 0
    s_cbranch_scc1 L_ox_nsb
    buffer_store_dwordx4 v[52:55], v6, s[32:35], s67 offen sc1
    s_add_u32 s67, s67, 327680
L_ox_nsb:
    s_waitcnt lgkmcnt(4)
    v_mfma_f32_16x16x32_bf16 v[52:55], v[64:67], v[20:23], 0
    ds_read_b128 v[44:47], v1 offset:6144
    v_mfma_f32_16x16x32_bf16 v[56:59], v[64:67], v[24:27], 0
    ds_read_b128 v[48:51], v1 offset:7168
    s_waitcnt lgkmcnt(4)
    v_mfma_f32_16x16x32_bf16 v[52:55], v[68:71], v[28:31], v[52:55]
    ds_read_b128 v[20:23], v1 offset:8192
    v_mfma_f32_16x16x32_bf16 v[56:59], v[68:71], v[32:35], v[56:59]
    ds_read_b128 v[24:27], v1 offset:9216
    s_waitcnt lgkmcnt(4)
    v_mfma_f32_16x16x32_bf16 v[52:55], v[72:75], v[36:39], v[52:55]
    ds_read_b128 v[28:31], v1 offset:10240
    v_mfma_f32_16x16x32_bf16 v[56:59], v[72:75], v[40:43], v[56:59]
    ds_read_b128 v[32:35], v1 offset:11264
    s_waitcnt lgkmcnt(4)
    v_mfma_f32_16x16x32_bf16 v[52:55], v[76:79], v[44:47], v[52:55]
    ds_read_b128 v[36:39], v1 offset:12288
    v_mfma_f32_16x16x32_bf16 v[56:59], v[76:79], v[48:51], v[56:59]
    ds_read_b128 v[40:43], v1 offset:13312
    s_waitcnt lgkmcnt(4)
    v_mfma_f32_16x16x32_bf16 v[52:55], v[80:83], v[20:23], v[52:55]
    ds_read_b128 v[44:47], v1 offset:14336
    v_mfma_f32_16x16x32_bf16 v[56:59], v[80:83], v[24:27], v[56:59]
    ds_read_b128 v[48:51], v1 offset:15360
    s_waitcnt lgkmcnt(4)
    v_mfma_f32_16x16x32_bf16 v[52:55], v[84:87], v[28:31], v[52:55]
    ds_read_b128 v[20:23], v1 offset:16384
    v_mfma_f32_16x16x32_bf16 v[56:59], v[84:87], v[32:35], v[56:59]
    ds_read_b128 v[24:27], v1 offset:17408
    s_waitcnt lgkmcnt(4)
    v_mfma_f32_16x16x32_bf16 v[52:55], v[88:91], v[36:39], v[52:55]
    ds_read_b128 v[28:31], v1 offset:18432
    v_mfma_f32_16x16x32_bf16 v[56:59], v[88:91], v[40:43], v[56:59]
    ds_read_b128 v[32:35], v1 offset:19456
    s_waitcnt lgkmcnt(4)
    v_mfma_f32_16x16x32_bf16 v[52:55], v[92:95], v[44:47], v[52:55]
    ds_read_b128 v[36:39], v1 offset:20480
    v_mfma_f32_16x16x32_bf16 v[56:59], v[92:95], v[48:51], v[56:59]
    ds_read_b128 v[40:43], v1 offset:21504
    s_waitcnt lgkmcnt(4)
    v_mfma_f32_16x16x32_bf16 v[52:55], v[96:99], v[20:23], v[52:55]
    ds_read_b128 v[44:47], v1 offset:22528
    v_mfma_f32_16x16x32_bf16 v[56:59], v[96:99], v[24:27], v[56:59]
    ds_read_b128 v[48:51], v1 offset:23552
    s_waitcnt lgkmcnt(4)
    v_mfma_f32_16x16x32_bf16 v[52:55], v[100:103], v[28:31], v[52:55]
    v_mfma_f32_16x16x32_bf16 v[56:59], v[100:103], v[32:35], v[56:59]
    s_waitcnt lgkmcnt(2)
    v_mfma_f32_16x16x32_bf16 v[52:55], v[104:107], v[36:39], v[52:55]
    v_mfma_f32_16x16x32_bf16 v[56:59], v[104:107], v[40:43], v[56:59]
    s_waitcnt lgkmcnt(0)
    v_mfma_f32_16x16x32_bf16 v[52:55], v[108:111], v[44:47], v[52:55]
    v_mfma_f32_16x16x32_bf16 v[56:59], v[108:111], v[48:51], v[56:59]
    s_waitcnt vmcnt(0)
    s_barrier
    ds_read_b128 v[20:23], v1 offset:24576
    ds_read_b128 v[24:27], v1 offset:25600
    ds_read_b128 v[28:31], v1 offset:26624
    ds_read_b128 v[32:35], v1 offset:27648
    ds_read_b128 v[36:39], v1 offset:28672
    ds_read_b128 v[40:43], v1 offset:29696
    buffer_store_dword v10, v4, s[32:35], 0 offen sc1
    v_add_u32 v10, 1, v10
    buffer_store_dword v10, v3, s[32:35], 0 offen
    s_add_u32 s64, s59, 1
    s_and_b32 s64, s64, 3
    s_lshl_b32 s64, s64, 4
    v_add_u32 v16, s64, v2
    s_waitcnt lgkmcnt(4)
    v_mfma_f32_16x16x32_bf16 v[52:55], v[112:115], v[20:23], v[52:55]
    ds_read_b128 v[44:47], v1 offset:30720
    v_mfma_f32_16x16x32_bf16 v[56:59], v[112:115], v[24:27], v[56:59]
    ds_read_b128 v[48:51], v1 offset:31744
    s_waitcnt lgkmcnt(4)
    v_mfma_f32_16x16x32_bf16 v[52:55], v[116:119], v[28:31], v[52:55]
    ds_read_b128 v[20:23], v1 offset:32768
    v_mfma_f32_16x16x32_bf16 v[56:59], v[116:119], v[32:35], v[56:59]
    ds_read_b128 v[24:27], v1 offset:33792
    s_waitcnt lgkmcnt(4)
    v_mfma_f32_16x16x32_bf16 v[52:55], v[120:123], v[36:39], v[52:55]
    ds_read_b128 v[28:31], v1 offset:34816
    v_mfma_f32_16x16x32_bf16 v[56:59], v[120:123], v[40:43], v[56:59]
    ds_read_b128 v[32:35], v1 offset:35840
    s_waitcnt lgkmcnt(4)
    v_mfma_f32_16x16x32_bf16 v[52:55], v[124:127], v[44:47], v[52:55]
    ds_read_b128 v[36:39], v1 offset:36864
    v_mfma_f32_16x16x32_bf16 v[56:59], v[124:127], v[48:51], v[56:59]
    ds_read_b128 v[40:43], v1 offset:37888
    s_waitcnt lgkmcnt(4)
    v_mfma_f32_16x16x32_bf16 v[52:55], v[128:131], v[20:23], v[52:55]
    ds_read_b128 v[44:47], v1 offset:38912
    v_mfma_f32_16x16x32_bf16 v[56:59], v[128:131], v[24:27], v[56:59]
    ds_read_b128 v[48:51], v1 offset:39936
    s_waitcnt lgkmcnt(4)
    v_mfma_f32_16x16x32_bf16 v[52:55], v[132:135], v[28:31], v[52:55]
    ds_read_b128 v[20:23], v1 offset:40960
    buffer_load_dword v17, v16, s[32:35], 0 offen sc1
    v_mfma_f32_16x16x32_bf16 v[56:59], v[132:135], v[32:35], v[56:59]
    ds_read_b128 v[24:27], v1 offset:41984
    s_waitcnt lgkmcnt(4)
    v_mfma_f32_16x16x32_bf16 v[52:55], v[136:139], v[36:39], v[52:55]
    ds_read_b128 v[28:31], v1 offset:43008
    v_mfma_f32_16x16x32_bf16 v[56:59], v[136:139], v[40:43], v[56:59]
    ds_read_b128 v[32:35], v1 offset:44032
    s_waitcnt lgkmcnt(4)
    v_mfma_f32_16x16x32_bf16 v[52:55], v[140:143], v[44:47], v[52:55]
    ds_read_b128 v[36:39], v1 offset:45056
    v_mfma_f32_16x16x32_bf16 v[56:59], v[140:143], v[48:51], v[56:59]
    ds_read_b128 v[40:43], v1 offset:46080
    s_waitcnt lgkmcnt(4)
    v_mfma_f32_16x16x32_bf16 v[52:55], v[144:147], v[20:23], v[52:55]
    ds_read_b128 v[44:47], v1 offset:47104
    v_mfma_f32_16x16x32_bf16 v[56:59], v[144:147], v[24:27], v[56:59]
    ds_read_b128 v[48:51], v1 offset:48128
    s_waitcnt lgkmcnt(4)
    v_mfma_f32_16x16x32_bf16 v[52:55], v[148:151], v[28:31], v[52:55]
    v_mfma_f32_16x16x32_bf16 v[56:59], v[148:151], v[32:35], v[56:59]
    s_waitcnt lgkmcnt(2)
    v_mfma_f32_16x16x32_bf16 v[52:55], v[152:155], v[36:39], v[52:55]
    v_mfma_f32_16x16x32_bf16 v[56:59], v[152:155], v[40:43], v[56:59]
    s_waitcnt lgkmcnt(0)
    v_mfma_f32_16x16x32_bf16 v[52:55], v[156:159], v[44:47], v[52:55]
    v_mfma_f32_16x16x32_bf16 v[56:59], v[156:159], v[48:51], v[56:59]
    s_nop 7
    v_cvt_pk_bf16_f32 v52, v52, v53
    v_cvt_pk_bf16_f32 v53, v54, v55
    v_cvt_pk_bf16_f32 v54, v56, v57
    v_cvt_pk_bf16_f32 v55, v58, v59
    s_nop 0
    v_permlane16_swap_b32 v52, v54
    v_permlane16_swap_b32 v53, v55
    s_waitcnt vmcnt(0)
    s_add_u32 s59, s59, 1
    s_cmp_lt_u32 s59, 63
    s_cbranch_scc1 L_ox_loopb
    buffer_store_dwordx4 v[52:55], v6, s[32:35], s67 offen sc1
    s_add_u32 s67, s67, 327680
    v_add_u32 v10, 1, v10
    buffer_store_dword v10, v3, s[32:35], 0 offen offset:16
    s_endpgm
L_role_a:
    s_sub_u32 s62, s58, 28
    s_lshl_b32 s63, s56, 2
    s_add_u32 s63, s63, s62
    v_lshrrev_b32 v18, 4, v0
    v_and_b32 v19, 15, v0
    s_lshl_b32 s65, s63, 7
    s_add_u32 s65, s65, 0xa102000
    s_cmp_eq_u32 s57, 0
    s_cselect_b32 s65, s65, 0x40000000
    v_cmp_eq_u32 vcc, 0, v0
    v_mov_b32 v12, 0x40000000
    v_mov_b32 v13, s65
    v_cndmask_b32 v10, v12, v13, vcc
    v_mov_b32 v12, 0
    buffer_store_dword v12, v10, s[32:35], 0 offen sc1
    s_lshl_b32 s65, s56, 17
    s_add_u32 s65, s65, 0xa010580
    v_and_b32 v13, 31, v0
    v_lshrrev_b32 v14, 2, v13
    v_cmp_eq_u32 vcc, s56, v14
    v_lshlrev_b32 v13, 7, v13
    v_add_u32 v13, 0xa102000, v13
    v_and_b32 v14, 3, v0
    v_lshl_add_u32 v14, v14, 2, s65
    v_cndmask_b32 v11, v13, v14, vcc
    s_lshl_b32 s64, s62, 2
    s_add_u32 s65, s65, s64
    s_cmp_eq_u32 s57, 0
    s_cselect_b32 s65, s65, 0x40000000
    v_cmp_eq_u32 vcc, 0, v0
    v_mov_b32 v13, 0x40000000
    v_mov_b32 v14, s65
    v_cndmask_b32 v92, v13, v14, vcc
    buffer_store_dword v12, v92, s[32:35], 0 offen
    s_lshl_b32 s65, s62, 3
    s_add_u32 s65, s65, s56
    s_lshl_b32 s65, s65, 3
    s_add_u32 s65, s65, s57
    s_mul_i32 s65, s65, 1280
    s_add_u32 s65, s65, 0x7f60000
    s_add_u32 s64, s65, 327680
    v_lshlrev_b32 v14, 2, v0
    v_mov_b32 v15, -1
    buffer_store_dword v15, v14, s[32:35], s65 offen offset:0 sc1
    buffer_store_dword v15, v14, s[32:35], s65 offen offset:256 sc1
    buffer_store_dword v15, v14, s[32:35], s65 offen offset:512 sc1
    buffer_store_dword v15, v14, s[32:35], s65 offen offset:768 sc1
    buffer_store_dword v15, v14, s[32:35], s65 offen offset:1024 sc1
    buffer_store_dword v15, v14, s[32:35], s64 offen offset:0 sc1
    buffer_store_dword v15, v14, s[32:35], s64 offen offset:256 sc1
    buffer_store_dword v15, v14, s[32:35], s64 offen offset:512 sc1
    buffer_store_dword v15, v14, s[32:35], s64 offen offset:768 sc1
    buffer_store_dword v15, v14, s[32:35], s64 offen offset:1024 sc1
    s_waitcnt vmcnt(0)
    s_barrier
    s_cmp_lg_u32 s57, 0
    s_cbranch_scc1 L_rdy_52
    s_lshl_b32 s61, s56, 4
    v_mov_b32 v12, 1
    v_mov_b32 v13, 8
    s_mov_b64 exec, 1
    buffer_atomic_add v12, v13, s[36:39], s61 offen
    s_mov_b64 exec, -1
L_rdy_52:
    s_sub_u32 s44, s58, 22
    s_mul_i32 s45, s57, 10
    s_add_u32 s44, s44, s45
    s_mul_i32 s44, s44, 98304
    s_mul_i32 s45, s56, 1536
    s_add_u32 s44, s44, s45
    s_add_u32 s44, s44, 3932160
    v_lshrrev_b32 v250, 3, v0
    v_mul_u32_u24 v250, 12288, v250
    v_bfe_u32 v251, v0, 2, 1
    s_mov_b32 s48, s16
    s_and_b32 s49, s17, 0xffff
    s_mov_b32 s50, 0x780000
    s_mov_b32 s51, 0x20000
    s_add_u32 s46, s16, s45
    s_sub_u32 s46, 0x180, s46
    s_and_b32 s46, s46, 0x380
    s_cmp_lt_u32 s46, 0x200
    s_cselect_b32 s47, 0x400, 0
    v_mad_u32_u24 v252, v251, s47, v250
    s_add_u32 s46, s46, s44
    buffer_load_dword v253, v252, s[48:51], s46 offen
    s_mov_b32 s48, s18
    s_and_b32 s49, s19, 0xffff
    s_mov_b32 s50, 0x780000
    s_mov_b32 s51, 0x20000
    s_add_u32 s46, s18, s45
    s_sub_u32 s46, 0x180, s46
    s_and_b32 s46, s46, 0x380
    s_cmp_lt_u32 s46, 0x200
    s_cselect_b32 s47, 0x400, 0
    v_mad_u32_u24 v252, v251, s47, v250
    s_add_u32 s46, s46, s44
    buffer_load_dword v253, v252, s[48:51], s46 offen
    s_mov_b32 s48, s20
    s_and_b32 s49, s21, 0xffff
    s_mov_b32 s50, 0x780000
    s_mov_b32 s51, 0x20000
    s_add_u32 s46, s20, s45
    s_sub_u32 s46, 0x180, s46
    s_and_b32 s46, s46, 0x380
    s_cmp_lt_u32 s46, 0x200
    s_cselect_b32 s47, 0x400, 0
    v_mad_u32_u24 v252, v251, s47, v250
    s_add_u32 s46, s46, s44
    buffer_load_dword v253, v252, s[48:51], s46 offen
    s_lshl_b32 s61, s56, 8
    s_or_b32 s61, s61, s58
    s_cmp_lg_u32 s61, 31
    s_cbranch_scc1 L_col_skip
    v_mov_b32 v12, 0
    v_mov_b32 v13, -1
    ds_write2_b32 v12, v13, v13 offset1:1
    s_mul_i32 s52, s57, 17152
    s_add_u32 s52, s52, 0xa200000
    s_mov_b32 s50, -1
    s_mov_b32 s51, -1
    s_mov_b32 s53, 3
L_near:
    s_memtime s[44:45]
    s_waitcnt lgkmcnt(0)
    s_load_dword s48, s[30:31], s52 glc
    s_waitcnt lgkmcnt(0)
    s_memtime s[46:47]
    s_waitcnt lgkmcnt(0)
    s_sub_u32 s48, s46, s44
    s_min_u32 s50, s50, s48
    s_xor_b32 s52, s52, 8192
    s_memtime s[44:45]
    s_waitcnt lgkmcnt(0)
    s_load_dword s48, s[30:31], s52 glc
    s_waitcnt lgkmcnt(0)
    s_memtime s[46:47]
    s_waitcnt lgkmcnt(0)
    s_sub_u32 s48, s46, s44
    s_min_u32 s51, s51, s48
    s_xor_b32 s52, s52, 8192
    s_sub_u32 s53, s53, 1
    s_cbranch_scc0 L_near
    s_barrier
    v_mov_b32 v13, s50
    ds_min_u32 v12, v13 offset:0
    v_mov_b32 v13, s51
    ds_min_u32 v12, v13 offset:4
    s_waitcnt lgkmcnt(0)
    s_barrier
    s_cmp_lg_u32 s57, 0
    s_cbranch_scc1 L_col_skip
    ds_read_b64 v[14:15], v12
    v_lshlrev_b32 v12, 4, v0
    s_mov_b64 exec, 0xff
L_col:
    v_mov_b32 v13, 0
    buffer_atomic_add v13, v12, s[36:39], 0 offen offset:8 sc0
    s_waitcnt vmcnt(0) lgkmcnt(0)
    v_cmp_gt_u32 vcc, 32, v13
    s_cbranch_vccnz L_retry_53
L_ok_54:
    s_mov_b64 exec, 1
    v_cmp_lt_u32 vcc, v15, v14
    s_nop 1
    v_cndmask_b32 v13, 1, 2, vcc
    buffer_store_dword v13, v12, s[36:39], 0 offen offset:252 sc1
    s_mov_b64 exec, -1
L_col_skip:
    s_mov_b32 s40, s6
    s_and_b32 s41, s7, 0xffff
    s_mov_b32 s42, 0x258000
    s_mov_b32 s43, 0x20000
    s_mov_b32 s44, s4
    s_and_b32 s45, s5, 0xffff
    s_mov_b32 s46, 0x280000
    s_mov_b32 s47, 0x20000
    s_mov_b32 s48, s8
    s_and_b32 s49, s9, 0xffff
    s_mov_b32 s50, 0x6400
    s_mov_b32 s51, 0x20000
    s_cmp_lg_u32 s57, 0
    s_cbranch_scc1 L_nrdy_55
    v_mov_b32 v12, 0
    s_sleep 64
L_wrdy_56:
    buffer_load_dword v13, v12, s[36:39], 0 offen offset:252 sc1
    s_waitcnt vmcnt(0)
    v_cmp_gt_u32 vcc, 1, v13
    s_cbranch_vccnz L_retry_57
L_ok_58:
    s_lshl_b32 s61, s56, 17
    s_add_u32 s61, s61, 0xa010000
    v_min_u32 v12, 47, v0
    v_lshl_add_u32 v12, v12, 2, s61
L_wrdy_56v:
    buffer_load_dword v13, v12, s[32:35], 0 offen sc1
    s_waitcnt vmcnt(0)
    v_cmp_gt_u32 vcc, 1, v13
    s_cbranch_vccnz L_retry_59
L_ok_60:
L_nrdy_55:
    s_barrier
    v_mov_b32 v12, 0
    v_cmp_lt_u32 vcc, 4, v19
    v_mov_b32 v13, 0x9d8
    s_nop 0
    v_cndmask_b32 v12, v12, v13, vcc
    v_cmp_lt_u32 vcc, 7, v19
    v_mov_b32 v13, 0x4c0
    s_nop 0
    v_cndmask_b32 v12, v12, v13, vcc
    v_cmp_lt_u32 vcc, 12, v19
    v_mov_b32 v13, 0x9b0
    s_nop 0
    v_cndmask_b32 v12, v12, v13, vcc
    v_cmp_lt_u32 vcc, 14, v19
    v_mov_b32 v13, 0x40000000
    s_nop 0
    v_cndmask_b32 v12, v12, v13, vcc
    v_lshl_add_u32 v12, v19, 3, v12
    s_lshl_b32 s65, s57, 2
    v_add_u32 v13, s65, v18
    v_mul_u32_u24 v13, 3840, v13
    s_mul_i32 s65, s63, 40
    v_add3_u32 v12, v12, v13, s65
    s_mov_b32 s65, 0
    buffer_load_dwordx2 v[96:97], v12, s[40:43], s65 offen
    s_mov_b32 s65, 122880
    buffer_load_dwordx2 v[98:99], v12, s[40:43], s65 offen
    s_mov_b32 s65, 245760
    buffer_load_dwordx2 v[100:101], v12, s[40:43], s65 offen
    s_mov_b32 s65, 368640
    buffer_load_dwordx2 v[102:103], v12, s[40:43], s65 offen
    s_mov_b32 s65, 491520
    buffer_load_dwordx2 v[104:105], v12, s[40:43], s65 offen
    s_mov_b32 s65, 614400
    buffer_load_dwordx2 v[106:107], v12, s[40:43], s65 offen
    s_mov_b32 s65, 737280
    buffer_load_dwordx2 v[108:109], v12, s[40:43], s65 offen
    s_mov_b32 s65, 860160
    buffer_load_dwordx2 v[110:111], v12, s[40:43], s65 offen
    s_mov_b32 s65, 983040
    buffer_load_dwordx2 v[112:113], v12, s[40:43], s65 offen
    s_mov_b32 s65, 1105920
    buffer_load_dwordx2 v[114:115], v12, s[40:43], s65 offen
    s_mov_b32 s65, 1228800
    buffer_load_dwordx2 v[116:117], v12, s[40:43], s65 offen
    s_mov_b32 s65, 1351680
    buffer_load_dwordx2 v[118:119], v12, s[40:43], s65 offen
    s_mov_b32 s65, 1474560
    buffer_load_dwordx2 v[120:121], v12, s[40:43], s65 offen
    s_mov_b32 s65, 1597440
    buffer_load_dwordx2 v[122:123], v12, s[40:43], s65 offen
    s_mov_b32 s65, 1720320
    buffer_load_dwordx2 v[124:125], v12, s[40:43], s65 offen
    s_mov_b32 s65, 1843200
    buffer_load_dwordx2 v[126:127], v12, s[40:43], s65 offen
    s_mov_b32 s65, 1966080
    buffer_load_dwordx2 v[128:129], v12, s[40:43], s65 offen
    s_mov_b32 s65, 2088960
    buffer_load_dwordx2 v[130:131], v12, s[40:43], s65 offen
    s_mov_b32 s65, 2211840
    buffer_load_dwordx2 v[132:133], v12, s[40:43], s65 offen
    s_mov_b32 s65, 2334720
    buffer_load_dwordx2 v[134:135], v12, s[40:43], s65 offen
    s_mul_i32 s65, s63, 800
    v_mov_b32 v17, 0x40000000
    v_lshlrev_b32 v13, 1, v19
    v_lshrrev_b32 v14, 1, v19
    v_add_u32 v14, 32, v14
    v_and_b32 v15, 3, v0
    v_cmp_eq_u32 vcc, 0, v15
    v_mul_u32_u24 v16, 160, v18
    s_nop 0
    v_cndmask_b32 v14, v17, v14, vcc
    v_cmp_eq_u32 vcc, 0, v18
    v_mov_b32 v15, 640
    s_nop 0
    v_cndmask_b32 v17, v17, v15, vcc
    v_add_u32 v15, v13, v16
    buffer_load_ushort v56, v15, s[48:51], s65 offen offset:0
    buffer_load_ushort v64, v15, s[48:51], s65 offen offset:40
    buffer_load_ushort v57, v15, s[48:51], s65 offen offset:80
    buffer_load_ushort v65, v15, s[48:51], s65 offen offset:120
    v_add_u32 v15, v13, v17
    buffer_load_ushort v58, v15, s[48:51], s65 offen offset:0
    buffer_load_ushort v66, v15, s[48:51], s65 offen offset:40
    buffer_load_ushort v59, v15, s[48:51], s65 offen offset:80
    buffer_load_ushort v67, v15, s[48:51], s65 offen offset:120
    v_add_u32 v15, v14, v16
    buffer_load_ushort v60, v15, s[48:51], s65 offen offset:0
    buffer_load_ushort v68, v15, s[48:51], s65 offen offset:40
    buffer_load_ushort v61, v15, s[48:51], s65 offen offset:80
    buffer_load_ushort v69, v15, s[48:51], s65 offen offset:120
    v_add_u32 v15, v14, v17
    buffer_load_ushort v62, v15, s[48:51], s65 offen offset:0
    buffer_load_ushort v70, v15, s[48:51], s65 offen offset:40
    buffer_load_ushort v63, v15, s[48:51], s65 offen offset:80
    buffer_load_ushort v71, v15, s[48:51], s65 offen offset:120
    s_lshl_b32 s65, s57, 9
    v_lshl_add_u32 v12, v0, 3, s65
    s_waitcnt vmcnt(35)
    ds_write_b64 v12, v[96:97] offset:0
    s_waitcnt vmcnt(34)
    ds_write_b64 v12, v[98:99] offset:4096
    s_waitcnt vmcnt(33)
    ds_write_b64 v12, v[100:101] offset:8192
    s_waitcnt vmcnt(32)
    ds_write_b64 v12, v[102:103] offset:12288
    s_waitcnt vmcnt(31)
    ds_write_b64 v12, v[104:105] offset:16384
    s_waitcnt vmcnt(30)
    ds_write_b64 v12, v[106:107] offset:20480
    s_waitcnt vmcnt(29)
    ds_write_b64 v12, v[108:109] offset:24576
    s_waitcnt vmcnt(28)
    ds_write_b64 v12, v[110:111] offset:28672
    s_waitcnt lgkmcnt(0)
    s_waitcnt vmcnt(27)
    ds_write_b64 v12, v[112:113] offset:32768
    s_waitcnt vmcnt(26)
    ds_write_b64 v12, v[114:115] offset:36864
    v_add_u32 v12, 40960, v12
    s_waitcnt vmcnt(25)
    ds_write_b64 v12, v[116:117] offset:0
    s_waitcnt vmcnt(24)
    ds_write_b64 v12, v[118:119] offset:4096
    s_waitcnt vmcnt(23)
    ds_write_b64 v12, v[120:121] offset:8192
    s_waitcnt vmcnt(22)
    ds_write_b64 v12, v[122:123] offset:12288
    s_waitcnt vmcnt(21)
    ds_write_b64 v12, v[124:125] offset:16384
    s_waitcnt vmcnt(20)
    ds_write_b64 v12, v[126:127] offset:20480
    s_waitcnt lgkmcnt(0)
    s_waitcnt vmcnt(19)
    ds_write_b64 v12, v[128:129] offset:24576
    s_waitcnt vmcnt(18)
    ds_write_b64 v12, v[130:131] offset:28672
    s_waitcnt vmcnt(17)
    ds_write_b64 v12, v[132:133] offset:32768
    s_waitcnt vmcnt(16)
    ds_write_b64 v12, v[134:135] offset:36864
    v_mov_b32 v20, 0
    v_mov_b32 v21, 0
    v_mov_b32 v22, 0
    v_mov_b32 v23, 0
    s_lshl_b32 s65, s57, 10
    s_add_u32 s65, s65, 122880
    v_lshl_add_u32 v12, v0, 4, s65
    ds_write_b128 v12, v[20:23]
    ds_write_b128 v12, v[20:23] offset:8192
    s_waitcnt vmcnt(0) lgkmcnt(0)
    s_barrier
    v_lshl_or_b32 v56, v64, 16, v56
    v_lshl_or_b32 v57, v65, 16, v57
    v_lshl_or_b32 v58, v66, 16, v58
    v_lshl_or_b32 v59, v67, 16, v59
    v_lshl_or_b32 v60, v68, 16, v60
    v_lshl_or_b32 v61, v69, 16, v61
    v_lshl_or_b32 v62, v70, 16, v62
    v_lshl_or_b32 v63, v71, 16, v63
    v_mul_u32_u24 v12, 168, v0
    v_add_u32 v12, 122880, v12
    v_mov_b32 v13, 0x3f80
    ds_write_b32 v12, v13 offset:136
    v_bfe_u32 v16, v0, 2, 2
    v_and_b32 v17, 3, v0
    v_lshlrev_b32 v12, 10, v18
    v_lshl_add_u32 v12, v16, 7, v12
    v_lshl_add_u32 v12, v17, 3, v12
    s_and_b32 s65, s57, 1
    s_lshl_b32 s65, s65, 6
    v_add_u32 v12, s65, v12
    ds_read_b64_tr_b16 v[96:97], v12 offset:0
    ds_read_b64_tr_b16 v[98:99], v12 offset:512
    ds_read_b64_tr_b16 v[176:177], v12 offset:32
    ds_read_b64_tr_b16 v[178:179], v12 offset:544
    ds_read_b64_tr_b16 v[100:101], v12 offset:4096
    ds_read_b64_tr_b16 v[102:103], v12 offset:4608
    ds_read_b64_tr_b16 v[180:181], v12 offset:4128
    ds_read_b64_tr_b16 v[182:183], v12 offset:4640
    s_waitcnt lgkmcnt(4)
    ds_read_b64_tr_b16 v[104:105], v12 offset:8192
    ds_read_b64_tr_b16 v[106:107], v12 offset:8704
    ds_read_b64_tr_b16 v[184:185], v12 offset:8224
    ds_read_b64_tr_b16 v[186:187], v12 offset:8736
    ds_read_b64_tr_b16 v[108:109], v12 offset:12288
    ds_read_b64_tr_b16 v[110:111], v12 offset:12800
    ds_read_b64_tr_b16 v[188:189], v12 offset:12320
    ds_read_b64_tr_b16 v[190:191], v12 offset:12832
    s_waitcnt lgkmcnt(4)
    ds_read_b64_tr_b16 v[112:113], v12 offset:16384
    ds_read_b64_tr_b16 v[114:115], v12 offset:16896
    ds_read_b64_tr_b16 v[192:193], v12 offset:16416
    ds_read_b64_tr_b16 v[194:195], v12 offset:16928
    ds_read_b64_tr_b16 v[116:117], v12 offset:20480
    ds_read_b64_tr_b16 v[118:119], v12 offset:20992
    ds_read_b64_tr_b16 v[196:197], v12 offset:20512
    ds_read_b64_tr_b16 v[198:199], v12 offset:21024
    s_waitcnt lgkmcnt(4)
    ds_read_b64_tr_b16 v[120:121], v12 offset:24576
    ds_read_b64_tr_b16 v[122:123], v12 offset:25088
    ds_read_b64_tr_b16 v[200:201], v12 offset:24608
    ds_read_b64_tr_b16 v[202:203], v12 offset:25120
    ds_read_b64_tr_b16 v[124:125], v12 offset:28672
    ds_read_b64_tr_b16 v[126:127], v12 offset:29184
    ds_read_b64_tr_b16 v[204:205], v12 offset:28704
    ds_read_b64_tr_b16 v[206:207], v12 offset:29216
    s_waitcnt lgkmcnt(4)
    ds_read_b64_tr_b16 v[128:129], v12 offset:32768
    ds_read_b64_tr_b16 v[130:131], v12 offset:33280
    ds_read_b64_tr_b16 v[208:209], v12 offset:32800
    ds_read_b64_tr_b16 v[210:211], v12 offset:33312
    ds_read_b64_tr_b16 v[132:133], v12 offset:36864
    ds_read_b64_tr_b16 v[134:135], v12 offset:37376
    ds_read_b64_tr_b16 v[212:213], v12 offset:36896
    ds_read_b64_tr_b16 v[214:215], v12 offset:37408
    s_waitcnt lgkmcnt(4)
    v_add_u32 v12, 40960, v12
    ds_read_b64_tr_b16 v[136:137], v12 offset:0
    ds_read_b64_tr_b16 v[138:139], v12 offset:512
    ds_read_b64_tr_b16 v[216:217], v12 offset:32
    ds_read_b64_tr_b16 v[218:219], v12 offset:544
    ds_read_b64_tr_b16 v[140:141], v12 offset:4096
    ds_read_b64_tr_b16 v[142:143], v12 offset:4608
    ds_read_b64_tr_b16 v[220:221], v12 offset:4128
    ds_read_b64_tr_b16 v[222:223], v12 offset:4640
    s_waitcnt lgkmcnt(4)
    ds_read_b64_tr_b16 v[144:145], v12 offset:8192
    ds_read_b64_tr_b16 v[146:147], v12 offset:8704
    ds_read_b64_tr_b16 v[224:225], v12 offset:8224
    ds_read_b64_tr_b16 v[226:227], v12 offset:8736
    ds_read_b64_tr_b16 v[148:149], v12 offset:12288
    ds_read_b64_tr_b16 v[150:151], v12 offset:12800
    ds_read_b64_tr_b16 v[228:229], v12 offset:12320
    ds_read_b64_tr_b16 v[230:231], v12 offset:12832
    s_waitcnt lgkmcnt(4)
    ds_read_b64_tr_b16 v[152:153], v12 offset:16384
    ds_read_b64_tr_b16 v[154:155], v12 offset:16896
    ds_read_b64_tr_b16 v[232:233], v12 offset:16416
    ds_read_b64_tr_b16 v[234:235], v12 offset:16928
    ds_read_b64_tr_b16 v[156:157], v12 offset:20480
    ds_read_b64_tr_b16 v[158:159], v12 offset:20992
    ds_read_b64_tr_b16 v[236:237], v12 offset:20512
    ds_read_b64_tr_b16 v[238:239], v12 offset:21024
    s_waitcnt lgkmcnt(4)
    ds_read_b64_tr_b16 v[160:161], v12 offset:24576
    ds_read_b64_tr_b16 v[162:163], v12 offset:25088
    ds_read_b64_tr_b16 v[240:241], v12 offset:24608
    ds_read_b64_tr_b16 v[242:243], v12 offset:25120
    ds_read_b64_tr_b16 v[164:165], v12 offset:28672
    ds_read_b64_tr_b16 v[166:167], v12 offset:29184
    ds_read_b64_tr_b16 v[244:245], v12 offset:28704
    ds_read_b64_tr_b16 v[246:247], v12 offset:29216
    s_waitcnt lgkmcnt(4)
    ds_read_b64_tr_b16 v[168:169], v12 offset:32768
    ds_read_b64_tr_b16 v[170:171], v12 offset:33280
    ds_read_b64_tr_b16 v[248:249], v12 offset:32800
    ds_read_b64_tr_b16 v[250:251], v12 offset:33312
    ds_read_b64_tr_b16 v[172:173], v12 offset:36864
    ds_read_b64_tr_b16 v[174:175], v12 offset:37376
    ds_read_b64_tr_b16 v[252:253], v12 offset:36896
    ds_read_b64_tr_b16 v[254:255], v12 offset:37408
    s_waitcnt lgkmcnt(4)
    v_lshrrev_b32 v12, 3, v0
    s_lshl_b32 s65, s57, 3
    v_add_u32 v12, s65, v12
    v_bfe_u32 v13, v12, 1, 3
    v_and_b32 v14, 7, v0
    v_xor_b32 v13, v13, v14
    v_mul_u32_u24 v12, 1280, v12
    v_lshl_add_u32 v1, v13, 4, v12
    v_lshrrev_b32 v12, 1, v19
    v_xor_b32 v12, v12, v18
    v_lshlrev_b32 v12, 4, v12
    v_lshl_add_u32 v12, v14, 7, v12
    v_bfe_u32 v13, v0, 3, 1
    s_and_b32 s65, s57, 6
    v_add_u32 v13, s65, v13
    v_mul_u32_u24 v13, 5120, v13
    v_add_u32 v2, v12, v13
    v_xor_b32 v3, 64, v2
    s_lshl_b32 s65, s65, 3
    v_add_u32 v12, s65, v19
    v_mul_u32_u24 v12, 168, v12
    v_add_u32 v12, 122880, v12
    v_lshl_add_u32 v4, v18, 3, v12
    s_bitcmp1_b32 s57, 0
    s_cselect_b32 s65, 0x13100f13, 0x0
    s_cselect_b32 s65, s65, 0xe0d0c12
    v_lshlrev_b32 v13, 3, v18
    v_bfe_u32 v13, s65, v13, 8
    v_lshl_add_u32 v5, v13, 3, v12
    v_lshl_add_u32 v12, v18, 3, v16
    v_mul_u32_u24 v12, 168, v12
    v_lshl_add_u32 v12, v17, 3, v12
    s_cmp_ge_u32 s57, 3
    s_cselect_b32 s64, 1, 0
    s_mul_i32 s65, s64, 3
    s_sub_u32 s65, s57, s65
    s_min_u32 s65, s65, 2
    s_lshl_b32 s65, s65, 5
    s_add_u32 s65, s65, 122880
    v_add_u32 v6, s65, v12
    s_lshl_b32 s64, s64, 5
    s_add_u32 s64, s64, 122976
    v_add_u32 v7, s64, v12
    s_mul_i32 s65, s63, 163840
    s_add_u32 s65, s65, 0xa400000
    v_lshl_add_u32 v8, v0, 4, s65
    v_lshl_add_u32 v9, v0, 2, s65
    v_mov_b32 v52, 0
    v_mov_b32 v53, 0
    v_mov_b32 v54, 0
    v_mov_b32 v55, 0
    v_mov_b32 v89, 0
    s_mov_b32 s52, 0x3fb8aa3b
    s_mul_i32 s68, s57, 5120
    s_mul_i32 s67, s63, 81920
    s_mov_b32 s66, 0
    s_mov_b32 s59, s63
    s_mov_b32 s70, 0
    s_mov_b32 s69, 0
    s_waitcnt lgkmcnt(0)
    s_barrier
    s_add_u32 m0, s68, s66
    s_add_u32 s64, s67, 0
    buffer_load_dwordx4 v1, s[44:47], s64 offen offset:0 lds
    s_add_u32 m0, m0, 896
    s_nop 0
    buffer_load_dwordx4 v1, s[44:47], s64 offen offset:128 lds
    s_add_u32 m0, m0, 896
    s_nop 0
    buffer_load_dwordx4 v1, s[44:47], s64 offen offset:256 lds
    s_add_u32 m0, m0, 896
    s_nop 0
    buffer_load_dwordx4 v1, s[44:47], s64 offen offset:384 lds
    s_add_u32 m0, m0, 896
    s_nop 0
    buffer_load_dwordx4 v1, s[44:47], s64 offen offset:512 lds
    s_add_u32 s66, s66, 40960
    s_cmp_ge_u32 s66, 0x1e000
    s_cselect_b32 vcc_lo, 122880, 0
    s_sub_u32 s66, s66, vcc_lo
    s_add_u32 m0, s68, s66
    s_add_u32 s64, s67, 640
    buffer_load_dwordx4 v1, s[44:47], s64 offen offset:0 lds
    s_add_u32 m0, m0, 896
    s_nop 0
    buffer_load_dwordx4 v1, s[44:47], s64 offen offset:128 lds
    s_add_u32 m0, m0, 896
    s_nop 0
    buffer_load_dwordx4 v1, s[44:47], s64 offen offset:256 lds
    s_add_u32 m0, m0, 896
    s_nop 0
    buffer_load_dwordx4 v1, s[44:47], s64 offen offset:384 lds
    s_add_u32 m0, m0, 896
    s_nop 0
    buffer_load_dwordx4 v1, s[44:47], s64 offen offset:512 lds
    s_add_u32 s66, s66, 40960
    s_cmp_ge_u32 s66, 0x1e000
    s_cselect_b32 vcc_lo, 122880, 0
    s_sub_u32 s66, s66, vcc_lo
    s_add_u32 s67, s67, 81920
    s_cmp_ge_u32 s67, 0x280000
    s_cselect_b32 vcc_lo, 2621440, 0
    s_sub_u32 s67, s67, vcc_lo
L_a_loop:
    s_waitcnt vmcnt(5) lgkmcnt(0)
    s_barrier
    s_add_u32 m0, s68, s66
    s_add_u32 s64, s67, 0
    buffer_load_dwordx4 v1, s[44:47], s64 offen offset:0 lds
    s_add_u32 m0, m0, 896
    s_nop 0
    buffer_load_dwordx4 v1, s[44:47], s64 offen offset:128 lds
    s_add_u32 m0, m0, 896
    s_nop 0
    buffer_load_dwordx4 v1, s[44:47], s64 offen offset:256 lds
    s_add_u32 m0, m0, 896
    s_nop 0
    buffer_load_dwordx4 v1, s[44:47], s64 offen offset:384 lds
    s_add_u32 m0, m0, 896
    s_nop 0
    buffer_load_dwordx4 v1, s[44:47], s64 offen offset:512 lds
    s_add_u32 s66, s66, 40960
    s_cmp_ge_u32 s66, 0x1e000
    s_cselect_b32 vcc_lo, 122880, 0
    s_sub_u32 s66, s66, vcc_lo
    ds_read_b64_tr_b16 v[20:21], v6 offset:0
    ds_read_b64_tr_b16 v[22:23], v6 offset:672
    ds_read_b64_tr_b16 v[24:25], v7 offset:0
    ds_read_b64_tr_b16 v[26:27], v7 offset:672
    ds_read_b64_tr_b16 v[28:29], v6 offset:5376
    ds_read_b64_tr_b16 v[30:31], v6 offset:6048
    ds_read_b64_tr_b16 v[32:33], v7 offset:5376
    ds_read_b64_tr_b16 v[34:35], v7 offset:6048
    s_waitcnt lgkmcnt(4)
    v_mfma_f32_16x16x32_bf16 v[52:55], v[20:23], v[24:27], v[52:55]
    s_waitcnt lgkmcnt(0)
    v_mfma_f32_16x16x32_bf16 v[52:55], v[28:31], v[32:35], v[52:55]
    v_add_u32 v12, s69, v2
    v_add_u32 v13, s69, v3
    s_add_u32 s69, s69, 40960
    s_cmp_ge_u32 s69, 0x1e000
    s_cselect_b32 vcc_lo, 122880, 0
    s_sub_u32 s69, s69, vcc_lo
    ds_read_b128 v[20:23], v12 offset:0
    ds_read_b128 v[24:27], v13 offset:0
    ds_read_b128 v[28:31], v12 offset:1024
    ds_read_b128 v[32:35], v13 offset:1024
    ds_read_b128 v[36:39], v12 offset:2048
    s_waitcnt lgkmcnt(4)
    v_mfma_f32_16x16x32_bf16 v[44:47], v[96:99], v[20:23], 0
    ds_read_b128 v[40:43], v13 offset:2048
    v_mfma_f32_16x16x32_bf16 v[48:51], v[176:179], v[20:23], 0
    s_waitcnt lgkmcnt(4)
    v_mfma_f32_16x16x32_bf16 v[44:47], v[100:103], v[24:27], v[44:47]
    ds_read_b128 v[20:23], v12 offset:3072
    v_mfma_f32_16x16x32_bf16 v[48:51], v[180:183], v[24:27], v[48:51]
    s_waitcnt lgkmcnt(4)
    v_mfma_f32_16x16x32_bf16 v[44:47], v[104:107], v[28:31], v[44:47]
    ds_read_b128 v[24:27], v13 offset:3072
    v_mfma_f32_16x16x32_bf16 v[48:51], v[184:187], v[28:31], v[48:51]
    s_waitcnt lgkmcnt(4)
    v_mfma_f32_16x16x32_bf16 v[44:47], v[108:111], v[32:35], v[44:47]
    ds_read_b128 v[28:31], v12 offset:4096
    v_mfma_f32_16x16x32_bf16 v[48:51], v[188:191], v[32:35], v[48:51]
    s_waitcnt lgkmcnt(4)
    v_mfma_f32_16x16x32_bf16 v[44:47], v[112:115], v[36:39], v[44:47]
    ds_read_b128 v[32:35], v13 offset:4096
    v_mfma_f32_16x16x32_bf16 v[48:51], v[192:195], v[36:39], v[48:51]
    s_waitcnt lgkmcnt(4)
    v_mfma_f32_16x16x32_bf16 v[44:47], v[116:119], v[40:43], v[44:47]
    v_mfma_f32_16x16x32_bf16 v[48:51], v[196:199], v[40:43], v[48:51]
    s_waitcnt lgkmcnt(3)
    v_mfma_f32_16x16x32_bf16 v[44:47], v[120:123], v[20:23], v[44:47]
    v_mfma_f32_16x16x32_bf16 v[48:51], v[200:203], v[20:23], v[48:51]
    s_waitcnt lgkmcnt(2)
    v_mfma_f32_16x16x32_bf16 v[44:47], v[124:127], v[24:27], v[44:47]
    v_mfma_f32_16x16x32_bf16 v[48:51], v[204:207], v[24:27], v[48:51]
    s_waitcnt lgkmcnt(1)
    v_mfma_f32_16x16x32_bf16 v[44:47], v[128:131], v[28:31], v[44:47]
    v_mfma_f32_16x16x32_bf16 v[48:51], v[208:211], v[28:31], v[48:51]
    s_waitcnt lgkmcnt(0)
    v_mfma_f32_16x16x32_bf16 v[44:47], v[132:135], v[32:35], v[44:47]
    v_mfma_f32_16x16x32_bf16 v[48:51], v[212:215], v[32:35], v[48:51]
    s_waitcnt vmcnt(5) lgkmcnt(0)
    s_barrier
    s_add_u32 m0, s68, s66
    s_add_u32 s64, s67, 640
    buffer_load_dwordx4 v1, s[44:47], s64 offen offset:0 lds
    s_add_u32 m0, m0, 896
    s_nop 0
    buffer_load_dwordx4 v1, s[44:47], s64 offen offset:128 lds
    s_add_u32 m0, m0, 896
    s_nop 0
    buffer_load_dwordx4 v1, s[44:47], s64 offen offset:256 lds
    s_add_u32 m0, m0, 896
    s_nop 0
    buffer_load_dwordx4 v1, s[44:47], s64 offen offset:384 lds
    s_add_u32 m0, m0, 896
    s_nop 0
    buffer_load_dwordx4 v1, s[44:47], s64 offen offset:512 lds
    s_add_u32 s66, s66, 40960
    s_cmp_ge_u32 s66, 0x1e000
    s_cselect_b32 vcc_lo, 122880, 0
    s_sub_u32 s66, s66, vcc_lo
    s_add_u32 s67, s67, 81920
    s_cmp_ge_u32 s67, 0x280000
    s_cselect_b32 vcc_lo, 2621440, 0
    s_sub_u32 s67, s67, vcc_lo
    v_add_u32 v12, s69, v2
    v_add_u32 v13, s69, v3
    s_add_u32 s69, s69, 40960
    s_cmp_ge_u32 s69, 0x1e000
    s_cselect_b32 vcc_lo, 122880, 0
    s_sub_u32 s69, s69, vcc_lo
    ds_read_b128 v[20:23], v12 offset:0
    ds_read_b128 v[24:27], v13 offset:0
    ds_read_b128 v[28:31], v12 offset:1024
    ds_read_b128 v[32:35], v13 offset:1024
    ds_read_b128 v[36:39], v12 offset:2048
    s_waitcnt lgkmcnt(4)
    v_mfma_f32_16x16x32_bf16 v[44:47], v[136:139], v[20:23], v[44:47]
    ds_read_b128 v[40:43], v13 offset:2048
    v_mfma_f32_16x16x32_bf16 v[48:51], v[216:219], v[20:23], v[48:51]
    s_waitcnt lgkmcnt(4)
    v_mfma_f32_16x16x32_bf16 v[44:47], v[140:143], v[24:27], v[44:47]
    ds_read_b128 v[20:23], v12 offset:3072
    v_mfma_f32_16x16x32_bf16 v[48:51], v[220:223], v[24:27], v[48:51]
    s_waitcnt lgkmcnt(4)
    v_mfma_f32_16x16x32_bf16 v[44:47], v[144:147], v[28:31], v[44:47]
    ds_read_b128 v[24:27], v13 offset:3072
    v_mfma_f32_16x16x32_bf16 v[48:51], v[224:227], v[28:31], v[48:51]
    s_waitcnt lgkmcnt(4)
    v_mfma_f32_16x16x32_bf16 v[44:47], v[148:151], v[32:35], v[44:47]
    ds_read_b128 v[28:31], v12 offset:4096
    v_mfma_f32_16x16x32_bf16 v[48:51], v[228:231], v[32:35], v[48:51]
    s_waitcnt lgkmcnt(4)
    v_mfma_f32_16x16x32_bf16 v[44:47], v[152:155], v[36:39], v[44:47]
    ds_read_b128 v[32:35], v13 offset:4096
    v_mfma_f32_16x16x32_bf16 v[48:51], v[232:235], v[36:39], v[48:51]
    s_waitcnt lgkmcnt(4)
    v_mfma_f32_16x16x32_bf16 v[44:47], v[156:159], v[40:43], v[44:47]
    v_mfma_f32_16x16x32_bf16 v[48:51], v[236:239], v[40:43], v[48:51]
    s_waitcnt lgkmcnt(3)
    v_mfma_f32_16x16x32_bf16 v[44:47], v[160:163], v[20:23], v[44:47]
    v_mfma_f32_16x16x32_bf16 v[48:51], v[240:243], v[20:23], v[48:51]
    s_waitcnt lgkmcnt(2)
    v_mfma_f32_16x16x32_bf16 v[44:47], v[164:167], v[24:27], v[44:47]
    v_mfma_f32_16x16x32_bf16 v[48:51], v[244:247], v[24:27], v[48:51]
    s_waitcnt lgkmcnt(1)
    v_mfma_f32_16x16x32_bf16 v[44:47], v[168:171], v[28:31], v[44:47]
    v_mfma_f32_16x16x32_bf16 v[48:51], v[248:251], v[28:31], v[48:51]
    s_waitcnt lgkmcnt(0)
    v_mfma_f32_16x16x32_bf16 v[44:47], v[172:175], v[32:35], v[44:47]
    v_mfma_f32_16x16x32_bf16 v[48:51], v[252:255], v[32:35], v[48:51]
    s_nop 6
    v_cvt_pk_bf16_f32 v64, v44, v45
    v_cvt_pk_bf16_f32 v65, v46, v47
    v_cvt_pk_bf16_f32 v66, v48, v49
    v_cvt_pk_bf16_f32 v67, v50, v51
    ds_write_b64 v5, v[66:67]
    s_nop 0
    v_mfma_f32_16x16x32_bf16 v[68:71], v[56:59], v[64:67], 0
    v_mfma_f32_16x16x32_bf16 v[72:75], v[60:63], v[64:67], 0
    s_lshl_b32 s65, s59, 2
    s_lshr_b32 s64, s57, 1
    s_add_u32 s65, s65, s64
    s_mul_i32 s65, s65, 1280
    s_add_u32 s59, s59, 1
    s_and_b32 s59, s59, 31
    s_add_u32 s70, s70, 1
    v_cvt_pk_bf16_f32 v12, v68, v69
    v_cvt_pk_bf16_f32 v13, v70, v71
    v_cvt_pk_bf16_f32 v72, 0, v72
    v_lshlrev_b32 v68, 16, v12
    v_and_b32 v69, 0xffff0000, v12
    v_lshlrev_b32 v70, 16, v13
    v_and_b32 v71, 0xffff0000, v13
    v_max3_f32 v12, v68, v69, v70
    v_max3_f32 v12, v12, v71, v72
    v_max3_f32 v13, -v68, -v69, -v70
    v_max3_f32 v13, v13, -v71, -v72
    s_nop 1
    v_permlane32_swap_b32 v12, v13
    v_max_f32 v12, v12, v13
    v_mov_b32 v13, v12
    s_nop 1
    v_permlane16_swap_b32 v12, v13
    v_max_f32 v12, v12, v13
    v_mov_b32 v13, v12
    s_nop 1
    v_permlane32_swap_b32 v12, v13
    v_sub_f32 v76, -v68, v13
    v_sub_f32 v68, v68, v12
    v_sub_f32 v77, -v69, v13
    v_sub_f32 v69, v69, v12
    v_sub_f32 v78, -v70, v13
    v_sub_f32 v70, v70, v12
    v_sub_f32 v79, -v71, v13
    v_sub_f32 v71, v71, v12
    v_sub_f32 v80, -v72, v13
    v_sub_f32 v72, v72, v12
    v_mul_f32 v68, s52, v68
    v_mul_f32 v69, s52, v69
    v_mul_f32 v70, s52, v70
    v_mul_f32 v71, s52, v71
    v_mul_f32 v72, s52, v72
    v_mul_f32 v76, s52, v76
    v_mul_f32 v77, s52, v77
    v_mul_f32 v78, s52, v78
    v_mul_f32 v79, s52, v79
    v_mul_f32 v80, s52, v80
    v_exp_f32 v68, v68
    v_exp_f32 v69, v69
    v_exp_f32 v70, v70
    v_exp_f32 v71, v71
    v_exp_f32 v72, v72
    v_exp_f32 v76, v76
    v_exp_f32 v77, v77
    v_exp_f32 v78, v78
    v_exp_f32 v79, v79
    v_exp_f32 v80, v80
    v_add_f32 v12, v68, v69
    v_add_f32 v12, v12, v70
    v_add_f32 v12, v12, v71
    v_add_f32 v12, v12, v72
    v_add_f32 v13, v76, v77
    v_add_f32 v13, v13, v78
    v_add_f32 v13, v13, v79
    v_add_f32 v13, v13, v80
    s_nop 1
    v_permlane32_swap_b32 v12, v13
    v_add_f32 v12, v12, v13
    v_mov_b32 v13, v12
    s_nop 1
    v_permlane16_swap_b32 v12, v13
    v_add_f32 v12, v12, v13
    v_mov_b32 v13, v12
    s_nop 1
    v_permlane32_swap_b32 v12, v13
    v_rcp_f32 v12, v12
    v_rcp_f32 v13, v13
    v_mul_f32 v68, v68, v12
    v_mul_f32 v69, v69, v12
    v_mul_f32 v70, v70, v12
    v_mul_f32 v71, v71, v12
    v_mul_f32 v72, v72, v12
    v_mul_f32 v76, v76, v13
    v_mul_f32 v77, v77, v13
    v_mul_f32 v78, v78, v13
    v_mul_f32 v79, v79, v13
    v_mul_f32 v80, v80, v13
    v_cvt_pk_bf16_f32 v84, v68, v69
    v_cvt_pk_bf16_f32 v86, v76, v77
    v_cvt_pk_bf16_f32 v85, v70, v71
    v_cvt_pk_bf16_f32 v87, v78, v79
    v_cvt_pk_bf16_f32 v88, v72, v80
    s_bitcmp1_b32 s57, 0
    s_cbranch_scc1 L_a_k
    buffer_store_dwordx4 v[84:87], v8, s[32:35], s65 offen
    buffer_store_dword v88, v9, s[32:35], s65 offen offset:1024
    s_branch L_a_j
L_a_k:
    ds_write_b64 v4, v[84:85] offset:0
    ds_write_b64 v4, v[86:87] offset:32
    ds_write_b64 v4, v[88:89] offset:64
L_a_j:
    s_cmp_lt_u32 s70, 32
    s_cbranch_scc1 L_a_loop
    s_waitcnt vmcnt(0) lgkmcnt(0)
    s_barrier
    ds_read_b64_tr_b16 v[20:21], v6 offset:0
    ds_read_b64_tr_b16 v[22:23], v6 offset:672
    ds_read_b64_tr_b16 v[24:25], v7 offset:0
    ds_read_b64_tr_b16 v[26:27], v7 offset:672
    ds_read_b64_tr_b16 v[28:29], v6 offset:5376
    ds_read_b64_tr_b16 v[30:31], v6 offset:6048
    ds_read_b64_tr_b16 v[32:33], v7 offset:5376
    ds_read_b64_tr_b16 v[34:35], v7 offset:6048
    s_waitcnt lgkmcnt(4)
    v_mfma_f32_16x16x32_bf16 v[52:55], v[20:23], v[24:27], v[52:55]
    s_waitcnt lgkmcnt(0)
    v_mfma_f32_16x16x32_bf16 v[52:55], v[28:31], v[32:35], v[52:55]
    s_min_u32 s65, s57, 5
    s_lshl_b32 s65, s65, 9
    s_add_u32 s65, s65, 133632
    v_lshl_add_u32 v14, v0, 3, s65
    s_nop 3
    v_cvt_pk_bf16_f32 v12, v52, v53
    v_cvt_pk_bf16_f32 v13, v54, v55
    ds_write_b64 v14, v[12:13]
    v_lshlrev_b32 v15, 3, v0
    v_add_u32 v15, 133632, v15
    v_lshlrev_b32 v16, 7, v18
    v_add_u32 v16, 135168, v16
    v_and_b32 v17, 3, v0
    v_lshl_add_u32 v17, v17, 3, v16
    s_waitcnt lgkmcnt(0)
    s_barrier
    ds_read_b64 v[20:21], v15 offset:0
    ds_read_b64 v[26:27], v16 offset:32
    ds_read_b64 v[96:97], v17 offset:0
    ds_read_b64 v[22:23], v15 offset:512
    ds_read_b64 v[28:29], v16 offset:544
    ds_read_b64 v[98:99], v17 offset:512
    ds_read_b64 v[24:25], v15 offset:1024
    ds_read_b64 v[30:31], v16 offset:1056
    ds_read_b64 v[100:101], v17 offset:1024
    v_lshrrev_b32 v12, 2, v19
    s_waitcnt lgkmcnt(0)
    v_cmp_eq_u32 vcc, 0, v12
    s_nop 1
    v_cndmask_b32 v32, 0, v96, vcc
    v_cndmask_b32 v33, 0, v97, vcc
    v_cndmask_b32 v34, 0, v98, vcc
    v_cndmask_b32 v35, 0, v99, vcc
    v_cndmask_b32 v36, 0, v100, vcc
    v_cndmask_b32 v37, 0, v101, vcc
    v_cmp_eq_u32 vcc, 1, v12
    s_nop 1
    v_cndmask_b32 v38, 0, v96, vcc
    v_cndmask_b32 v39, 0, v97, vcc
    v_cndmask_b32 v40, 0, v98, vcc
    v_cndmask_b32 v41, 0, v99, vcc
    v_cndmask_b32 v42, 0, v100, vcc
    v_cndmask_b32 v43, 0, v101, vcc
    v_cmp_eq_u32 vcc, 2, v12
    s_nop 1
    v_cndmask_b32 v44, 0, v96, vcc
    v_cndmask_b32 v45, 0, v97, vcc
    v_cndmask_b32 v46, 0, v98, vcc
    v_cndmask_b32 v47, 0, v99, vcc
    v_cndmask_b32 v48, 0, v100, vcc
    v_cndmask_b32 v49, 0, v101, vcc
    v_cmp_eq_u32 vcc, 3, v12
    s_nop 1
    v_cndmask_b32 v50, 0, v96, vcc
    v_cndmask_b32 v51, 0, v97, vcc
    v_cndmask_b32 v52, 0, v98, vcc
    v_cndmask_b32 v53, 0, v99, vcc
    v_cndmask_b32 v54, 0, v100, vcc
    v_cndmask_b32 v55, 0, v101, vcc
    v_mov_b32 v101, 0
    v_mov_b32 v102, 0
    v_mov_b32 v103, 0
    v_mov_b32 v109, 0
    v_mov_b32 v110, 0
    v_mov_b32 v111, 0
    v_mov_b32 v117, 0
    v_mov_b32 v118, 0
    v_mov_b32 v119, 0
    v_mov_b32 v125, 0
    v_mov_b32 v126, 0
    v_mov_b32 v127, 0
    v_cmp_eq_u32 s[42:43], 1, v18
    v_cmp_eq_u32 s[44:45], 2, v18
    v_cmp_eq_u32 s[46:47], 3, v18
    v_lshlrev_b32 v15, 4, v0
    v_lshlrev_b32 v16, 3, v0
    s_mul_i32 s69, s57, 5120
    s_lshl_b32 s67, s57, 5
    s_add_u32 s67, s67, s63
    s_mul_i32 s67, s67, 2560
    s_add_u32 s67, s67, 0xac00000
    s_mov_b32 s70, 0
L_a_p2:
    s_add_u32 s64, s69, 0
    buffer_load_dwordx4 v[96:99], v8, s[32:35], s64 offen offset:0 sc1
    buffer_load_dword v100, v9, s[32:35], s64 offen offset:1024 sc1
    buffer_load_dwordx4 v[104:107], v8, s[32:35], s64 offen offset:1280 sc1
    buffer_load_dword v108, v9, s[32:35], s64 offen offset:2304 sc1
    s_add_u32 s64, s69, 2560
    buffer_load_dwordx4 v[112:115], v8, s[32:35], s64 offen offset:0 sc1
    buffer_load_dword v116, v9, s[32:35], s64 offen offset:1024 sc1
    buffer_load_dwordx4 v[120:123], v8, s[32:35], s64 offen offset:1280 sc1
    buffer_load_dword v124, v9, s[32:35], s64 offen offset:2304 sc1
    s_add_u32 s69, s69, 40960
    s_waitcnt vmcnt(6)
    v_mfma_f32_16x16x32_bf16 v[144:147], v[26:29], v[96:99], 0
    v_mfma_f32_16x16x32_bf16 v[144:147], v[30:33], v[100:103], v[144:147]
    v_mfma_f32_16x16x32_bf16 v[128:131], v[20:23], v[96:99], 0
    v_mfma_f32_16x16x32_bf16 v[128:131], v[24:27], v[100:103], v[128:131]
    v_mfma_f32_16x16x32_bf16 v[160:163], v[32:35], v[96:99], 0
    v_mfma_f32_16x16x32_bf16 v[160:163], v[36:39], v[100:103], v[160:163]
    s_waitcnt vmcnt(4)
    v_mfma_f32_16x16x32_bf16 v[148:151], v[26:29], v[104:107], 0
    v_mfma_f32_16x16x32_bf16 v[148:151], v[30:33], v[108:111], v[148:151]
    v_mfma_f32_16x16x32_bf16 v[132:135], v[20:23], v[104:107], 0
    v_mfma_f32_16x16x32_bf16 v[132:135], v[24:27], v[108:111], v[132:135]
    v_mfma_f32_16x16x32_bf16 v[160:163], v[38:41], v[104:107], v[160:163]
    v_mfma_f32_16x16x32_bf16 v[160:163], v[42:45], v[108:111], v[160:163]
    s_waitcnt vmcnt(2)
    v_mfma_f32_16x16x32_bf16 v[152:155], v[26:29], v[112:115], 0
    v_mfma_f32_16x16x32_bf16 v[152:155], v[30:33], v[116:119], v[152:155]
    v_mfma_f32_16x16x32_bf16 v[136:139], v[20:23], v[112:115], 0
    v_mfma_f32_16x16x32_bf16 v[136:139], v[24:27], v[116:119], v[136:139]
    v_mfma_f32_16x16x32_bf16 v[160:163], v[44:47], v[112:115], v[160:163]
    v_mfma_f32_16x16x32_bf16 v[160:163], v[48:51], v[116:119], v[160:163]
    s_waitcnt vmcnt(0)
    v_mfma_f32_16x16x32_bf16 v[156:159], v[26:29], v[120:123], 0
    v_mfma_f32_16x16x32_bf16 v[156:159], v[30:33], v[124:127], v[156:159]
    v_mfma_f32_16x16x32_bf16 v[140:143], v[20:23], v[120:123], 0
    v_mfma_f32_16x16x32_bf16 v[140:143], v[24:27], v[124:127], v[140:143]
    v_mfma_f32_16x16x32_bf16 v[160:163], v[50:53], v[120:123], v[160:163]
    v_mfma_f32_16x16x32_bf16 v[160:163], v[54:57], v[124:127], v[160:163]
    s_nop 1
    v_add_f32 v144, 0x358637bd, v144
    v_add_f32 v148, 0x358637bd, v148
    v_add_f32 v152, 0x358637bd, v152
    v_add_f32 v156, 0x358637bd, v156
    v_rcp_f32 v144, v144
    v_rcp_f32 v148, v148
    v_rcp_f32 v152, v152
    v_rcp_f32 v156, v156
    v_mul_f32 v128, v128, v144
    v_mul_f32 v129, v129, v144
    v_mul_f32 v130, v130, v144
    v_mul_f32 v131, v131, v144
    v_cvt_pk_bf16_f32 v164, v128, v129
    v_cvt_pk_bf16_f32 v165, v130, v131
    v_mul_f32 v132, v132, v148
    v_mul_f32 v133, v133, v148
    v_mul_f32 v134, v134, v148
    v_mul_f32 v135, v135, v148
    v_cvt_pk_bf16_f32 v166, v132, v133
    v_cvt_pk_bf16_f32 v167, v134, v135
    v_mul_f32 v136, v136, v152
    v_mul_f32 v137, v137, v152
    v_mul_f32 v138, v138, v152
    v_mul_f32 v139, v139, v152
    v_cvt_pk_bf16_f32 v168, v136, v137
    v_cvt_pk_bf16_f32 v169, v138, v139
    v_mul_f32 v140, v140, v156
    v_mul_f32 v141, v141, v156
    v_mul_f32 v142, v142, v156
    v_mul_f32 v143, v143, v156
    v_cvt_pk_bf16_f32 v170, v140, v141
    v_cvt_pk_bf16_f32 v171, v142, v143
    v_cndmask_b32 v144, v144, v148, s[42:43]
    v_cndmask_b32 v144, v144, v152, s[44:45]
    v_cndmask_b32 v144, v144, v156, s[46:47]
    v_mul_f32 v160, v160, v144
    v_mul_f32 v161, v161, v144
    v_mul_f32 v162, v162, v144
    v_mul_f32 v163, v163, v144
    v_cvt_pk_bf16_f32 v172, v160, v161
    v_cvt_pk_bf16_f32 v173, v162, v163
    buffer_store_dwordx4 v[164:167], v15, s[32:35], s67 offen sc1
    buffer_store_dwordx4 v[168:171], v15, s[32:35], s67 offen offset:1024 sc1
    buffer_store_dwordx2 v[172:173], v16, s[32:35], s67 offen offset:2048 sc1
    s_add_u32 s67, s67, 655360
    s_add_u32 s70, s70, 1
    s_cmp_lt_u32 s70, 4
    s_cbranch_scc1 L_a_p2
    s_waitcnt vmcnt(0)
    s_barrier
    v_mov_b32 v12, 1
    buffer_store_dword v12, v10, s[32:35], 0 offen sc1
    buffer_store_dword v12, v92, s[32:35], 0 offen
    s_mov_b32 s40, s10
    s_and_b32 s41, s11, 0xffff
    s_mov_b32 s42, 0xc8000
    s_mov_b32 s43, 0x20000
    s_mov_b32 s44, s26
    s_and_b32 s45, s27, 0xffff
    s_mov_b32 s46, 0x500000
    s_mov_b32 s47, 0x20000
    s_and_b32 s68, s57, 3
    v_bfe_u32 v12, v0, 3, 2
    v_lshrrev_b32 v13, 5, v0
    v_mad_u32_u24 v14, v13, 20, v12
    v_mul_u32_u24 v14, 1280, v14
    v_and_b32 v12, 2, v12
    s_and_b32 s65, s57, 1
    s_lshl_b32 s65, s65, 2
    v_or_b32 v12, s65, v12
    v_and_b32 v15, 7, v0
    v_xor_b32 v12, v12, v15
    v_lshl_add_u32 v14, v12, 4, v14
    s_lshr_b32 s70, s57, 2
    s_mul_i32 s65, s70, 640
    s_mul_i32 s64, s68, 5120
    s_add_u32 s64, s64, s65
    v_add_u32 v1, s64, v14
    s_mul_i32 s64, s68, 51200
    s_add_u32 s64, s64, s65
    s_add_u32 s64, s64, 20480
    v_add_u32 v2, s64, v14
    s_mul_i32 s67, s63, 81920
    s_add_u32 s67, s67, 0xac00000
    s_lshr_b32 s65, s68, 1
    s_mul_i32 s65, s65, 2560
    s_and_b32 s64, s68, 1
    s_lshl_b32 s64, s64, 10
    s_add_u32 s65, s65, s64
    v_lshl_add_u32 v3, v0, 4, s65
    v_mul_u32_u24 v14, 2560, v13
    v_and_b32 v15, 31, v0
    v_lshl_add_u32 v14, v15, 4, v14
    s_mul_i32 s65, s68, 5120
    s_add_u32 s65, s65, 2048
    v_add_u32 v4, s65, v14
    v_lshlrev_b32 v5, 4, v0
    v_lshlrev_b32 v6, 10, v18
    v_lshl_add_u32 v6, v19, 3, v6
    v_bfe_u32 v13, v0, 2, 2
    v_and_b32 v14, 2, v13
    v_and_b32 v15, 1, v18
    v_lshl_or_b32 v14, v15, 2, v14
    v_bfe_u32 v15, v0, 1, 1
    v_or_b32 v14, v14, v15
    v_lshlrev_b32 v14, 4, v14
    v_lshl_add_u32 v14, v18, 10, v14
    v_lshl_add_u32 v14, v13, 7, v14
    v_and_b32 v15, 1, v0
    v_lshl_add_u32 v14, v15, 3, v14
    s_mul_i32 s65, s57, 5
    s_add_u32 s65, s65, 0
    s_and_b32 s64, s65, 3
    s_lshl_b32 s64, s64, 5
    s_lshr_b32 s65, s65, 2
    s_lshl_b32 s65, s65, 12
    s_or_b32 s65, s65, s64
    v_xor_b32 v20, s65, v14
    s_mul_i32 s65, s57, 5
    s_add_u32 s65, s65, 1
    s_and_b32 s64, s65, 3
    s_lshl_b32 s64, s64, 5
    s_lshr_b32 s65, s65, 2
    s_lshl_b32 s65, s65, 12
    s_or_b32 s65, s65, s64
    v_xor_b32 v21, s65, v14
    s_mul_i32 s65, s57, 5
    s_add_u32 s65, s65, 2
    s_and_b32 s64, s65, 3
    s_lshl_b32 s64, s64, 5
    s_lshr_b32 s65, s65, 2
    s_lshl_b32 s65, s65, 12
    s_or_b32 s65, s65, s64
    v_xor_b32 v22, s65, v14
    s_mul_i32 s65, s57, 5
    s_add_u32 s65, s65, 3
    s_and_b32 s64, s65, 3
    s_lshl_b32 s64, s64, 5
    s_lshr_b32 s65, s65, 2
    s_lshl_b32 s65, s65, 12
    s_or_b32 s65, s65, s64
    v_xor_b32 v23, s65, v14
    s_mul_i32 s65, s57, 5
    s_add_u32 s65, s65, 4
    s_and_b32 s64, s65, 3
    s_lshl_b32 s64, s64, 5
    s_lshr_b32 s65, s65, 2
    s_lshl_b32 s65, s65, 12
    s_or_b32 s65, s65, s64
    v_xor_b32 v24, s65, v14
    v_and_b32 v14, 1, v18
    v_lshl_add_u32 v14, v14, 4, v19
    v_mul_u32_u24 v14, 2560, v14
    v_lshrrev_b32 v15, 1, v18
    v_lshl_add_u32 v14, v15, 4, v14
    s_mul_i32 s65, s63, 163840
    s_mul_i32 s64, s57, 160
    s_add_u32 s65, s65, s64
    v_add_u32 v7, s65, v14
    s_lshl_b32 s68, s68, 10
    s_mul_i32 s70, s70, 20480
    s_add_u32 s70, s70, s68
    s_mov_b32 s65, 1
    s_cmp_lg_u32 s57, 0
    s_cbranch_scc1 L_a_go
    s_mov_b64 exec, 0xffffffff
L_a_w1:
    buffer_load_dword v12, v11, s[32:35], 0 offen sc1
    s_waitcnt vmcnt(0)
    v_cmp_gt_i32 vcc, s65, v12
    s_cbranch_vccnz L_retry_61
L_ok_62:
    s_mov_b64 exec, -1
L_a_go:
    s_barrier
    s_lshl_b32 s66, s62, 2
    s_add_u32 m0, s70, 0
    s_add_u32 s69, s66, 0
    s_and_b32 s69, s69, 15
    s_mul_i32 s64, s69, 51200
    buffer_load_dwordx4 v1, s[40:43], s64 offen offset:0 lds
    s_add_u32 m0, m0, 3968
    s_nop 0
    buffer_load_dwordx4 v1, s[40:43], s64 offen offset:128 lds
    s_add_u32 m0, m0, 3968
    s_nop 0
    buffer_load_dwordx4 v1, s[40:43], s64 offen offset:256 lds
    s_add_u32 m0, m0, 3968
    s_nop 0
    buffer_load_dwordx4 v1, s[40:43], s64 offen offset:384 lds
    s_add_u32 m0, m0, 3968
    s_nop 0
    buffer_load_dwordx4 v1, s[40:43], s64 offen offset:512 lds
    s_cmp_ge_u32 s57, 4
    s_cbranch_scc1 L_a_no0
    s_add_u32 m0, s68, 40960
    s_mul_i32 s64, s69, 5120
    s_add_u32 s64, s64, s67
    buffer_load_dwordx4 v3, s[32:35], s64 offen sc1 lds
L_a_no0:
    s_add_u32 m0, s70, 45056
    s_add_u32 s69, s66, 1
    s_and_b32 s69, s69, 15
    s_mul_i32 s64, s69, 51200
    buffer_load_dwordx4 v1, s[40:43], s64 offen offset:0 lds
    s_add_u32 m0, m0, 3968
    s_nop 0
    buffer_load_dwordx4 v1, s[40:43], s64 offen offset:128 lds
    s_add_u32 m0, m0, 3968
    s_nop 0
    buffer_load_dwordx4 v1, s[40:43], s64 offen offset:256 lds
    s_add_u32 m0, m0, 3968
    s_nop 0
    buffer_load_dwordx4 v1, s[40:43], s64 offen offset:384 lds
    s_add_u32 m0, m0, 3968
    s_nop 0
    buffer_load_dwordx4 v1, s[40:43], s64 offen offset:512 lds
    s_cmp_ge_u32 s57, 4
    s_cbranch_scc1 L_a_no1
    s_add_u32 m0, s68, 86016
    s_mul_i32 s64, s69, 5120
    s_add_u32 s64, s64, s67
    buffer_load_dwordx4 v3, s[32:35], s64 offen sc1 lds
L_a_no1:
    s_waitcnt vmcnt(5)
    s_barrier
    ds_read_b64 v[48:49], v5 offset:40960
    ds_read_b64 v[50:51], v5 offset:43008
    ds_read_b64 v[52:53], v5 offset:40968
    ds_read_b64 v[54:55], v5 offset:43016
    ds_read_b64 v[56:57], v5 offset:41984
    ds_read_b64 v[58:59], v5 offset:44032
    ds_read_b64 v[60:61], v5 offset:41992
    ds_read_b64 v[62:63], v5 offset:44040
    ds_read_b64_tr_b16 v[28:29], v20 offset:0
    ds_read_b64_tr_b16 v[30:31], v20 offset:512
    ds_read_b64_tr_b16 v[32:33], v21 offset:0
    ds_read_b64_tr_b16 v[34:35], v21 offset:512
    ds_read_b64_tr_b16 v[36:37], v22 offset:0
    ds_read_b64_tr_b16 v[38:39], v22 offset:512
    s_add_u32 m0, s70, 90112
    s_add_u32 s69, s66, 2
    s_and_b32 s69, s69, 15
    s_mul_i32 s64, s69, 51200
    buffer_load_dwordx4 v1, s[40:43], s64 offen offset:0 lds
    s_add_u32 m0, m0, 3968
    s_nop 0
    buffer_load_dwordx4 v1, s[40:43], s64 offen offset:128 lds
    s_add_u32 m0, m0, 3968
    s_nop 0
    buffer_load_dwordx4 v1, s[40:43], s64 offen offset:256 lds
    s_add_u32 m0, m0, 3968
    s_nop 0
    buffer_load_dwordx4 v1, s[40:43], s64 offen offset:384 lds
    s_add_u32 m0, m0, 3968
    s_nop 0
    buffer_load_dwordx4 v1, s[40:43], s64 offen offset:512 lds
    s_cmp_ge_u32 s57, 4
    s_cbranch_scc1 L_a_no2
    s_add_u32 m0, s68, 131072
    s_mul_i32 s64, s69, 5120
    s_add_u32 s64, s64, s67
    buffer_load_dwordx4 v3, s[32:35], s64 offen sc1 lds
L_a_no2:
    s_waitcnt lgkmcnt(4)
    v_mfma_f32_16x16x32_bf16 v[64:67], v[28:31], v[48:51], 0
    ds_read_b64_tr_b16 v[40:41], v23 offset:0
    ds_read_b64_tr_b16 v[42:43], v23 offset:512
    v_mfma_f32_16x16x32_bf16 v[68:71], v[28:31], v[52:55], 0
    v_mfma_f32_16x16x32_bf16 v[72:75], v[28:31], v[56:59], 0
    v_mfma_f32_16x16x32_bf16 v[76:79], v[28:31], v[60:63], 0
    s_waitcnt lgkmcnt(4)
    v_mfma_f32_16x16x32_bf16 v[80:83], v[32:35], v[48:51], 0
    ds_read_b64_tr_b16 v[44:45], v24 offset:0
    ds_read_b64_tr_b16 v[46:47], v24 offset:512
    v_mfma_f32_16x16x32_bf16 v[84:87], v[32:35], v[52:55], 0
    v_mfma_f32_16x16x32_bf16 v[88:91], v[32:35], v[56:59], 0
    v_mfma_f32_16x16x32_bf16 v[92:95], v[32:35], v[60:63], 0
    s_waitcnt lgkmcnt(4)
    v_mfma_f32_16x16x32_bf16 v[96:99], v[36:39], v[48:51], 0
    v_mfma_f32_16x16x32_bf16 v[100:103], v[36:39], v[52:55], 0
    v_mfma_f32_16x16x32_bf16 v[104:107], v[36:39], v[56:59], 0
    v_mfma_f32_16x16x32_bf16 v[108:111], v[36:39], v[60:63], 0
    s_waitcnt lgkmcnt(2)
    v_mfma_f32_16x16x32_bf16 v[112:115], v[40:43], v[48:51], 0
    v_mfma_f32_16x16x32_bf16 v[116:119], v[40:43], v[52:55], 0
    v_mfma_f32_16x16x32_bf16 v[120:123], v[40:43], v[56:59], 0
    v_mfma_f32_16x16x32_bf16 v[124:127], v[40:43], v[60:63], 0
    s_waitcnt lgkmcnt(0)
    v_mfma_f32_16x16x32_bf16 v[128:131], v[44:47], v[48:51], 0
    v_mfma_f32_16x16x32_bf16 v[132:135], v[44:47], v[52:55], 0
    v_mfma_f32_16x16x32_bf16 v[136:139], v[44:47], v[56:59], 0
    v_mfma_f32_16x16x32_bf16 v[140:143], v[44:47], v[60:63], 0
    v_add_u32 v5, 45056, v5
    v_add_u32 v6, 45056, v6
    v_add_u32 v20, 45056, v20
    v_add_u32 v21, 45056, v21
    v_add_u32 v22, 45056, v22
    v_add_u32 v23, 45056, v23
    v_add_u32 v24, 45056, v24
    s_waitcnt vmcnt(5)
    s_barrier
    ds_read_b64 v[48:49], v5 offset:40960
    ds_read_b64 v[50:51], v5 offset:43008
    ds_read_b64 v[52:53], v5 offset:40968
    ds_read_b64 v[54:55], v5 offset:43016
    ds_read_b64 v[56:57], v5 offset:41984
    ds_read_b64 v[58:59], v5 offset:44032
    ds_read_b64 v[60:61], v5 offset:41992
    ds_read_b64 v[62:63], v5 offset:44040
    ds_read_b64_tr_b16 v[28:29], v20 offset:0
    ds_read_b64_tr_b16 v[30:31], v20 offset:512
    ds_read_b64_tr_b16 v[32:33], v21 offset:0
    ds_read_b64_tr_b16 v[34:35], v21 offset:512
    ds_read_b64_tr_b16 v[36:37], v22 offset:0
    ds_read_b64_tr_b16 v[38:39], v22 offset:512
    s_add_u32 m0, s70, 0
    s_add_u32 s69, s66, 3
    s_and_b32 s69, s69, 15
    s_mul_i32 s64, s69, 51200
    buffer_load_dwordx4 v1, s[40:43], s64 offen offset:0 lds
    s_add_u32 m0, m0, 3968
    s_nop 0
    buffer_load_dwordx4 v1, s[40:43], s64 offen offset:128 lds
    s_add_u32 m0, m0, 3968
    s_nop 0
    buffer_load_dwordx4 v1, s[40:43], s64 offen offset:256 lds
    s_add_u32 m0, m0, 3968
    s_nop 0
    buffer_load_dwordx4 v1, s[40:43], s64 offen offset:384 lds
    s_add_u32 m0, m0, 3968
    s_nop 0
    buffer_load_dwordx4 v1, s[40:43], s64 offen offset:512 lds
    s_cmp_ge_u32 s57, 4
    s_cbranch_scc1 L_a_no3
    s_add_u32 m0, s68, 40960
    s_mul_i32 s64, s69, 5120
    s_add_u32 s64, s64, s67
    buffer_load_dwordx4 v3, s[32:35], s64 offen sc1 lds
L_a_no3:
    s_waitcnt lgkmcnt(4)
    v_mfma_f32_16x16x32_bf16 v[64:67], v[28:31], v[48:51], v[64:67]
    ds_read_b64_tr_b16 v[40:41], v23 offset:0
    ds_read_b64_tr_b16 v[42:43], v23 offset:512
    v_mfma_f32_16x16x32_bf16 v[68:71], v[28:31], v[52:55], v[68:71]
    v_mfma_f32_16x16x32_bf16 v[72:75], v[28:31], v[56:59], v[72:75]
    v_mfma_f32_16x16x32_bf16 v[76:79], v[28:31], v[60:63], v[76:79]
    s_waitcnt lgkmcnt(4)
    v_mfma_f32_16x16x32_bf16 v[80:83], v[32:35], v[48:51], v[80:83]
    ds_read_b64_tr_b16 v[44:45], v24 offset:0
    ds_read_b64_tr_b16 v[46:47], v24 offset:512
    v_mfma_f32_16x16x32_bf16 v[84:87], v[32:35], v[52:55], v[84:87]
    v_mfma_f32_16x16x32_bf16 v[88:91], v[32:35], v[56:59], v[88:91]
    v_mfma_f32_16x16x32_bf16 v[92:95], v[32:35], v[60:63], v[92:95]
    s_waitcnt lgkmcnt(4)
    v_mfma_f32_16x16x32_bf16 v[96:99], v[36:39], v[48:51], v[96:99]
    v_mfma_f32_16x16x32_bf16 v[100:103], v[36:39], v[52:55], v[100:103]
    v_mfma_f32_16x16x32_bf16 v[104:107], v[36:39], v[56:59], v[104:107]
    v_mfma_f32_16x16x32_bf16 v[108:111], v[36:39], v[60:63], v[108:111]
    s_waitcnt lgkmcnt(2)
    v_mfma_f32_16x16x32_bf16 v[112:115], v[40:43], v[48:51], v[112:115]
    v_mfma_f32_16x16x32_bf16 v[116:119], v[40:43], v[52:55], v[116:119]
    v_mfma_f32_16x16x32_bf16 v[120:123], v[40:43], v[56:59], v[120:123]
    v_mfma_f32_16x16x32_bf16 v[124:127], v[40:43], v[60:63], v[124:127]
    s_waitcnt lgkmcnt(0)
    v_mfma_f32_16x16x32_bf16 v[128:131], v[44:47], v[48:51], v[128:131]
    v_mfma_f32_16x16x32_bf16 v[132:135], v[44:47], v[52:55], v[132:135]
    v_mfma_f32_16x16x32_bf16 v[136:139], v[44:47], v[56:59], v[136:139]
    v_mfma_f32_16x16x32_bf16 v[140:143], v[44:47], v[60:63], v[140:143]
    v_add_u32 v5, 45056, v5
    v_add_u32 v6, 45056, v6
    v_add_u32 v20, 45056, v20
    v_add_u32 v21, 45056, v21
    v_add_u32 v22, 45056, v22
    v_add_u32 v23, 45056, v23
    v_add_u32 v24, 45056, v24
    s_waitcnt vmcnt(5)
    s_barrier
    ds_read_b64 v[48:49], v5 offset:40960
    ds_read_b64 v[50:51], v5 offset:43008
    ds_read_b64 v[52:53], v5 offset:40968
    ds_read_b64 v[54:55], v5 offset:43016
    ds_read_b64 v[56:57], v5 offset:41984
    ds_read_b64 v[58:59], v5 offset:44032
    ds_read_b64 v[60:61], v5 offset:41992
    ds_read_b64 v[62:63], v5 offset:44040
    ds_read_b64_tr_b16 v[28:29], v20 offset:0
    ds_read_b64_tr_b16 v[30:31], v20 offset:512
    ds_read_b64_tr_b16 v[32:33], v21 offset:0
    ds_read_b64_tr_b16 v[34:35], v21 offset:512
    ds_read_b64_tr_b16 v[36:37], v22 offset:0
    ds_read_b64_tr_b16 v[38:39], v22 offset:512
    s_add_u32 m0, s70, 45056
    s_add_u32 s69, s66, 4
    s_and_b32 s69, s69, 15
    s_mul_i32 s64, s69, 51200
    buffer_load_dwordx4 v1, s[40:43], s64 offen offset:0 lds
    s_add_u32 m0, m0, 3968
    s_nop 0
    buffer_load_dwordx4 v1, s[40:43], s64 offen offset:128 lds
    s_add_u32 m0, m0, 3968
    s_nop 0
    buffer_load_dwordx4 v1, s[40:43], s64 offen offset:256 lds
    s_add_u32 m0, m0, 3968
    s_nop 0
    buffer_load_dwordx4 v1, s[40:43], s64 offen offset:384 lds
    s_add_u32 m0, m0, 3968
    s_nop 0
    buffer_load_dwordx4 v1, s[40:43], s64 offen offset:512 lds
    s_cmp_ge_u32 s57, 4
    s_cbranch_scc1 L_a_no4
    s_add_u32 m0, s68, 86016
    s_mul_i32 s64, s69, 5120
    s_add_u32 s64, s64, s67
    buffer_load_dwordx4 v3, s[32:35], s64 offen sc1 lds
L_a_no4:
    s_waitcnt lgkmcnt(4)
    v_mfma_f32_16x16x32_bf16 v[64:67], v[28:31], v[48:51], v[64:67]
    ds_read_b64_tr_b16 v[40:41], v23 offset:0
    ds_read_b64_tr_b16 v[42:43], v23 offset:512
    v_mfma_f32_16x16x32_bf16 v[68:71], v[28:31], v[52:55], v[68:71]
    v_mfma_f32_16x16x32_bf16 v[72:75], v[28:31], v[56:59], v[72:75]
    v_mfma_f32_16x16x32_bf16 v[76:79], v[28:31], v[60:63], v[76:79]
    s_waitcnt lgkmcnt(4)
    v_mfma_f32_16x16x32_bf16 v[80:83], v[32:35], v[48:51], v[80:83]
    ds_read_b64_tr_b16 v[44:45], v24 offset:0
    ds_read_b64_tr_b16 v[46:47], v24 offset:512
    v_mfma_f32_16x16x32_bf16 v[84:87], v[32:35], v[52:55], v[84:87]
    v_mfma_f32_16x16x32_bf16 v[88:91], v[32:35], v[56:59], v[88:91]
    v_mfma_f32_16x16x32_bf16 v[92:95], v[32:35], v[60:63], v[92:95]
    s_waitcnt lgkmcnt(4)
    v_mfma_f32_16x16x32_bf16 v[96:99], v[36:39], v[48:51], v[96:99]
    v_mfma_f32_16x16x32_bf16 v[100:103], v[36:39], v[52:55], v[100:103]
    v_mfma_f32_16x16x32_bf16 v[104:107], v[36:39], v[56:59], v[104:107]
    v_mfma_f32_16x16x32_bf16 v[108:111], v[36:39], v[60:63], v[108:111]
    s_waitcnt lgkmcnt(2)
    v_mfma_f32_16x16x32_bf16 v[112:115], v[40:43], v[48:51], v[112:115]
    v_mfma_f32_16x16x32_bf16 v[116:119], v[40:43], v[52:55], v[116:119]
    v_mfma_f32_16x16x32_bf16 v[120:123], v[40:43], v[56:59], v[120:123]
    v_mfma_f32_16x16x32_bf16 v[124:127], v[40:43], v[60:63], v[124:127]
    s_waitcnt lgkmcnt(0)
    v_mfma_f32_16x16x32_bf16 v[128:131], v[44:47], v[48:51], v[128:131]
    v_mfma_f32_16x16x32_bf16 v[132:135], v[44:47], v[52:55], v[132:135]
    v_mfma_f32_16x16x32_bf16 v[136:139], v[44:47], v[56:59], v[136:139]
    v_mfma_f32_16x16x32_bf16 v[140:143], v[44:47], v[60:63], v[140:143]
    v_subrev_u32 v5, 90112, v5
    v_subrev_u32 v6, 90112, v6
    v_subrev_u32 v20, 90112, v20
    v_subrev_u32 v21, 90112, v21
    v_subrev_u32 v22, 90112, v22
    v_subrev_u32 v23, 90112, v23
    v_subrev_u32 v24, 90112, v24
    s_waitcnt vmcnt(5)
    s_barrier
    ds_read_b64 v[48:49], v5 offset:40960
    ds_read_b64 v[50:51], v5 offset:43008
    ds_read_b64 v[52:53], v5 offset:40968
    ds_read_b64 v[54:55], v5 offset:43016
    ds_read_b64 v[56:57], v5 offset:41984
    ds_read_b64 v[58:59], v5 offset:44032
    ds_read_b64 v[60:61], v5 offset:41992
    ds_read_b64 v[62:63], v5 offset:44040
    ds_read_b64_tr_b16 v[28:29], v20 offset:0
    ds_read_b64_tr_b16 v[30:31], v20 offset:512
    ds_read_b64_tr_b16 v[32:33], v21 offset:0
    ds_read_b64_tr_b16 v[34:35], v21 offset:512
    ds_read_b64_tr_b16 v[36:37], v22 offset:0
    ds_read_b64_tr_b16 v[38:39], v22 offset:512
    s_add_u32 m0, s70, 90112
    s_add_u32 s69, s66, 5
    s_and_b32 s69, s69, 15
    s_mul_i32 s64, s69, 51200
    buffer_load_dwordx4 v1, s[40:43], s64 offen offset:0 lds
    s_add_u32 m0, m0, 3968
    s_nop 0
    buffer_load_dwordx4 v1, s[40:43], s64 offen offset:128 lds
    s_add_u32 m0, m0, 3968
    s_nop 0
    buffer_load_dwordx4 v1, s[40:43], s64 offen offset:256 lds
    s_add_u32 m0, m0, 3968
    s_nop 0
    buffer_load_dwordx4 v1, s[40:43], s64 offen offset:384 lds
    s_add_u32 m0, m0, 3968
    s_nop 0
    buffer_load_dwordx4 v1, s[40:43], s64 offen offset:512 lds
    s_cmp_ge_u32 s57, 4
    s_cbranch_scc1 L_a_no5
    s_add_u32 m0, s68, 131072
    s_mul_i32 s64, s69, 5120
    s_add_u32 s64, s64, s67
    buffer_load_dwordx4 v3, s[32:35], s64 offen sc1 lds
L_a_no5:
    s_waitcnt lgkmcnt(4)
    v_mfma_f32_16x16x32_bf16 v[64:67], v[28:31], v[48:51], v[64:67]
    ds_read_b64_tr_b16 v[40:41], v23 offset:0
    ds_read_b64_tr_b16 v[42:43], v23 offset:512
    v_mfma_f32_16x16x32_bf16 v[68:71], v[28:31], v[52:55], v[68:71]
    v_mfma_f32_16x16x32_bf16 v[72:75], v[28:31], v[56:59], v[72:75]
    v_mfma_f32_16x16x32_bf16 v[76:79], v[28:31], v[60:63], v[76:79]
    s_waitcnt lgkmcnt(4)
    v_mfma_f32_16x16x32_bf16 v[80:83], v[32:35], v[48:51], v[80:83]
    ds_read_b64_tr_b16 v[44:45], v24 offset:0
    ds_read_b64_tr_b16 v[46:47], v24 offset:512
    v_mfma_f32_16x16x32_bf16 v[84:87], v[32:35], v[52:55], v[84:87]
    v_mfma_f32_16x16x32_bf16 v[88:91], v[32:35], v[56:59], v[88:91]
    v_mfma_f32_16x16x32_bf16 v[92:95], v[32:35], v[60:63], v[92:95]
    s_waitcnt lgkmcnt(4)
    v_mfma_f32_16x16x32_bf16 v[96:99], v[36:39], v[48:51], v[96:99]
    v_mfma_f32_16x16x32_bf16 v[100:103], v[36:39], v[52:55], v[100:103]
    v_mfma_f32_16x16x32_bf16 v[104:107], v[36:39], v[56:59], v[104:107]
    v_mfma_f32_16x16x32_bf16 v[108:111], v[36:39], v[60:63], v[108:111]
    s_waitcnt lgkmcnt(2)
    v_mfma_f32_16x16x32_bf16 v[112:115], v[40:43], v[48:51], v[112:115]
    v_mfma_f32_16x16x32_bf16 v[116:119], v[40:43], v[52:55], v[116:119]
    v_mfma_f32_16x16x32_bf16 v[120:123], v[40:43], v[56:59], v[120:123]
    v_mfma_f32_16x16x32_bf16 v[124:127], v[40:43], v[60:63], v[124:127]
    s_waitcnt lgkmcnt(0)
    v_mfma_f32_16x16x32_bf16 v[128:131], v[44:47], v[48:51], v[128:131]
    v_mfma_f32_16x16x32_bf16 v[132:135], v[44:47], v[52:55], v[132:135]
    v_mfma_f32_16x16x32_bf16 v[136:139], v[44:47], v[56:59], v[136:139]
    v_mfma_f32_16x16x32_bf16 v[140:143], v[44:47], v[60:63], v[140:143]
    v_add_u32 v5, 45056, v5
    v_add_u32 v6, 45056, v6
    v_add_u32 v20, 45056, v20
    v_add_u32 v21, 45056, v21
    v_add_u32 v22, 45056, v22
    v_add_u32 v23, 45056, v23
    v_add_u32 v24, 45056, v24
    s_waitcnt vmcnt(5)
    s_barrier
    ds_read_b64 v[48:49], v5 offset:40960
    ds_read_b64 v[50:51], v5 offset:43008
    ds_read_b64 v[52:53], v5 offset:40968
    ds_read_b64 v[54:55], v5 offset:43016
    ds_read_b64 v[56:57], v5 offset:41984
    ds_read_b64 v[58:59], v5 offset:44032
    ds_read_b64 v[60:61], v5 offset:41992
    ds_read_b64 v[62:63], v5 offset:44040
    ds_read_b64_tr_b16 v[28:29], v20 offset:0
    ds_read_b64_tr_b16 v[30:31], v20 offset:512
    ds_read_b64_tr_b16 v[32:33], v21 offset:0
    ds_read_b64_tr_b16 v[34:35], v21 offset:512
    ds_read_b64_tr_b16 v[36:37], v22 offset:0
    ds_read_b64_tr_b16 v[38:39], v22 offset:512
    s_add_u32 m0, s70, 0
    s_add_u32 s69, s66, 6
    s_and_b32 s69, s69, 15
    s_mul_i32 s64, s69, 51200
    buffer_load_dwordx4 v1, s[40:43], s64 offen offset:0 lds
    s_add_u32 m0, m0, 3968
    s_nop 0
    buffer_load_dwordx4 v1, s[40:43], s64 offen offset:128 lds
    s_add_u32 m0, m0, 3968
    s_nop 0
    buffer_load_dwordx4 v1, s[40:43], s64 offen offset:256 lds
    s_add_u32 m0, m0, 3968
    s_nop 0
    buffer_load_dwordx4 v1, s[40:43], s64 offen offset:384 lds
    s_add_u32 m0, m0, 3968
    s_nop 0
    buffer_load_dwordx4 v1, s[40:43], s64 offen offset:512 lds
    s_cmp_ge_u32 s57, 4
    s_cbranch_scc1 L_a_no6
    s_add_u32 m0, s68, 40960
    s_mul_i32 s64, s69, 5120
    s_add_u32 s64, s64, s67
    buffer_load_dwordx4 v3, s[32:35], s64 offen sc1 lds
L_a_no6:
    s_waitcnt lgkmcnt(4)
    v_mfma_f32_16x16x32_bf16 v[64:67], v[28:31], v[48:51], v[64:67]
    ds_read_b64_tr_b16 v[40:41], v23 offset:0
    ds_read_b64_tr_b16 v[42:43], v23 offset:512
    v_mfma_f32_16x16x32_bf16 v[68:71], v[28:31], v[52:55], v[68:71]
    v_mfma_f32_16x16x32_bf16 v[72:75], v[28:31], v[56:59], v[72:75]
    v_mfma_f32_16x16x32_bf16 v[76:79], v[28:31], v[60:63], v[76:79]
    s_waitcnt lgkmcnt(4)
    v_mfma_f32_16x16x32_bf16 v[80:83], v[32:35], v[48:51], v[80:83]
    ds_read_b64_tr_b16 v[44:45], v24 offset:0
    ds_read_b64_tr_b16 v[46:47], v24 offset:512
    v_mfma_f32_16x16x32_bf16 v[84:87], v[32:35], v[52:55], v[84:87]
    v_mfma_f32_16x16x32_bf16 v[88:91], v[32:35], v[56:59], v[88:91]
    v_mfma_f32_16x16x32_bf16 v[92:95], v[32:35], v[60:63], v[92:95]
    s_waitcnt lgkmcnt(4)
    v_mfma_f32_16x16x32_bf16 v[96:99], v[36:39], v[48:51], v[96:99]
    v_mfma_f32_16x16x32_bf16 v[100:103], v[36:39], v[52:55], v[100:103]
    v_mfma_f32_16x16x32_bf16 v[104:107], v[36:39], v[56:59], v[104:107]
    v_mfma_f32_16x16x32_bf16 v[108:111], v[36:39], v[60:63], v[108:111]
    s_waitcnt lgkmcnt(2)
    v_mfma_f32_16x16x32_bf16 v[112:115], v[40:43], v[48:51], v[112:115]
    v_mfma_f32_16x16x32_bf16 v[116:119], v[40:43], v[52:55], v[116:119]
    v_mfma_f32_16x16x32_bf16 v[120:123], v[40:43], v[56:59], v[120:123]
    v_mfma_f32_16x16x32_bf16 v[124:127], v[40:43], v[60:63], v[124:127]
    s_waitcnt lgkmcnt(0)
    v_mfma_f32_16x16x32_bf16 v[128:131], v[44:47], v[48:51], v[128:131]
    v_mfma_f32_16x16x32_bf16 v[132:135], v[44:47], v[52:55], v[132:135]
    v_mfma_f32_16x16x32_bf16 v[136:139], v[44:47], v[56:59], v[136:139]
    v_mfma_f32_16x16x32_bf16 v[140:143], v[44:47], v[60:63], v[140:143]
    v_add_u32 v5, 45056, v5
    v_add_u32 v6, 45056, v6
    v_add_u32 v20, 45056, v20
    v_add_u32 v21, 45056, v21
    v_add_u32 v22, 45056, v22
    v_add_u32 v23, 45056, v23
    v_add_u32 v24, 45056, v24
    s_waitcnt vmcnt(5)
    s_barrier
    ds_read_b64 v[48:49], v5 offset:40960
    ds_read_b64 v[50:51], v5 offset:43008
    ds_read_b64 v[52:53], v5 offset:40968
    ds_read_b64 v[54:55], v5 offset:43016
    ds_read_b64 v[56:57], v5 offset:41984
    ds_read_b64 v[58:59], v5 offset:44032
    ds_read_b64 v[60:61], v5 offset:41992
    ds_read_b64 v[62:63], v5 offset:44040
    ds_read_b64_tr_b16 v[28:29], v20 offset:0
    ds_read_b64_tr_b16 v[30:31], v20 offset:512
    ds_read_b64_tr_b16 v[32:33], v21 offset:0
    ds_read_b64_tr_b16 v[34:35], v21 offset:512
    ds_read_b64_tr_b16 v[36:37], v22 offset:0
    ds_read_b64_tr_b16 v[38:39], v22 offset:512
    s_add_u32 m0, s70, 45056
    s_add_u32 s69, s66, 7
    s_and_b32 s69, s69, 15
    s_mul_i32 s64, s69, 51200
    buffer_load_dwordx4 v1, s[40:43], s64 offen offset:0 lds
    s_add_u32 m0, m0, 3968
    s_nop 0
    buffer_load_dwordx4 v1, s[40:43], s64 offen offset:128 lds
    s_add_u32 m0, m0, 3968
    s_nop 0
    buffer_load_dwordx4 v1, s[40:43], s64 offen offset:256 lds
    s_add_u32 m0, m0, 3968
    s_nop 0
    buffer_load_dwordx4 v1, s[40:43], s64 offen offset:384 lds
    s_add_u32 m0, m0, 3968
    s_nop 0
    buffer_load_dwordx4 v1, s[40:43], s64 offen offset:512 lds
    s_cmp_ge_u32 s57, 4
    s_cbranch_scc1 L_a_no7
    s_add_u32 m0, s68, 86016
    s_mul_i32 s64, s69, 5120
    s_add_u32 s64, s64, s67
    buffer_load_dwordx4 v3, s[32:35], s64 offen sc1 lds
L_a_no7:
    s_waitcnt lgkmcnt(4)
    v_mfma_f32_16x16x32_bf16 v[64:67], v[28:31], v[48:51], v[64:67]
    ds_read_b64_tr_b16 v[40:41], v23 offset:0
    ds_read_b64_tr_b16 v[42:43], v23 offset:512
    v_mfma_f32_16x16x32_bf16 v[68:71], v[28:31], v[52:55], v[68:71]
    v_mfma_f32_16x16x32_bf16 v[72:75], v[28:31], v[56:59], v[72:75]
    v_mfma_f32_16x16x32_bf16 v[76:79], v[28:31], v[60:63], v[76:79]
    s_waitcnt lgkmcnt(4)
    v_mfma_f32_16x16x32_bf16 v[80:83], v[32:35], v[48:51], v[80:83]
    ds_read_b64_tr_b16 v[44:45], v24 offset:0
    ds_read_b64_tr_b16 v[46:47], v24 offset:512
    v_mfma_f32_16x16x32_bf16 v[84:87], v[32:35], v[52:55], v[84:87]
    v_mfma_f32_16x16x32_bf16 v[88:91], v[32:35], v[56:59], v[88:91]
    v_mfma_f32_16x16x32_bf16 v[92:95], v[32:35], v[60:63], v[92:95]
    s_waitcnt lgkmcnt(4)
    v_mfma_f32_16x16x32_bf16 v[96:99], v[36:39], v[48:51], v[96:99]
    v_mfma_f32_16x16x32_bf16 v[100:103], v[36:39], v[52:55], v[100:103]
    v_mfma_f32_16x16x32_bf16 v[104:107], v[36:39], v[56:59], v[104:107]
    v_mfma_f32_16x16x32_bf16 v[108:111], v[36:39], v[60:63], v[108:111]
    s_waitcnt lgkmcnt(2)
    v_mfma_f32_16x16x32_bf16 v[112:115], v[40:43], v[48:51], v[112:115]
    v_mfma_f32_16x16x32_bf16 v[116:119], v[40:43], v[52:55], v[116:119]
    v_mfma_f32_16x16x32_bf16 v[120:123], v[40:43], v[56:59], v[120:123]
    v_mfma_f32_16x16x32_bf16 v[124:127], v[40:43], v[60:63], v[124:127]
    s_waitcnt lgkmcnt(0)
    v_mfma_f32_16x16x32_bf16 v[128:131], v[44:47], v[48:51], v[128:131]
    v_mfma_f32_16x16x32_bf16 v[132:135], v[44:47], v[52:55], v[132:135]
    v_mfma_f32_16x16x32_bf16 v[136:139], v[44:47], v[56:59], v[136:139]
    v_mfma_f32_16x16x32_bf16 v[140:143], v[44:47], v[60:63], v[140:143]
    v_subrev_u32 v5, 90112, v5
    v_subrev_u32 v6, 90112, v6
    v_subrev_u32 v20, 90112, v20
    v_subrev_u32 v21, 90112, v21
    v_subrev_u32 v22, 90112, v22
    v_subrev_u32 v23, 90112, v23
    v_subrev_u32 v24, 90112, v24
    s_waitcnt vmcnt(5)
    s_barrier
    ds_read_b64 v[48:49], v5 offset:40960
    ds_read_b64 v[50:51], v5 offset:43008
    ds_read_b64 v[52:53], v5 offset:40968
    ds_read_b64 v[54:55], v5 offset:43016
    ds_read_b64 v[56:57], v5 offset:41984
    ds_read_b64 v[58:59], v5 offset:44032
    ds_read_b64 v[60:61], v5 offset:41992
    ds_read_b64 v[62:63], v5 offset:44040
    ds_read_b64_tr_b16 v[28:29], v20 offset:0
    ds_read_b64_tr_b16 v[30:31], v20 offset:512
    ds_read_b64_tr_b16 v[32:33], v21 offset:0
    ds_read_b64_tr_b16 v[34:35], v21 offset:512
    ds_read_b64_tr_b16 v[36:37], v22 offset:0
    ds_read_b64_tr_b16 v[38:39], v22 offset:512
    s_add_u32 m0, s70, 90112
    s_add_u32 s69, s66, 8
    s_and_b32 s69, s69, 15
    s_mul_i32 s64, s69, 51200
    buffer_load_dwordx4 v1, s[40:43], s64 offen offset:0 lds
    s_add_u32 m0, m0, 3968
    s_nop 0
    buffer_load_dwordx4 v1, s[40:43], s64 offen offset:128 lds
    s_add_u32 m0, m0, 3968
    s_nop 0
    buffer_load_dwordx4 v1, s[40:43], s64 offen offset:256 lds
    s_add_u32 m0, m0, 3968
    s_nop 0
    buffer_load_dwordx4 v1, s[40:43], s64 offen offset:384 lds
    s_add_u32 m0, m0, 3968
    s_nop 0
    buffer_load_dwordx4 v1, s[40:43], s64 offen offset:512 lds
    s_cmp_ge_u32 s57, 4
    s_cbranch_scc1 L_a_no8
    s_add_u32 m0, s68, 131072
    s_mul_i32 s64, s69, 5120
    s_add_u32 s64, s64, s67
    buffer_load_dwordx4 v3, s[32:35], s64 offen sc1 lds
L_a_no8:
    s_waitcnt lgkmcnt(4)
    v_mfma_f32_16x16x32_bf16 v[64:67], v[28:31], v[48:51], v[64:67]
    ds_read_b64_tr_b16 v[40:41], v23 offset:0
    ds_read_b64_tr_b16 v[42:43], v23 offset:512
    v_mfma_f32_16x16x32_bf16 v[68:71], v[28:31], v[52:55], v[68:71]
    v_mfma_f32_16x16x32_bf16 v[72:75], v[28:31], v[56:59], v[72:75]
    v_mfma_f32_16x16x32_bf16 v[76:79], v[28:31], v[60:63], v[76:79]
    s_waitcnt lgkmcnt(4)
    v_mfma_f32_16x16x32_bf16 v[80:83], v[32:35], v[48:51], v[80:83]
    ds_read_b64_tr_b16 v[44:45], v24 offset:0
    ds_read_b64_tr_b16 v[46:47], v24 offset:512
    v_mfma_f32_16x16x32_bf16 v[84:87], v[32:35], v[52:55], v[84:87]
    v_mfma_f32_16x16x32_bf16 v[88:91], v[32:35], v[56:59], v[88:91]
    v_mfma_f32_16x16x32_bf16 v[92:95], v[32:35], v[60:63], v[92:95]
    s_waitcnt lgkmcnt(4)
    v_mfma_f32_16x16x32_bf16 v[96:99], v[36:39], v[48:51], v[96:99]
    v_mfma_f32_16x16x32_bf16 v[100:103], v[36:39], v[52:55], v[100:103]
    v_mfma_f32_16x16x32_bf16 v[104:107], v[36:39], v[56:59], v[104:107]
    v_mfma_f32_16x16x32_bf16 v[108:111], v[36:39], v[60:63], v[108:111]
    s_waitcnt lgkmcnt(2)
    v_mfma_f32_16x16x32_bf16 v[112:115], v[40:43], v[48:51], v[112:115]
    v_mfma_f32_16x16x32_bf16 v[116:119], v[40:43], v[52:55], v[116:119]
    v_mfma_f32_16x16x32_bf16 v[120:123], v[40:43], v[56:59], v[120:123]
    v_mfma_f32_16x16x32_bf16 v[124:127], v[40:43], v[60:63], v[124:127]
    s_waitcnt lgkmcnt(0)
    v_mfma_f32_16x16x32_bf16 v[128:131], v[44:47], v[48:51], v[128:131]
    v_mfma_f32_16x16x32_bf16 v[132:135], v[44:47], v[52:55], v[132:135]
    v_mfma_f32_16x16x32_bf16 v[136:139], v[44:47], v[56:59], v[136:139]
    v_mfma_f32_16x16x32_bf16 v[140:143], v[44:47], v[60:63], v[140:143]
    v_add_u32 v5, 45056, v5
    v_add_u32 v6, 45056, v6
    v_add_u32 v20, 45056, v20
    v_add_u32 v21, 45056, v21
    v_add_u32 v22, 45056, v22
    v_add_u32 v23, 45056, v23
    v_add_u32 v24, 45056, v24
    s_waitcnt vmcnt(5)
    s_barrier
    ds_read_b64 v[48:49], v5 offset:40960
    ds_read_b64 v[50:51], v5 offset:43008
    ds_read_b64 v[52:53], v5 offset:40968
    ds_read_b64 v[54:55], v5 offset:43016
    ds_read_b64 v[56:57], v5 offset:41984
    ds_read_b64 v[58:59], v5 offset:44032
    ds_read_b64 v[60:61], v5 offset:41992
    ds_read_b64 v[62:63], v5 offset:44040
    ds_read_b64_tr_b16 v[28:29], v20 offset:0
    ds_read_b64_tr_b16 v[30:31], v20 offset:512
    ds_read_b64_tr_b16 v[32:33], v21 offset:0
    ds_read_b64_tr_b16 v[34:35], v21 offset:512
    ds_read_b64_tr_b16 v[36:37], v22 offset:0
    ds_read_b64_tr_b16 v[38:39], v22 offset:512
    s_add_u32 m0, s70, 0
    s_add_u32 s69, s66, 9
    s_and_b32 s69, s69, 15
    s_mul_i32 s64, s69, 51200
    buffer_load_dwordx4 v1, s[40:43], s64 offen offset:0 lds
    s_add_u32 m0, m0, 3968
    s_nop 0
    buffer_load_dwordx4 v1, s[40:43], s64 offen offset:128 lds
    s_add_u32 m0, m0, 3968
    s_nop 0
    buffer_load_dwordx4 v1, s[40:43], s64 offen offset:256 lds
    s_add_u32 m0, m0, 3968
    s_nop 0
    buffer_load_dwordx4 v1, s[40:43], s64 offen offset:384 lds
    s_add_u32 m0, m0, 3968
    s_nop 0
    buffer_load_dwordx4 v1, s[40:43], s64 offen offset:512 lds
    s_cmp_ge_u32 s57, 4
    s_cbranch_scc1 L_a_no9
    s_add_u32 m0, s68, 40960
    s_mul_i32 s64, s69, 5120
    s_add_u32 s64, s64, s67
    buffer_load_dwordx4 v3, s[32:35], s64 offen sc1 lds
L_a_no9:
    s_waitcnt lgkmcnt(4)
    v_mfma_f32_16x16x32_bf16 v[64:67], v[28:31], v[48:51], v[64:67]
    ds_read_b64_tr_b16 v[40:41], v23 offset:0
    ds_read_b64_tr_b16 v[42:43], v23 offset:512
    v_mfma_f32_16x16x32_bf16 v[68:71], v[28:31], v[52:55], v[68:71]
    v_mfma_f32_16x16x32_bf16 v[72:75], v[28:31], v[56:59], v[72:75]
    v_mfma_f32_16x16x32_bf16 v[76:79], v[28:31], v[60:63], v[76:79]
    s_waitcnt lgkmcnt(4)
    v_mfma_f32_16x16x32_bf16 v[80:83], v[32:35], v[48:51], v[80:83]
    ds_read_b64_tr_b16 v[44:45], v24 offset:0
    ds_read_b64_tr_b16 v[46:47], v24 offset:512
    v_mfma_f32_16x16x32_bf16 v[84:87], v[32:35], v[52:55], v[84:87]
    v_mfma_f32_16x16x32_bf16 v[88:91], v[32:35], v[56:59], v[88:91]
    v_mfma_f32_16x16x32_bf16 v[92:95], v[32:35], v[60:63], v[92:95]
    s_waitcnt lgkmcnt(4)
    v_mfma_f32_16x16x32_bf16 v[96:99], v[36:39], v[48:51], v[96:99]
    v_mfma_f32_16x16x32_bf16 v[100:103], v[36:39], v[52:55], v[100:103]
    v_mfma_f32_16x16x32_bf16 v[104:107], v[36:39], v[56:59], v[104:107]
    v_mfma_f32_16x16x32_bf16 v[108:111], v[36:39], v[60:63], v[108:111]
    s_waitcnt lgkmcnt(2)
    v_mfma_f32_16x16x32_bf16 v[112:115], v[40:43], v[48:51], v[112:115]
    v_mfma_f32_16x16x32_bf16 v[116:119], v[40:43], v[52:55], v[116:119]
    v_mfma_f32_16x16x32_bf16 v[120:123], v[40:43], v[56:59], v[120:123]
    v_mfma_f32_16x16x32_bf16 v[124:127], v[40:43], v[60:63], v[124:127]
    s_waitcnt lgkmcnt(0)
    v_mfma_f32_16x16x32_bf16 v[128:131], v[44:47], v[48:51], v[128:131]
    v_mfma_f32_16x16x32_bf16 v[132:135], v[44:47], v[52:55], v[132:135]
    v_mfma_f32_16x16x32_bf16 v[136:139], v[44:47], v[56:59], v[136:139]
    v_mfma_f32_16x16x32_bf16 v[140:143], v[44:47], v[60:63], v[140:143]
    v_add_u32 v5, 45056, v5
    v_add_u32 v6, 45056, v6
    v_add_u32 v20, 45056, v20
    v_add_u32 v21, 45056, v21
    v_add_u32 v22, 45056, v22
    v_add_u32 v23, 45056, v23
    v_add_u32 v24, 45056, v24
    s_waitcnt vmcnt(5)
    s_barrier
    ds_read_b64 v[48:49], v5 offset:40960
    ds_read_b64 v[50:51], v5 offset:43008
    ds_read_b64 v[52:53], v5 offset:40968
    ds_read_b64 v[54:55], v5 offset:43016
    ds_read_b64 v[56:57], v5 offset:41984
    ds_read_b64 v[58:59], v5 offset:44032
    ds_read_b64 v[60:61], v5 offset:41992
    ds_read_b64 v[62:63], v5 offset:44040
    ds_read_b64_tr_b16 v[28:29], v20 offset:0
    ds_read_b64_tr_b16 v[30:31], v20 offset:512
    ds_read_b64_tr_b16 v[32:33], v21 offset:0
    ds_read_b64_tr_b16 v[34:35], v21 offset:512
    ds_read_b64_tr_b16 v[36:37], v22 offset:0
    ds_read_b64_tr_b16 v[38:39], v22 offset:512
    s_add_u32 m0, s70, 45056
    s_add_u32 s69, s66, 10
    s_and_b32 s69, s69, 15
    s_mul_i32 s64, s69, 51200
    buffer_load_dwordx4 v1, s[40:43], s64 offen offset:0 lds
    s_add_u32 m0, m0, 3968
    s_nop 0
    buffer_load_dwordx4 v1, s[40:43], s64 offen offset:128 lds
    s_add_u32 m0, m0, 3968
    s_nop 0
    buffer_load_dwordx4 v1, s[40:43], s64 offen offset:256 lds
    s_add_u32 m0, m0, 3968
    s_nop 0
    buffer_load_dwordx4 v1, s[40:43], s64 offen offset:384 lds
    s_add_u32 m0, m0, 3968
    s_nop 0
    buffer_load_dwordx4 v1, s[40:43], s64 offen offset:512 lds
    s_cmp_ge_u32 s57, 4
    s_cbranch_scc1 L_a_no10
    s_add_u32 m0, s68, 86016
    s_mul_i32 s64, s69, 5120
    s_add_u32 s64, s64, s67
    buffer_load_dwordx4 v3, s[32:35], s64 offen sc1 lds
L_a_no10:
    s_waitcnt lgkmcnt(4)
    v_mfma_f32_16x16x32_bf16 v[64:67], v[28:31], v[48:51], v[64:67]
    ds_read_b64_tr_b16 v[40:41], v23 offset:0
    ds_read_b64_tr_b16 v[42:43], v23 offset:512
    v_mfma_f32_16x16x32_bf16 v[68:71], v[28:31], v[52:55], v[68:71]
    v_mfma_f32_16x16x32_bf16 v[72:75], v[28:31], v[56:59], v[72:75]
    v_mfma_f32_16x16x32_bf16 v[76:79], v[28:31], v[60:63], v[76:79]
    s_waitcnt lgkmcnt(4)
    v_mfma_f32_16x16x32_bf16 v[80:83], v[32:35], v[48:51], v[80:83]
    ds_read_b64_tr_b16 v[44:45], v24 offset:0
    ds_read_b64_tr_b16 v[46:47], v24 offset:512
    v_mfma_f32_16x16x32_bf16 v[84:87], v[32:35], v[52:55], v[84:87]
    v_mfma_f32_16x16x32_bf16 v[88:91], v[32:35], v[56:59], v[88:91]
    v_mfma_f32_16x16x32_bf16 v[92:95], v[32:35], v[60:63], v[92:95]
    s_waitcnt lgkmcnt(4)
    v_mfma_f32_16x16x32_bf16 v[96:99], v[36:39], v[48:51], v[96:99]
    v_mfma_f32_16x16x32_bf16 v[100:103], v[36:39], v[52:55], v[100:103]
    v_mfma_f32_16x16x32_bf16 v[104:107], v[36:39], v[56:59], v[104:107]
    v_mfma_f32_16x16x32_bf16 v[108:111], v[36:39], v[60:63], v[108:111]
    s_waitcnt lgkmcnt(2)
    v_mfma_f32_16x16x32_bf16 v[112:115], v[40:43], v[48:51], v[112:115]
    v_mfma_f32_16x16x32_bf16 v[116:119], v[40:43], v[52:55], v[116:119]
    v_mfma_f32_16x16x32_bf16 v[120:123], v[40:43], v[56:59], v[120:123]
    v_mfma_f32_16x16x32_bf16 v[124:127], v[40:43], v[60:63], v[124:127]
    s_waitcnt lgkmcnt(0)
    v_mfma_f32_16x16x32_bf16 v[128:131], v[44:47], v[48:51], v[128:131]
    v_mfma_f32_16x16x32_bf16 v[132:135], v[44:47], v[52:55], v[132:135]
    v_mfma_f32_16x16x32_bf16 v[136:139], v[44:47], v[56:59], v[136:139]
    v_mfma_f32_16x16x32_bf16 v[140:143], v[44:47], v[60:63], v[140:143]
    v_subrev_u32 v5, 90112, v5
    v_subrev_u32 v6, 90112, v6
    v_subrev_u32 v20, 90112, v20
    v_subrev_u32 v21, 90112, v21
    v_subrev_u32 v22, 90112, v22
    v_subrev_u32 v23, 90112, v23
    v_subrev_u32 v24, 90112, v24
    s_waitcnt vmcnt(5)
    s_barrier
    ds_read_b64 v[48:49], v5 offset:40960
    ds_read_b64 v[50:51], v5 offset:43008
    ds_read_b64 v[52:53], v5 offset:40968
    ds_read_b64 v[54:55], v5 offset:43016
    ds_read_b64 v[56:57], v5 offset:41984
    ds_read_b64 v[58:59], v5 offset:44032
    ds_read_b64 v[60:61], v5 offset:41992
    ds_read_b64 v[62:63], v5 offset:44040
    ds_read_b64_tr_b16 v[28:29], v20 offset:0
    ds_read_b64_tr_b16 v[30:31], v20 offset:512
    ds_read_b64_tr_b16 v[32:33], v21 offset:0
    ds_read_b64_tr_b16 v[34:35], v21 offset:512
    ds_read_b64_tr_b16 v[36:37], v22 offset:0
    ds_read_b64_tr_b16 v[38:39], v22 offset:512
    s_add_u32 m0, s70, 90112
    s_add_u32 s69, s66, 11
    s_and_b32 s69, s69, 15
    s_mul_i32 s64, s69, 51200
    buffer_load_dwordx4 v1, s[40:43], s64 offen offset:0 lds
    s_add_u32 m0, m0, 3968
    s_nop 0
    buffer_load_dwordx4 v1, s[40:43], s64 offen offset:128 lds
    s_add_u32 m0, m0, 3968
    s_nop 0
    buffer_load_dwordx4 v1, s[40:43], s64 offen offset:256 lds
    s_add_u32 m0, m0, 3968
    s_nop 0
    buffer_load_dwordx4 v1, s[40:43], s64 offen offset:384 lds
    s_add_u32 m0, m0, 3968
    s_nop 0
    buffer_load_dwordx4 v1, s[40:43], s64 offen offset:512 lds
    s_cmp_ge_u32 s57, 4
    s_cbranch_scc1 L_a_no11
    s_add_u32 m0, s68, 131072
    s_mul_i32 s64, s69, 5120
    s_add_u32 s64, s64, s67
    buffer_load_dwordx4 v3, s[32:35], s64 offen sc1 lds
L_a_no11:
    s_waitcnt lgkmcnt(4)
    v_mfma_f32_16x16x32_bf16 v[64:67], v[28:31], v[48:51], v[64:67]
    ds_read_b64_tr_b16 v[40:41], v23 offset:0
    ds_read_b64_tr_b16 v[42:43], v23 offset:512
    v_mfma_f32_16x16x32_bf16 v[68:71], v[28:31], v[52:55], v[68:71]
    v_mfma_f32_16x16x32_bf16 v[72:75], v[28:31], v[56:59], v[72:75]
    v_mfma_f32_16x16x32_bf16 v[76:79], v[28:31], v[60:63], v[76:79]
    s_waitcnt lgkmcnt(4)
    v_mfma_f32_16x16x32_bf16 v[80:83], v[32:35], v[48:51], v[80:83]
    ds_read_b64_tr_b16 v[44:45], v24 offset:0
    ds_read_b64_tr_b16 v[46:47], v24 offset:512
    v_mfma_f32_16x16x32_bf16 v[84:87], v[32:35], v[52:55], v[84:87]
    v_mfma_f32_16x16x32_bf16 v[88:91], v[32:35], v[56:59], v[88:91]
    v_mfma_f32_16x16x32_bf16 v[92:95], v[32:35], v[60:63], v[92:95]
    s_waitcnt lgkmcnt(4)
    v_mfma_f32_16x16x32_bf16 v[96:99], v[36:39], v[48:51], v[96:99]
    v_mfma_f32_16x16x32_bf16 v[100:103], v[36:39], v[52:55], v[100:103]
    v_mfma_f32_16x16x32_bf16 v[104:107], v[36:39], v[56:59], v[104:107]
    v_mfma_f32_16x16x32_bf16 v[108:111], v[36:39], v[60:63], v[108:111]
    s_waitcnt lgkmcnt(2)
    v_mfma_f32_16x16x32_bf16 v[112:115], v[40:43], v[48:51], v[112:115]
    v_mfma_f32_16x16x32_bf16 v[116:119], v[40:43], v[52:55], v[116:119]
    v_mfma_f32_16x16x32_bf16 v[120:123], v[40:43], v[56:59], v[120:123]
    v_mfma_f32_16x16x32_bf16 v[124:127], v[40:43], v[60:63], v[124:127]
    s_waitcnt lgkmcnt(0)
    v_mfma_f32_16x16x32_bf16 v[128:131], v[44:47], v[48:51], v[128:131]
    v_mfma_f32_16x16x32_bf16 v[132:135], v[44:47], v[52:55], v[132:135]
    v_mfma_f32_16x16x32_bf16 v[136:139], v[44:47], v[56:59], v[136:139]
    v_mfma_f32_16x16x32_bf16 v[140:143], v[44:47], v[60:63], v[140:143]
    v_add_u32 v5, 45056, v5
    v_add_u32 v6, 45056, v6
    v_add_u32 v20, 45056, v20
    v_add_u32 v21, 45056, v21
    v_add_u32 v22, 45056, v22
    v_add_u32 v23, 45056, v23
    v_add_u32 v24, 45056, v24
    s_waitcnt vmcnt(5)
    s_barrier
    ds_read_b64 v[48:49], v5 offset:40960
    ds_read_b64 v[50:51], v5 offset:43008
    ds_read_b64 v[52:53], v5 offset:40968
    ds_read_b64 v[54:55], v5 offset:43016
    ds_read_b64 v[56:57], v5 offset:41984
    ds_read_b64 v[58:59], v5 offset:44032
    ds_read_b64 v[60:61], v5 offset:41992
    ds_read_b64 v[62:63], v5 offset:44040
    ds_read_b64_tr_b16 v[28:29], v20 offset:0
    ds_read_b64_tr_b16 v[30:31], v20 offset:512
    ds_read_b64_tr_b16 v[32:33], v21 offset:0
    ds_read_b64_tr_b16 v[34:35], v21 offset:512
    ds_read_b64_tr_b16 v[36:37], v22 offset:0
    ds_read_b64_tr_b16 v[38:39], v22 offset:512
    s_add_u32 m0, s70, 0
    s_add_u32 s69, s66, 12
    s_and_b32 s69, s69, 15
    s_mul_i32 s64, s69, 51200
    buffer_load_dwordx4 v1, s[40:43], s64 offen offset:0 lds
    s_add_u32 m0, m0, 3968
    s_nop 0
    buffer_load_dwordx4 v1, s[40:43], s64 offen offset:128 lds
    s_add_u32 m0, m0, 3968
    s_nop 0
    buffer_load_dwordx4 v1, s[40:43], s64 offen offset:256 lds
    s_add_u32 m0, m0, 3968
    s_nop 0
    buffer_load_dwordx4 v1, s[40:43], s64 offen offset:384 lds
    s_add_u32 m0, m0, 3968
    s_nop 0
    buffer_load_dwordx4 v1, s[40:43], s64 offen offset:512 lds
    s_cmp_ge_u32 s57, 4
    s_cbranch_scc1 L_a_no12
    s_add_u32 m0, s68, 40960
    s_mul_i32 s64, s69, 5120
    s_add_u32 s64, s64, s67
    buffer_load_dwordx4 v3, s[32:35], s64 offen sc1 lds
L_a_no12:
    s_waitcnt lgkmcnt(4)
    v_mfma_f32_16x16x32_bf16 v[64:67], v[28:31], v[48:51], v[64:67]
    ds_read_b64_tr_b16 v[40:41], v23 offset:0
    ds_read_b64_tr_b16 v[42:43], v23 offset:512
    v_mfma_f32_16x16x32_bf16 v[68:71], v[28:31], v[52:55], v[68:71]
    v_mfma_f32_16x16x32_bf16 v[72:75], v[28:31], v[56:59], v[72:75]
    v_mfma_f32_16x16x32_bf16 v[76:79], v[28:31], v[60:63], v[76:79]
    s_waitcnt lgkmcnt(4)
    v_mfma_f32_16x16x32_bf16 v[80:83], v[32:35], v[48:51], v[80:83]
    ds_read_b64_tr_b16 v[44:45], v24 offset:0
    ds_read_b64_tr_b16 v[46:47], v24 offset:512
    v_mfma_f32_16x16x32_bf16 v[84:87], v[32:35], v[52:55], v[84:87]
    v_mfma_f32_16x16x32_bf16 v[88:91], v[32:35], v[56:59], v[88:91]
    v_mfma_f32_16x16x32_bf16 v[92:95], v[32:35], v[60:63], v[92:95]
    s_waitcnt lgkmcnt(4)
    v_mfma_f32_16x16x32_bf16 v[96:99], v[36:39], v[48:51], v[96:99]
    v_mfma_f32_16x16x32_bf16 v[100:103], v[36:39], v[52:55], v[100:103]
    v_mfma_f32_16x16x32_bf16 v[104:107], v[36:39], v[56:59], v[104:107]
    v_mfma_f32_16x16x32_bf16 v[108:111], v[36:39], v[60:63], v[108:111]
    s_waitcnt lgkmcnt(2)
    v_mfma_f32_16x16x32_bf16 v[112:115], v[40:43], v[48:51], v[112:115]
    v_mfma_f32_16x16x32_bf16 v[116:119], v[40:43], v[52:55], v[116:119]
    v_mfma_f32_16x16x32_bf16 v[120:123], v[40:43], v[56:59], v[120:123]
    v_mfma_f32_16x16x32_bf16 v[124:127], v[40:43], v[60:63], v[124:127]
    s_waitcnt lgkmcnt(0)
    v_mfma_f32_16x16x32_bf16 v[128:131], v[44:47], v[48:51], v[128:131]
    v_mfma_f32_16x16x32_bf16 v[132:135], v[44:47], v[52:55], v[132:135]
    v_mfma_f32_16x16x32_bf16 v[136:139], v[44:47], v[56:59], v[136:139]
    v_mfma_f32_16x16x32_bf16 v[140:143], v[44:47], v[60:63], v[140:143]
    v_add_u32 v5, 45056, v5
    v_add_u32 v6, 45056, v6
    v_add_u32 v20, 45056, v20
    v_add_u32 v21, 45056, v21
    v_add_u32 v22, 45056, v22
    v_add_u32 v23, 45056, v23
    v_add_u32 v24, 45056, v24
    s_waitcnt vmcnt(5)
    s_barrier
    ds_read_b64 v[48:49], v5 offset:40960
    ds_read_b64 v[50:51], v5 offset:43008
    ds_read_b64 v[52:53], v5 offset:40968
    ds_read_b64 v[54:55], v5 offset:43016
    ds_read_b64 v[56:57], v5 offset:41984
    ds_read_b64 v[58:59], v5 offset:44032
    ds_read_b64 v[60:61], v5 offset:41992
    ds_read_b64 v[62:63], v5 offset:44040
    ds_read_b64_tr_b16 v[28:29], v20 offset:0
    ds_read_b64_tr_b16 v[30:31], v20 offset:512
    ds_read_b64_tr_b16 v[32:33], v21 offset:0
    ds_read_b64_tr_b16 v[34:35], v21 offset:512
    ds_read_b64_tr_b16 v[36:37], v22 offset:0
    ds_read_b64_tr_b16 v[38:39], v22 offset:512
    s_add_u32 m0, s70, 45056
    s_add_u32 s69, s66, 13
    s_and_b32 s69, s69, 15
    s_mul_i32 s64, s69, 51200
    buffer_load_dwordx4 v1, s[40:43], s64 offen offset:0 lds
    s_add_u32 m0, m0, 3968
    s_nop 0
    buffer_load_dwordx4 v1, s[40:43], s64 offen offset:128 lds
    s_add_u32 m0, m0, 3968
    s_nop 0
    buffer_load_dwordx4 v1, s[40:43], s64 offen offset:256 lds
    s_add_u32 m0, m0, 3968
    s_nop 0
    buffer_load_dwordx4 v1, s[40:43], s64 offen offset:384 lds
    s_add_u32 m0, m0, 3968
    s_nop 0
    buffer_load_dwordx4 v1, s[40:43], s64 offen offset:512 lds
    s_cmp_ge_u32 s57, 4
    s_cbranch_scc1 L_a_no13
    s_add_u32 m0, s68, 86016
    s_mul_i32 s64, s69, 5120
    s_add_u32 s64, s64, s67
    buffer_load_dwordx4 v3, s[32:35], s64 offen sc1 lds
L_a_no13:
    s_waitcnt lgkmcnt(4)
    v_mfma_f32_16x16x32_bf16 v[64:67], v[28:31], v[48:51], v[64:67]
    ds_read_b64_tr_b16 v[40:41], v23 offset:0
    ds_read_b64_tr_b16 v[42:43], v23 offset:512
    v_mfma_f32_16x16x32_bf16 v[68:71], v[28:31], v[52:55], v[68:71]
    v_mfma_f32_16x16x32_bf16 v[72:75], v[28:31], v[56:59], v[72:75]
    v_mfma_f32_16x16x32_bf16 v[76:79], v[28:31], v[60:63], v[76:79]
    s_waitcnt lgkmcnt(4)
    v_mfma_f32_16x16x32_bf16 v[80:83], v[32:35], v[48:51], v[80:83]
    ds_read_b64_tr_b16 v[44:45], v24 offset:0
    ds_read_b64_tr_b16 v[46:47], v24 offset:512
    v_mfma_f32_16x16x32_bf16 v[84:87], v[32:35], v[52:55], v[84:87]
    v_mfma_f32_16x16x32_bf16 v[88:91], v[32:35], v[56:59], v[88:91]
    v_mfma_f32_16x16x32_bf16 v[92:95], v[32:35], v[60:63], v[92:95]
    s_waitcnt lgkmcnt(4)
    v_mfma_f32_16x16x32_bf16 v[96:99], v[36:39], v[48:51], v[96:99]
    v_mfma_f32_16x16x32_bf16 v[100:103], v[36:39], v[52:55], v[100:103]
    v_mfma_f32_16x16x32_bf16 v[104:107], v[36:39], v[56:59], v[104:107]
    v_mfma_f32_16x16x32_bf16 v[108:111], v[36:39], v[60:63], v[108:111]
    s_waitcnt lgkmcnt(2)
    v_mfma_f32_16x16x32_bf16 v[112:115], v[40:43], v[48:51], v[112:115]
    v_mfma_f32_16x16x32_bf16 v[116:119], v[40:43], v[52:55], v[116:119]
    v_mfma_f32_16x16x32_bf16 v[120:123], v[40:43], v[56:59], v[120:123]
    v_mfma_f32_16x16x32_bf16 v[124:127], v[40:43], v[60:63], v[124:127]
    s_waitcnt lgkmcnt(0)
    v_mfma_f32_16x16x32_bf16 v[128:131], v[44:47], v[48:51], v[128:131]
    v_mfma_f32_16x16x32_bf16 v[132:135], v[44:47], v[52:55], v[132:135]
    v_mfma_f32_16x16x32_bf16 v[136:139], v[44:47], v[56:59], v[136:139]
    v_mfma_f32_16x16x32_bf16 v[140:143], v[44:47], v[60:63], v[140:143]
    v_subrev_u32 v5, 90112, v5
    v_subrev_u32 v6, 90112, v6
    v_subrev_u32 v20, 90112, v20
    v_subrev_u32 v21, 90112, v21
    v_subrev_u32 v22, 90112, v22
    v_subrev_u32 v23, 90112, v23
    v_subrev_u32 v24, 90112, v24
    s_waitcnt vmcnt(5)
    s_barrier
    ds_read_b64 v[48:49], v5 offset:40960
    ds_read_b64 v[50:51], v5 offset:43008
    ds_read_b64 v[52:53], v5 offset:40968
    ds_read_b64 v[54:55], v5 offset:43016
    ds_read_b64 v[56:57], v5 offset:41984
    ds_read_b64 v[58:59], v5 offset:44032
    ds_read_b64 v[60:61], v5 offset:41992
    ds_read_b64 v[62:63], v5 offset:44040
    ds_read_b64_tr_b16 v[28:29], v20 offset:0
    ds_read_b64_tr_b16 v[30:31], v20 offset:512
    ds_read_b64_tr_b16 v[32:33], v21 offset:0
    ds_read_b64_tr_b16 v[34:35], v21 offset:512
    ds_read_b64_tr_b16 v[36:37], v22 offset:0
    ds_read_b64_tr_b16 v[38:39], v22 offset:512
    s_add_u32 m0, s70, 90112
    s_add_u32 s69, s66, 14
    s_and_b32 s69, s69, 15
    s_mul_i32 s64, s69, 51200
    buffer_load_dwordx4 v1, s[40:43], s64 offen offset:0 lds
    s_add_u32 m0, m0, 3968
    s_nop 0
    buffer_load_dwordx4 v1, s[40:43], s64 offen offset:128 lds
    s_add_u32 m0, m0, 3968
    s_nop 0
    buffer_load_dwordx4 v1, s[40:43], s64 offen offset:256 lds
    s_add_u32 m0, m0, 3968
    s_nop 0
    buffer_load_dwordx4 v1, s[40:43], s64 offen offset:384 lds
    s_add_u32 m0, m0, 3968
    s_nop 0
    buffer_load_dwordx4 v1, s[40:43], s64 offen offset:512 lds
    s_cmp_ge_u32 s57, 4
    s_cbranch_scc1 L_a_no14
    s_add_u32 m0, s68, 131072
    s_mul_i32 s64, s69, 5120
    s_add_u32 s64, s64, s67
    buffer_load_dwordx4 v3, s[32:35], s64 offen sc1 lds
L_a_no14:
    s_waitcnt lgkmcnt(4)
    v_mfma_f32_16x16x32_bf16 v[64:67], v[28:31], v[48:51], v[64:67]
    ds_read_b64_tr_b16 v[40:41], v23 offset:0
    ds_read_b64_tr_b16 v[42:43], v23 offset:512
    v_mfma_f32_16x16x32_bf16 v[68:71], v[28:31], v[52:55], v[68:71]
    v_mfma_f32_16x16x32_bf16 v[72:75], v[28:31], v[56:59], v[72:75]
    v_mfma_f32_16x16x32_bf16 v[76:79], v[28:31], v[60:63], v[76:79]
    s_waitcnt lgkmcnt(4)
    v_mfma_f32_16x16x32_bf16 v[80:83], v[32:35], v[48:51], v[80:83]
    ds_read_b64_tr_b16 v[44:45], v24 offset:0
    ds_read_b64_tr_b16 v[46:47], v24 offset:512
    v_mfma_f32_16x16x32_bf16 v[84:87], v[32:35], v[52:55], v[84:87]
    v_mfma_f32_16x16x32_bf16 v[88:91], v[32:35], v[56:59], v[88:91]
    v_mfma_f32_16x16x32_bf16 v[92:95], v[32:35], v[60:63], v[92:95]
    s_waitcnt lgkmcnt(4)
    v_mfma_f32_16x16x32_bf16 v[96:99], v[36:39], v[48:51], v[96:99]
    v_mfma_f32_16x16x32_bf16 v[100:103], v[36:39], v[52:55], v[100:103]
    v_mfma_f32_16x16x32_bf16 v[104:107], v[36:39], v[56:59], v[104:107]
    v_mfma_f32_16x16x32_bf16 v[108:111], v[36:39], v[60:63], v[108:111]
    s_waitcnt lgkmcnt(2)
    v_mfma_f32_16x16x32_bf16 v[112:115], v[40:43], v[48:51], v[112:115]
    v_mfma_f32_16x16x32_bf16 v[116:119], v[40:43], v[52:55], v[116:119]
    v_mfma_f32_16x16x32_bf16 v[120:123], v[40:43], v[56:59], v[120:123]
    v_mfma_f32_16x16x32_bf16 v[124:127], v[40:43], v[60:63], v[124:127]
    s_waitcnt lgkmcnt(0)
    v_mfma_f32_16x16x32_bf16 v[128:131], v[44:47], v[48:51], v[128:131]
    v_mfma_f32_16x16x32_bf16 v[132:135], v[44:47], v[52:55], v[132:135]
    v_mfma_f32_16x16x32_bf16 v[136:139], v[44:47], v[56:59], v[136:139]
    v_mfma_f32_16x16x32_bf16 v[140:143], v[44:47], v[60:63], v[140:143]
    v_add_u32 v5, 45056, v5
    v_add_u32 v6, 45056, v6
    v_add_u32 v20, 45056, v20
    v_add_u32 v21, 45056, v21
    v_add_u32 v22, 45056, v22
    v_add_u32 v23, 45056, v23
    v_add_u32 v24, 45056, v24
    s_waitcnt vmcnt(5)
    s_barrier
    ds_read_b64 v[48:49], v5 offset:40960
    ds_read_b64 v[50:51], v5 offset:43008
    ds_read_b64 v[52:53], v5 offset:40968
    ds_read_b64 v[54:55], v5 offset:43016
    ds_read_b64 v[56:57], v5 offset:41984
    ds_read_b64 v[58:59], v5 offset:44032
    ds_read_b64 v[60:61], v5 offset:41992
    ds_read_b64 v[62:63], v5 offset:44040
    ds_read_b64_tr_b16 v[28:29], v20 offset:0
    ds_read_b64_tr_b16 v[30:31], v20 offset:512
    ds_read_b64_tr_b16 v[32:33], v21 offset:0
    ds_read_b64_tr_b16 v[34:35], v21 offset:512
    ds_read_b64_tr_b16 v[36:37], v22 offset:0
    ds_read_b64_tr_b16 v[38:39], v22 offset:512
    s_add_u32 m0, s70, 0
    s_add_u32 s69, s66, 15
    s_and_b32 s69, s69, 15
    s_mul_i32 s64, s69, 51200
    buffer_load_dwordx4 v1, s[40:43], s64 offen offset:0 lds
    s_add_u32 m0, m0, 3968
    s_nop 0
    buffer_load_dwordx4 v1, s[40:43], s64 offen offset:128 lds
    s_add_u32 m0, m0, 3968
    s_nop 0
    buffer_load_dwordx4 v1, s[40:43], s64 offen offset:256 lds
    s_add_u32 m0, m0, 3968
    s_nop 0
    buffer_load_dwordx4 v1, s[40:43], s64 offen offset:384 lds
    s_add_u32 m0, m0, 3968
    s_nop 0
    buffer_load_dwordx4 v1, s[40:43], s64 offen offset:512 lds
    s_cmp_ge_u32 s57, 4
    s_cbranch_scc1 L_a_no15
    s_add_u32 m0, s68, 40960
    s_mul_i32 s64, s69, 5120
    s_add_u32 s64, s64, s67
    buffer_load_dwordx4 v3, s[32:35], s64 offen sc1 lds
L_a_no15:
    s_waitcnt lgkmcnt(4)
    v_mfma_f32_16x16x32_bf16 v[64:67], v[28:31], v[48:51], v[64:67]
    ds_read_b64_tr_b16 v[40:41], v23 offset:0
    ds_read_b64_tr_b16 v[42:43], v23 offset:512
    v_mfma_f32_16x16x32_bf16 v[68:71], v[28:31], v[52:55], v[68:71]
    v_mfma_f32_16x16x32_bf16 v[72:75], v[28:31], v[56:59], v[72:75]
    v_mfma_f32_16x16x32_bf16 v[76:79], v[28:31], v[60:63], v[76:79]
    s_waitcnt lgkmcnt(4)
    v_mfma_f32_16x16x32_bf16 v[80:83], v[32:35], v[48:51], v[80:83]
    ds_read_b64_tr_b16 v[44:45], v24 offset:0
    ds_read_b64_tr_b16 v[46:47], v24 offset:512
    v_mfma_f32_16x16x32_bf16 v[84:87], v[32:35], v[52:55], v[84:87]
    v_mfma_f32_16x16x32_bf16 v[88:91], v[32:35], v[56:59], v[88:91]
    v_mfma_f32_16x16x32_bf16 v[92:95], v[32:35], v[60:63], v[92:95]
    s_waitcnt lgkmcnt(4)
    v_mfma_f32_16x16x32_bf16 v[96:99], v[36:39], v[48:51], v[96:99]
    v_mfma_f32_16x16x32_bf16 v[100:103], v[36:39], v[52:55], v[100:103]
    v_mfma_f32_16x16x32_bf16 v[104:107], v[36:39], v[56:59], v[104:107]
    v_mfma_f32_16x16x32_bf16 v[108:111], v[36:39], v[60:63], v[108:111]
    s_waitcnt lgkmcnt(2)
    v_mfma_f32_16x16x32_bf16 v[112:115], v[40:43], v[48:51], v[112:115]
    v_mfma_f32_16x16x32_bf16 v[116:119], v[40:43], v[52:55], v[116:119]
    v_mfma_f32_16x16x32_bf16 v[120:123], v[40:43], v[56:59], v[120:123]
    v_mfma_f32_16x16x32_bf16 v[124:127], v[40:43], v[60:63], v[124:127]
    s_waitcnt lgkmcnt(0)
    v_mfma_f32_16x16x32_bf16 v[128:131], v[44:47], v[48:51], v[128:131]
    v_mfma_f32_16x16x32_bf16 v[132:135], v[44:47], v[52:55], v[132:135]
    v_mfma_f32_16x16x32_bf16 v[136:139], v[44:47], v[56:59], v[136:139]
    v_mfma_f32_16x16x32_bf16 v[140:143], v[44:47], v[60:63], v[140:143]
    v_add_u32 v5, 45056, v5
    v_add_u32 v6, 45056, v6
    v_add_u32 v20, 45056, v20
    v_add_u32 v21, 45056, v21
    v_add_u32 v22, 45056, v22
    v_add_u32 v23, 45056, v23
    v_add_u32 v24, 45056, v24
    s_waitcnt vmcnt(5)
    s_barrier
    ds_read_b64 v[48:49], v5 offset:40960
    ds_read_b64 v[50:51], v5 offset:43008
    ds_read_b64 v[52:53], v5 offset:40968
    ds_read_b64 v[54:55], v5 offset:43016
    ds_read_b64 v[56:57], v5 offset:41984
    ds_read_b64 v[58:59], v5 offset:44032
    ds_read_b64 v[60:61], v5 offset:41992
    ds_read_b64 v[62:63], v5 offset:44040
    ds_read_b64_tr_b16 v[28:29], v20 offset:0
    ds_read_b64_tr_b16 v[30:31], v20 offset:512
    ds_read_b64_tr_b16 v[32:33], v21 offset:0
    ds_read_b64_tr_b16 v[34:35], v21 offset:512
    ds_read_b64_tr_b16 v[36:37], v22 offset:0
    ds_read_b64_tr_b16 v[38:39], v22 offset:512
    s_add_u32 m0, s70, 45056
    s_add_u32 s69, s62, 16
    s_and_b32 s69, s69, 3
    s_mul_i32 s64, s69, 204800
    buffer_load_dwordx4 v2, s[40:43], s64 offen offset:0 lds
    s_add_u32 m0, m0, 3968
    s_nop 0
    buffer_load_dwordx4 v2, s[40:43], s64 offen offset:128 lds
    s_add_u32 m0, m0, 3968
    s_nop 0
    buffer_load_dwordx4 v2, s[40:43], s64 offen offset:256 lds
    s_add_u32 m0, m0, 3968
    s_nop 0
    buffer_load_dwordx4 v2, s[40:43], s64 offen offset:384 lds
    s_add_u32 m0, m0, 3968
    s_nop 0
    buffer_load_dwordx4 v2, s[40:43], s64 offen offset:512 lds
    s_cmp_ge_u32 s57, 4
    s_cbranch_scc1 L_a_no16
    s_add_u32 m0, s68, 86016
    s_mul_i32 s64, s69, 20480
    s_add_u32 s64, s64, s67
    buffer_load_dwordx4 v4, s[32:35], s64 offen sc1 lds
L_a_no16:
    s_waitcnt lgkmcnt(4)
    v_mfma_f32_16x16x32_bf16 v[64:67], v[28:31], v[48:51], v[64:67]
    ds_read_b64_tr_b16 v[40:41], v23 offset:0
    ds_read_b64_tr_b16 v[42:43], v23 offset:512
    v_mfma_f32_16x16x32_bf16 v[68:71], v[28:31], v[52:55], v[68:71]
    v_mfma_f32_16x16x32_bf16 v[72:75], v[28:31], v[56:59], v[72:75]
    v_mfma_f32_16x16x32_bf16 v[76:79], v[28:31], v[60:63], v[76:79]
    s_waitcnt lgkmcnt(4)
    v_mfma_f32_16x16x32_bf16 v[80:83], v[32:35], v[48:51], v[80:83]
    ds_read_b64_tr_b16 v[44:45], v24 offset:0
    ds_read_b64_tr_b16 v[46:47], v24 offset:512
    v_mfma_f32_16x16x32_bf16 v[84:87], v[32:35], v[52:55], v[84:87]
    v_mfma_f32_16x16x32_bf16 v[88:91], v[32:35], v[56:59], v[88:91]
    v_mfma_f32_16x16x32_bf16 v[92:95], v[32:35], v[60:63], v[92:95]
    s_waitcnt lgkmcnt(4)
    v_mfma_f32_16x16x32_bf16 v[96:99], v[36:39], v[48:51], v[96:99]
    v_mfma_f32_16x16x32_bf16 v[100:103], v[36:39], v[52:55], v[100:103]
    v_mfma_f32_16x16x32_bf16 v[104:107], v[36:39], v[56:59], v[104:107]
    v_mfma_f32_16x16x32_bf16 v[108:111], v[36:39], v[60:63], v[108:111]
    s_waitcnt lgkmcnt(2)
    v_mfma_f32_16x16x32_bf16 v[112:115], v[40:43], v[48:51], v[112:115]
    v_mfma_f32_16x16x32_bf16 v[116:119], v[40:43], v[52:55], v[116:119]
    v_mfma_f32_16x16x32_bf16 v[120:123], v[40:43], v[56:59], v[120:123]
    v_mfma_f32_16x16x32_bf16 v[124:127], v[40:43], v[60:63], v[124:127]
    s_waitcnt lgkmcnt(0)
    v_mfma_f32_16x16x32_bf16 v[128:131], v[44:47], v[48:51], v[128:131]
    v_mfma_f32_16x16x32_bf16 v[132:135], v[44:47], v[52:55], v[132:135]
    v_mfma_f32_16x16x32_bf16 v[136:139], v[44:47], v[56:59], v[136:139]
    v_mfma_f32_16x16x32_bf16 v[140:143], v[44:47], v[60:63], v[140:143]
    v_subrev_u32 v5, 90112, v5
    v_subrev_u32 v6, 90112, v6
    v_subrev_u32 v20, 90112, v20
    v_subrev_u32 v21, 90112, v21
    v_subrev_u32 v22, 90112, v22
    v_subrev_u32 v23, 90112, v23
    v_subrev_u32 v24, 90112, v24
    s_waitcnt vmcnt(5)
    s_barrier
    ds_read_b64 v[48:49], v5 offset:40960
    ds_read_b64 v[50:51], v5 offset:43008
    ds_read_b64 v[52:53], v5 offset:40968
    ds_read_b64 v[54:55], v5 offset:43016
    ds_read_b64 v[56:57], v5 offset:41984
    ds_read_b64 v[58:59], v5 offset:44032
    ds_read_b64 v[60:61], v5 offset:41992
    ds_read_b64 v[62:63], v5 offset:44040
    ds_read_b64_tr_b16 v[28:29], v20 offset:0
    ds_read_b64_tr_b16 v[30:31], v20 offset:512
    ds_read_b64_tr_b16 v[32:33], v21 offset:0
    ds_read_b64_tr_b16 v[34:35], v21 offset:512
    ds_read_b64_tr_b16 v[36:37], v22 offset:0
    ds_read_b64_tr_b16 v[38:39], v22 offset:512
    s_add_u32 m0, s70, 90112
    s_add_u32 s69, s62, 17
    s_and_b32 s69, s69, 3
    s_mul_i32 s64, s69, 204800
    buffer_load_dwordx4 v2, s[40:43], s64 offen offset:0 lds
    s_add_u32 m0, m0, 3968
    s_nop 0
    buffer_load_dwordx4 v2, s[40:43], s64 offen offset:128 lds
    s_add_u32 m0, m0, 3968
    s_nop 0
    buffer_load_dwordx4 v2, s[40:43], s64 offen offset:256 lds
    s_add_u32 m0, m0, 3968
    s_nop 0
    buffer_load_dwordx4 v2, s[40:43], s64 offen offset:384 lds
    s_add_u32 m0, m0, 3968
    s_nop 0
    buffer_load_dwordx4 v2, s[40:43], s64 offen offset:512 lds
    s_cmp_ge_u32 s57, 4
    s_cbranch_scc1 L_a_no17
    s_add_u32 m0, s68, 131072
    s_mul_i32 s64, s69, 20480
    s_add_u32 s64, s64, s67
    buffer_load_dwordx4 v4, s[32:35], s64 offen sc1 lds
L_a_no17:
    s_waitcnt lgkmcnt(4)
    v_mfma_f32_16x16x32_bf16 v[64:67], v[28:31], v[48:51], v[64:67]
    ds_read_b64_tr_b16 v[40:41], v23 offset:0
    ds_read_b64_tr_b16 v[42:43], v23 offset:512
    v_mfma_f32_16x16x32_bf16 v[68:71], v[28:31], v[52:55], v[68:71]
    v_mfma_f32_16x16x32_bf16 v[72:75], v[28:31], v[56:59], v[72:75]
    v_mfma_f32_16x16x32_bf16 v[76:79], v[28:31], v[60:63], v[76:79]
    s_waitcnt lgkmcnt(4)
    v_mfma_f32_16x16x32_bf16 v[80:83], v[32:35], v[48:51], v[80:83]
    ds_read_b64_tr_b16 v[44:45], v24 offset:0
    ds_read_b64_tr_b16 v[46:47], v24 offset:512
    v_mfma_f32_16x16x32_bf16 v[84:87], v[32:35], v[52:55], v[84:87]
    v_mfma_f32_16x16x32_bf16 v[88:91], v[32:35], v[56:59], v[88:91]
    v_mfma_f32_16x16x32_bf16 v[92:95], v[32:35], v[60:63], v[92:95]
    s_waitcnt lgkmcnt(4)
    v_mfma_f32_16x16x32_bf16 v[96:99], v[36:39], v[48:51], v[96:99]
    v_mfma_f32_16x16x32_bf16 v[100:103], v[36:39], v[52:55], v[100:103]
    v_mfma_f32_16x16x32_bf16 v[104:107], v[36:39], v[56:59], v[104:107]
    v_mfma_f32_16x16x32_bf16 v[108:111], v[36:39], v[60:63], v[108:111]
    s_waitcnt lgkmcnt(2)
    v_mfma_f32_16x16x32_bf16 v[112:115], v[40:43], v[48:51], v[112:115]
    v_mfma_f32_16x16x32_bf16 v[116:119], v[40:43], v[52:55], v[116:119]
    v_mfma_f32_16x16x32_bf16 v[120:123], v[40:43], v[56:59], v[120:123]
    v_mfma_f32_16x16x32_bf16 v[124:127], v[40:43], v[60:63], v[124:127]
    s_waitcnt lgkmcnt(0)
    v_mfma_f32_16x16x32_bf16 v[128:131], v[44:47], v[48:51], v[128:131]
    v_mfma_f32_16x16x32_bf16 v[132:135], v[44:47], v[52:55], v[132:135]
    v_mfma_f32_16x16x32_bf16 v[136:139], v[44:47], v[56:59], v[136:139]
    v_mfma_f32_16x16x32_bf16 v[140:143], v[44:47], v[60:63], v[140:143]
    v_add_u32 v5, 45056, v5
    v_add_u32 v6, 45056, v6
    v_add_u32 v20, 45056, v20
    v_add_u32 v21, 45056, v21
    v_add_u32 v22, 45056, v22
    v_add_u32 v23, 45056, v23
    v_add_u32 v24, 45056, v24
    s_waitcnt vmcnt(5)
    s_barrier
    ds_read_b64 v[48:49], v6 offset:40960
    ds_read_b64 v[50:51], v6 offset:41472
    ds_read_b64 v[52:53], v6 offset:41088
    ds_read_b64 v[54:55], v6 offset:41600
    ds_read_b64 v[56:57], v6 offset:41216
    ds_read_b64 v[58:59], v6 offset:41728
    ds_read_b64 v[60:61], v6 offset:41344
    ds_read_b64 v[62:63], v6 offset:41856
    ds_read_b64_tr_b16 v[28:29], v20 offset:0
    ds_read_b64_tr_b16 v[30:31], v20 offset:512
    ds_read_b64_tr_b16 v[32:33], v21 offset:0
    ds_read_b64_tr_b16 v[34:35], v21 offset:512
    ds_read_b64_tr_b16 v[36:37], v22 offset:0
    ds_read_b64_tr_b16 v[38:39], v22 offset:512
    s_add_u32 m0, s70, 0
    s_add_u32 s69, s62, 18
    s_and_b32 s69, s69, 3
    s_mul_i32 s64, s69, 204800
    buffer_load_dwordx4 v2, s[40:43], s64 offen offset:0 lds
    s_add_u32 m0, m0, 3968
    s_nop 0
    buffer_load_dwordx4 v2, s[40:43], s64 offen offset:128 lds
    s_add_u32 m0, m0, 3968
    s_nop 0
    buffer_load_dwordx4 v2, s[40:43], s64 offen offset:256 lds
    s_add_u32 m0, m0, 3968
    s_nop 0
    buffer_load_dwordx4 v2, s[40:43], s64 offen offset:384 lds
    s_add_u32 m0, m0, 3968
    s_nop 0
    buffer_load_dwordx4 v2, s[40:43], s64 offen offset:512 lds
    s_cmp_ge_u32 s57, 4
    s_cbranch_scc1 L_a_no18
    s_add_u32 m0, s68, 40960
    s_mul_i32 s64, s69, 20480
    s_add_u32 s64, s64, s67
    buffer_load_dwordx4 v4, s[32:35], s64 offen sc1 lds
L_a_no18:
    s_waitcnt lgkmcnt(4)
    v_mfma_f32_16x16x32_bf16 v[64:67], v[28:31], v[48:51], v[64:67]
    ds_read_b64_tr_b16 v[40:41], v23 offset:0
    ds_read_b64_tr_b16 v[42:43], v23 offset:512
    v_mfma_f32_16x16x32_bf16 v[68:71], v[28:31], v[52:55], v[68:71]
    v_mfma_f32_16x16x32_bf16 v[72:75], v[28:31], v[56:59], v[72:75]
    v_mfma_f32_16x16x32_bf16 v[76:79], v[28:31], v[60:63], v[76:79]
    s_waitcnt lgkmcnt(4)
    v_mfma_f32_16x16x32_bf16 v[80:83], v[32:35], v[48:51], v[80:83]
    ds_read_b64_tr_b16 v[44:45], v24 offset:0
    ds_read_b64_tr_b16 v[46:47], v24 offset:512
    v_mfma_f32_16x16x32_bf16 v[84:87], v[32:35], v[52:55], v[84:87]
    v_mfma_f32_16x16x32_bf16 v[88:91], v[32:35], v[56:59], v[88:91]
    v_mfma_f32_16x16x32_bf16 v[92:95], v[32:35], v[60:63], v[92:95]
    s_waitcnt lgkmcnt(4)
    v_mfma_f32_16x16x32_bf16 v[96:99], v[36:39], v[48:51], v[96:99]
    v_mfma_f32_16x16x32_bf16 v[100:103], v[36:39], v[52:55], v[100:103]
    v_mfma_f32_16x16x32_bf16 v[104:107], v[36:39], v[56:59], v[104:107]
    v_mfma_f32_16x16x32_bf16 v[108:111], v[36:39], v[60:63], v[108:111]
    s_waitcnt lgkmcnt(2)
    v_mfma_f32_16x16x32_bf16 v[112:115], v[40:43], v[48:51], v[112:115]
    v_mfma_f32_16x16x32_bf16 v[116:119], v[40:43], v[52:55], v[116:119]
    v_mfma_f32_16x16x32_bf16 v[120:123], v[40:43], v[56:59], v[120:123]
    v_mfma_f32_16x16x32_bf16 v[124:127], v[40:43], v[60:63], v[124:127]
    s_waitcnt lgkmcnt(0)
    v_mfma_f32_16x16x32_bf16 v[128:131], v[44:47], v[48:51], v[128:131]
    v_mfma_f32_16x16x32_bf16 v[132:135], v[44:47], v[52:55], v[132:135]
    v_mfma_f32_16x16x32_bf16 v[136:139], v[44:47], v[56:59], v[136:139]
    v_mfma_f32_16x16x32_bf16 v[140:143], v[44:47], v[60:63], v[140:143]
    v_add_u32 v5, 45056, v5
    v_add_u32 v6, 45056, v6
    v_add_u32 v20, 45056, v20
    v_add_u32 v21, 45056, v21
    v_add_u32 v22, 45056, v22
    v_add_u32 v23, 45056, v23
    v_add_u32 v24, 45056, v24
    s_waitcnt vmcnt(5)
    s_barrier
    ds_read_b64 v[48:49], v6 offset:40960
    ds_read_b64 v[50:51], v6 offset:41472
    ds_read_b64 v[52:53], v6 offset:41088
    ds_read_b64 v[54:55], v6 offset:41600
    ds_read_b64 v[56:57], v6 offset:41216
    ds_read_b64 v[58:59], v6 offset:41728
    ds_read_b64 v[60:61], v6 offset:41344
    ds_read_b64 v[62:63], v6 offset:41856
    ds_read_b64_tr_b16 v[28:29], v20 offset:0
    ds_read_b64_tr_b16 v[30:31], v20 offset:512
    ds_read_b64_tr_b16 v[32:33], v21 offset:0
    ds_read_b64_tr_b16 v[34:35], v21 offset:512
    ds_read_b64_tr_b16 v[36:37], v22 offset:0
    ds_read_b64_tr_b16 v[38:39], v22 offset:512
    s_add_u32 m0, s70, 45056
    s_add_u32 s69, s62, 19
    s_and_b32 s69, s69, 3
    s_mul_i32 s64, s69, 204800
    buffer_load_dwordx4 v2, s[40:43], s64 offen offset:0 lds
    s_add_u32 m0, m0, 3968
    s_nop 0
    buffer_load_dwordx4 v2, s[40:43], s64 offen offset:128 lds
    s_add_u32 m0, m0, 3968
    s_nop 0
    buffer_load_dwordx4 v2, s[40:43], s64 offen offset:256 lds
    s_add_u32 m0, m0, 3968
    s_nop 0
    buffer_load_dwordx4 v2, s[40:43], s64 offen offset:384 lds
    s_add_u32 m0, m0, 3968
    s_nop 0
    buffer_load_dwordx4 v2, s[40:43], s64 offen offset:512 lds
    s_cmp_ge_u32 s57, 4
    s_cbranch_scc1 L_a_no19
    s_add_u32 m0, s68, 86016
    s_mul_i32 s64, s69, 20480
    s_add_u32 s64, s64, s67
    buffer_load_dwordx4 v4, s[32:35], s64 offen sc1 lds
L_a_no19:
    s_waitcnt lgkmcnt(4)
    v_mfma_f32_16x16x32_bf16 v[64:67], v[28:31], v[48:51], v[64:67]
    ds_read_b64_tr_b16 v[40:41], v23 offset:0
    ds_read_b64_tr_b16 v[42:43], v23 offset:512
    v_mfma_f32_16x16x32_bf16 v[68:71], v[28:31], v[52:55], v[68:71]
    v_mfma_f32_16x16x32_bf16 v[72:75], v[28:31], v[56:59], v[72:75]
    v_mfma_f32_16x16x32_bf16 v[76:79], v[28:31], v[60:63], v[76:79]
    s_waitcnt lgkmcnt(4)
    v_mfma_f32_16x16x32_bf16 v[80:83], v[32:35], v[48:51], v[80:83]
    ds_read_b64_tr_b16 v[44:45], v24 offset:0
    ds_read_b64_tr_b16 v[46:47], v24 offset:512
    v_mfma_f32_16x16x32_bf16 v[84:87], v[32:35], v[52:55], v[84:87]
    v_mfma_f32_16x16x32_bf16 v[88:91], v[32:35], v[56:59], v[88:91]
    v_mfma_f32_16x16x32_bf16 v[92:95], v[32:35], v[60:63], v[92:95]
    s_waitcnt lgkmcnt(4)
    v_mfma_f32_16x16x32_bf16 v[96:99], v[36:39], v[48:51], v[96:99]
    v_mfma_f32_16x16x32_bf16 v[100:103], v[36:39], v[52:55], v[100:103]
    v_mfma_f32_16x16x32_bf16 v[104:107], v[36:39], v[56:59], v[104:107]
    v_mfma_f32_16x16x32_bf16 v[108:111], v[36:39], v[60:63], v[108:111]
    s_waitcnt lgkmcnt(2)
    v_mfma_f32_16x16x32_bf16 v[112:115], v[40:43], v[48:51], v[112:115]
    v_mfma_f32_16x16x32_bf16 v[116:119], v[40:43], v[52:55], v[116:119]
    v_mfma_f32_16x16x32_bf16 v[120:123], v[40:43], v[56:59], v[120:123]
    v_mfma_f32_16x16x32_bf16 v[124:127], v[40:43], v[60:63], v[124:127]
    s_waitcnt lgkmcnt(0)
    v_mfma_f32_16x16x32_bf16 v[128:131], v[44:47], v[48:51], v[128:131]
    v_mfma_f32_16x16x32_bf16 v[132:135], v[44:47], v[52:55], v[132:135]
    v_mfma_f32_16x16x32_bf16 v[136:139], v[44:47], v[56:59], v[136:139]
    v_mfma_f32_16x16x32_bf16 v[140:143], v[44:47], v[60:63], v[140:143]
    v_subrev_u32 v5, 90112, v5
    v_subrev_u32 v6, 90112, v6
    v_subrev_u32 v20, 90112, v20
    v_subrev_u32 v21, 90112, v21
    v_subrev_u32 v22, 90112, v22
    v_subrev_u32 v23, 90112, v23
    v_subrev_u32 v24, 90112, v24
    s_waitcnt vmcnt(5)
    s_barrier
    ds_read_b64 v[48:49], v6 offset:40960
    ds_read_b64 v[50:51], v6 offset:41472
    ds_read_b64 v[52:53], v6 offset:41088
    ds_read_b64 v[54:55], v6 offset:41600
    ds_read_b64 v[56:57], v6 offset:41216
    ds_read_b64 v[58:59], v6 offset:41728
    ds_read_b64 v[60:61], v6 offset:41344
    ds_read_b64 v[62:63], v6 offset:41856
    ds_read_b64_tr_b16 v[28:29], v20 offset:0
    ds_read_b64_tr_b16 v[30:31], v20 offset:512
    ds_read_b64_tr_b16 v[32:33], v21 offset:0
    ds_read_b64_tr_b16 v[34:35], v21 offset:512
    ds_read_b64_tr_b16 v[36:37], v22 offset:0
    ds_read_b64_tr_b16 v[38:39], v22 offset:512
    s_waitcnt lgkmcnt(4)
    v_mfma_f32_16x16x32_bf16 v[64:67], v[28:31], v[48:51], v[64:67]
    ds_read_b64_tr_b16 v[40:41], v23 offset:0
    ds_read_b64_tr_b16 v[42:43], v23 offset:512
    v_mfma_f32_16x16x32_bf16 v[68:71], v[28:31], v[52:55], v[68:71]
    v_mfma_f32_16x16x32_bf16 v[72:75], v[28:31], v[56:59], v[72:75]
    v_mfma_f32_16x16x32_bf16 v[76:79], v[28:31], v[60:63], v[76:79]
    s_waitcnt lgkmcnt(4)
    v_mfma_f32_16x16x32_bf16 v[80:83], v[32:35], v[48:51], v[80:83]
    ds_read_b64_tr_b16 v[44:45], v24 offset:0
    ds_read_b64_tr_b16 v[46:47], v24 offset:512
    v_mfma_f32_16x16x32_bf16 v[84:87], v[32:35], v[52:55], v[84:87]
    v_mfma_f32_16x16x32_bf16 v[88:91], v[32:35], v[56:59], v[88:91]
    v_mfma_f32_16x16x32_bf16 v[92:95], v[32:35], v[60:63], v[92:95]
    s_waitcnt lgkmcnt(4)
    v_mfma_f32_16x16x32_bf16 v[96:99], v[36:39], v[48:51], v[96:99]
    v_mfma_f32_16x16x32_bf16 v[100:103], v[36:39], v[52:55], v[100:103]
    v_mfma_f32_16x16x32_bf16 v[104:107], v[36:39], v[56:59], v[104:107]
    v_mfma_f32_16x16x32_bf16 v[108:111], v[36:39], v[60:63], v[108:111]
    s_waitcnt lgkmcnt(2)
    v_mfma_f32_16x16x32_bf16 v[112:115], v[40:43], v[48:51], v[112:115]
    v_mfma_f32_16x16x32_bf16 v[116:119], v[40:43], v[52:55], v[116:119]
    v_mfma_f32_16x16x32_bf16 v[120:123], v[40:43], v[56:59], v[120:123]
    v_mfma_f32_16x16x32_bf16 v[124:127], v[40:43], v[60:63], v[124:127]
    s_waitcnt lgkmcnt(0)
    v_mfma_f32_16x16x32_bf16 v[128:131], v[44:47], v[48:51], v[128:131]
    v_mfma_f32_16x16x32_bf16 v[132:135], v[44:47], v[52:55], v[132:135]
    v_mfma_f32_16x16x32_bf16 v[136:139], v[44:47], v[56:59], v[136:139]
    v_mfma_f32_16x16x32_bf16 v[140:143], v[44:47], v[60:63], v[140:143]
    v_add_u32 v5, 45056, v5
    v_add_u32 v6, 45056, v6
    v_add_u32 v20, 45056, v20
    v_add_u32 v21, 45056, v21
    v_add_u32 v22, 45056, v22
    v_add_u32 v23, 45056, v23
    v_add_u32 v24, 45056, v24
    s_waitcnt vmcnt(0)
    s_barrier
    ds_read_b64 v[48:49], v6 offset:40960
    ds_read_b64 v[50:51], v6 offset:41472
    ds_read_b64 v[52:53], v6 offset:41088
    ds_read_b64 v[54:55], v6 offset:41600
    ds_read_b64 v[56:57], v6 offset:41216
    ds_read_b64 v[58:59], v6 offset:41728
    ds_read_b64 v[60:61], v6 offset:41344
    ds_read_b64 v[62:63], v6 offset:41856
    ds_read_b64_tr_b16 v[28:29], v20 offset:0
    ds_read_b64_tr_b16 v[30:31], v20 offset:512
    ds_read_b64_tr_b16 v[32:33], v21 offset:0
    ds_read_b64_tr_b16 v[34:35], v21 offset:512
    ds_read_b64_tr_b16 v[36:37], v22 offset:0
    ds_read_b64_tr_b16 v[38:39], v22 offset:512
    s_waitcnt lgkmcnt(4)
    v_mfma_f32_16x16x32_bf16 v[64:67], v[28:31], v[48:51], v[64:67]
    ds_read_b64_tr_b16 v[40:41], v23 offset:0
    ds_read_b64_tr_b16 v[42:43], v23 offset:512
    v_mfma_f32_16x16x32_bf16 v[68:71], v[28:31], v[52:55], v[68:71]
    v_mfma_f32_16x16x32_bf16 v[72:75], v[28:31], v[56:59], v[72:75]
    v_mfma_f32_16x16x32_bf16 v[76:79], v[28:31], v[60:63], v[76:79]
    s_waitcnt lgkmcnt(4)
    v_mfma_f32_16x16x32_bf16 v[80:83], v[32:35], v[48:51], v[80:83]
    ds_read_b64_tr_b16 v[44:45], v24 offset:0
    ds_read_b64_tr_b16 v[46:47], v24 offset:512
    v_mfma_f32_16x16x32_bf16 v[84:87], v[32:35], v[52:55], v[84:87]
    v_mfma_f32_16x16x32_bf16 v[88:91], v[32:35], v[56:59], v[88:91]
    v_mfma_f32_16x16x32_bf16 v[92:95], v[32:35], v[60:63], v[92:95]
    s_waitcnt lgkmcnt(4)
    v_mfma_f32_16x16x32_bf16 v[96:99], v[36:39], v[48:51], v[96:99]
    v_mfma_f32_16x16x32_bf16 v[100:103], v[36:39], v[52:55], v[100:103]
    v_mfma_f32_16x16x32_bf16 v[104:107], v[36:39], v[56:59], v[104:107]
    v_mfma_f32_16x16x32_bf16 v[108:111], v[36:39], v[60:63], v[108:111]
    s_waitcnt lgkmcnt(2)
    v_mfma_f32_16x16x32_bf16 v[112:115], v[40:43], v[48:51], v[112:115]
    v_mfma_f32_16x16x32_bf16 v[116:119], v[40:43], v[52:55], v[116:119]
    v_mfma_f32_16x16x32_bf16 v[120:123], v[40:43], v[56:59], v[120:123]
    v_mfma_f32_16x16x32_bf16 v[124:127], v[40:43], v[60:63], v[124:127]
    s_waitcnt lgkmcnt(0)
    v_mfma_f32_16x16x32_bf16 v[128:131], v[44:47], v[48:51], v[128:131]
    v_mfma_f32_16x16x32_bf16 v[132:135], v[44:47], v[52:55], v[132:135]
    v_mfma_f32_16x16x32_bf16 v[136:139], v[44:47], v[56:59], v[136:139]
    v_mfma_f32_16x16x32_bf16 v[140:143], v[44:47], v[60:63], v[140:143]
    s_mov_b32 s65, 81920
    v_cvt_pk_bf16_f32 v28, v64, v65
    v_cvt_pk_bf16_f32 v29, v66, v67
    v_cvt_pk_bf16_f32 v30, v68, v69
    v_cvt_pk_bf16_f32 v31, v70, v71
    s_nop 0
    v_permlane16_swap_b32 v28, v30
    v_permlane16_swap_b32 v29, v31
    buffer_store_dwordx4 v[28:31], v7, s[44:47], 0 offen offset:0
    v_cvt_pk_bf16_f32 v32, v72, v73
    v_cvt_pk_bf16_f32 v33, v74, v75
    v_cvt_pk_bf16_f32 v34, v76, v77
    v_cvt_pk_bf16_f32 v35, v78, v79
    s_nop 0
    v_permlane16_swap_b32 v32, v34
    v_permlane16_swap_b32 v33, v35
    buffer_store_dwordx4 v[32:35], v7, s[44:47], s65 offen offset:0
    v_cvt_pk_bf16_f32 v36, v80, v81
    v_cvt_pk_bf16_f32 v37, v82, v83
    v_cvt_pk_bf16_f32 v38, v84, v85
    v_cvt_pk_bf16_f32 v39, v86, v87
    s_nop 0
    v_permlane16_swap_b32 v36, v38
    v_permlane16_swap_b32 v37, v39
    buffer_store_dwordx4 v[36:39], v7, s[44:47], 0 offen offset:32
    v_cvt_pk_bf16_f32 v40, v88, v89
    v_cvt_pk_bf16_f32 v41, v90, v91
    v_cvt_pk_bf16_f32 v42, v92, v93
    v_cvt_pk_bf16_f32 v43, v94, v95
    s_nop 0
    v_permlane16_swap_b32 v40, v42
    v_permlane16_swap_b32 v41, v43
    buffer_store_dwordx4 v[40:43], v7, s[44:47], s65 offen offset:32
    v_cvt_pk_bf16_f32 v28, v96, v97
    v_cvt_pk_bf16_f32 v29, v98, v99
    v_cvt_pk_bf16_f32 v30, v100, v101
    v_cvt_pk_bf16_f32 v31, v102, v103
    s_nop 0
    v_permlane16_swap_b32 v28, v30
    v_permlane16_swap_b32 v29, v31
    buffer_store_dwordx4 v[28:31], v7, s[44:47], 0 offen offset:64
    v_cvt_pk_bf16_f32 v32, v104, v105
    v_cvt_pk_bf16_f32 v33, v106, v107
    v_cvt_pk_bf16_f32 v34, v108, v109
    v_cvt_pk_bf16_f32 v35, v110, v111
    s_nop 0
    v_permlane16_swap_b32 v32, v34
    v_permlane16_swap_b32 v33, v35
    buffer_store_dwordx4 v[32:35], v7, s[44:47], s65 offen offset:64
    v_cvt_pk_bf16_f32 v36, v112, v113
    v_cvt_pk_bf16_f32 v37, v114, v115
    v_cvt_pk_bf16_f32 v38, v116, v117
    v_cvt_pk_bf16_f32 v39, v118, v119
    s_nop 0
    v_permlane16_swap_b32 v36, v38
    v_permlane16_swap_b32 v37, v39
    buffer_store_dwordx4 v[36:39], v7, s[44:47], 0 offen offset:96
    v_cvt_pk_bf16_f32 v40, v120, v121
    v_cvt_pk_bf16_f32 v41, v122, v123
    v_cvt_pk_bf16_f32 v42, v124, v125
    v_cvt_pk_bf16_f32 v43, v126, v127
    s_nop 0
    v_permlane16_swap_b32 v40, v42
    v_permlane16_swap_b32 v41, v43
    buffer_store_dwordx4 v[40:43], v7, s[44:47], s65 offen offset:96
    v_cvt_pk_bf16_f32 v28, v128, v129
    v_cvt_pk_bf16_f32 v29, v130, v131
    v_cvt_pk_bf16_f32 v30, v132, v133
    v_cvt_pk_bf16_f32 v31, v134, v135
    s_nop 0
    v_permlane16_swap_b32 v28, v30
    v_permlane16_swap_b32 v29, v31
    buffer_store_dwordx4 v[28:31], v7, s[44:47], 0 offen offset:128
    v_cvt_pk_bf16_f32 v32, v136, v137
    v_cvt_pk_bf16_f32 v33, v138, v139
    v_cvt_pk_bf16_f32 v34, v140, v141
    v_cvt_pk_bf16_f32 v35, v142, v143
    s_nop 0
    v_permlane16_swap_b32 v32, v34
    v_permlane16_swap_b32 v33, v35
    buffer_store_dwordx4 v[32:35], v7, s[44:47], s65 offen offset:128
    s_waitcnt vmcnt(0)
L_a_done:
    s_mov_b32 s44, s26
    s_and_b32 s45, s27, 0xffff
    s_mov_b32 s46, 0x500000
    s_mov_b32 s47, 0x20000
    s_lshl_b32 s65, s62, 10
    s_add_u32 s65, s65, 0xa100000
    v_and_b32 v7, 7, v0
    v_lshl_add_u32 v3, v7, 7, s65
    s_lshl_b32 s65, s56, 17
    s_add_u32 s65, s65, 0xa010800
    v_mov_b32 v4, s65
    s_lshl_b32 s64, s62, 2
    s_add_u32 s65, s65, s64
    s_sub_u32 s65, s65, 768
    v_cmp_eq_u32 vcc, s56, v7
    v_mov_b32 v8, s65
    v_mov_b32 v6, 0x40000000
    v_cndmask_b32 v11, v6, v8, vcc
    v_cndmask_b32 v3, v3, v6, vcc
    v_cndmask_b32 v10, 0, 1, vcc
    v_mov_b32 v60, 0
    s_and_b32 s64, s57, 1
    s_mul_i32 s64, s64, 40
    v_add_u32 v6, s64, v0
    v_cmp_gt_u32 vcc, 40, v0
    s_mul_i32 s65, s56, 10240
    v_lshl_add_u32 v7, v6, 4, s65
    v_mov_b32 v2, 0x40000000
    v_cndmask_b32 v1, v2, v7, vcc
    v_and_b32 v8, 3, v0
    v_mul_u32_u24 v8, 2560, v8
    v_lshrrev_b32 v6, 2, v6
    v_lshl_add_u32 v8, v6, 4, v8
    s_mul_i32 s65, s56, 10240
    s_mul_i32 s64, s62, 320
    s_add_u32 s65, s65, s64
    s_add_u32 s65, s65, 1280
    v_add_u32 v8, s65, v8
    v_cndmask_b32 v2, v2, v8, vcc
    s_lshr_b32 s59, s57, 1
    s_mul_i32 s68, s62, 81920
    s_mul_i32 s64, s59, 327680
    s_add_u32 s68, s68, s64
    s_add_u32 s68, s68, 0x6c00000
    s_mov_b32 s40, 0x3f80
    s_mov_b32 s41, 0x3f800000
    v_and_b32 v9, 7, v0
    v_lshlrev_b32 v9, 2, v9
    s_mov_b32 s70, 0
    s_mov_b32 s66, 0
    v_mov_b32 v5, 0
    s_mov_b32 s67, 0
L_red_loop:
    s_barrier
    s_add_u32 s65, s66, 12
    s_cmp_ge_u32 s67, s65
    s_cbranch_scc1 L_red_nw
    s_cmp_lg_u32 s57, 0
    s_cbranch_scc1 L_red_nw
    s_mov_b64 exec, 0xff
L_red_tick:
    s_add_u32 s65, s70, 1
    s_min_u32 s65, s65, 64
L_red_t:
    buffer_load_dword v8, v4, s[32:35], 0 offen sc1
    s_waitcnt vmcnt(0)
    v_cmp_gt_i32 vcc, s65, v8
    s_cbranch_vccnz L_retry_63
L_ok_64:
    v_readfirstlane_b32 s70, v8
    s_cmp_eq_u32 s60, 0
    s_cselect_b32 s65, 62, 0
    v_sub_u32 v7, v5, v10
    v_add_u32 v7, v7, v60
    v_max_i32 v7, s65, v7
    v_mov_b32 v5, 0
    buffer_atomic_add v5, v3, s[32:35], 0 offen sc0
    buffer_load_dword v60, v11, s[32:35], 0 offen sc1
    v_cmp_ge_u32 vcc, s66, v7
    s_cbranch_vccnz L_retry_65
L_ok_66:
    ds_write_b32 v9, v7
    s_waitcnt lgkmcnt(0)
    s_mov_b64 exec, -1
L_red_nw:
    s_barrier
    ds_read_b32 v6, v9
    s_waitcnt lgkmcnt(0)
    v_min_u32_dpp v6, v6, v6 quad_perm:[1,0,3,2] row_mask:0xf bank_mask:0xf
    s_nop 1
    v_min_u32_dpp v6, v6, v6 quad_perm:[2,3,0,1] row_mask:0xf bank_mask:0xf
    s_nop 1
    v_min_u32_dpp v6, v6, v6 row_half_mirror row_mask:0xf bank_mask:0xf
    s_nop 1
    v_readfirstlane_b32 s67, v6
    s_add_u32 s66, s66, 4
    s_nop 1
    s_min_u32 s66, s66, s67
    s_cmp_ge_u32 s59, s66
    s_cbranch_scc1 L_red_next
    s_add_u32 s64, s68, 0
    buffer_load_dwordx4 v[12:15], v1, s[32:35], s64 offen offset:0 sc1
    buffer_load_dwordx4 v[16:19], v1, s[32:35], s64 offen offset:1280 sc1
    buffer_load_dwordx4 v[20:23], v1, s[32:35], s64 offen offset:2560 sc1
    buffer_load_dwordx4 v[24:27], v1, s[32:35], s64 offen offset:3840 sc1
    s_add_u32 s64, s68, 5120
    buffer_load_dwordx4 v[28:31], v1, s[32:35], s64 offen offset:0 sc1
    buffer_load_dwordx4 v[32:35], v1, s[32:35], s64 offen offset:1280 sc1
    buffer_load_dwordx4 v[36:39], v1, s[32:35], s64 offen offset:2560 sc1
    buffer_load_dwordx4 v[40:43], v1, s[32:35], s64 offen offset:3840 sc1
    s_add_u32 s68, s68, 1310720
    s_mul_i32 s69, s59, 81920
    s_waitcnt vmcnt(7)
    v_dot2_f32_bf16 v44, v12, s40, 0
    v_dot2_f32_bf16 v45, v12, s41, 0
    v_dot2_f32_bf16 v46, v13, s40, 0
    v_dot2_f32_bf16 v47, v13, s41, 0
    v_dot2_f32_bf16 v48, v14, s40, 0
    v_dot2_f32_bf16 v49, v14, s41, 0
    v_dot2_f32_bf16 v50, v15, s40, 0
    v_dot2_f32_bf16 v51, v15, s41, 0
    s_waitcnt vmcnt(6)
    v_dot2_f32_bf16 v44, v16, s40, v44
    v_dot2_f32_bf16 v45, v16, s41, v45
    v_dot2_f32_bf16 v46, v17, s40, v46
    v_dot2_f32_bf16 v47, v17, s41, v47
    v_dot2_f32_bf16 v48, v18, s40, v48
    v_dot2_f32_bf16 v49, v18, s41, v49
    v_dot2_f32_bf16 v50, v19, s40, v50
    v_dot2_f32_bf16 v51, v19, s41, v51
    s_waitcnt vmcnt(5)
    v_dot2_f32_bf16 v44, v20, s40, v44
    v_dot2_f32_bf16 v45, v20, s41, v45
    v_dot2_f32_bf16 v46, v21, s40, v46
    v_dot2_f32_bf16 v47, v21, s41, v47
    v_dot2_f32_bf16 v48, v22, s40, v48
    v_dot2_f32_bf16 v49, v22, s41, v49
    v_dot2_f32_bf16 v50, v23, s40, v50
    v_dot2_f32_bf16 v51, v23, s41, v51
    s_waitcnt vmcnt(4)
    v_dot2_f32_bf16 v44, v24, s40, v44
    v_dot2_f32_bf16 v45, v24, s41, v45
    v_dot2_f32_bf16 v46, v25, s40, v46
    v_dot2_f32_bf16 v47, v25, s41, v47
    v_dot2_f32_bf16 v48, v26, s40, v48
    v_dot2_f32_bf16 v49, v26, s41, v49
    v_dot2_f32_bf16 v50, v27, s40, v50
    v_dot2_f32_bf16 v51, v27, s41, v51
    s_waitcnt vmcnt(3)
    v_dot2_f32_bf16 v44, v28, s40, v44
    v_dot2_f32_bf16 v45, v28, s41, v45
    v_dot2_f32_bf16 v46, v29, s40, v46
    v_dot2_f32_bf16 v47, v29, s41, v47
    v_dot2_f32_bf16 v48, v30, s40, v48
    v_dot2_f32_bf16 v49, v30, s41, v49
    v_dot2_f32_bf16 v50, v31, s40, v50
    v_dot2_f32_bf16 v51, v31, s41, v51
    s_waitcnt vmcnt(2)
    v_dot2_f32_bf16 v44, v32, s40, v44
    v_dot2_f32_bf16 v45, v32, s41, v45
    v_dot2_f32_bf16 v46, v33, s40, v46
    v_dot2_f32_bf16 v47, v33, s41, v47
    v_dot2_f32_bf16 v48, v34, s40, v48
    v_dot2_f32_bf16 v49, v34, s41, v49
    v_dot2_f32_bf16 v50, v35, s40, v50
    v_dot2_f32_bf16 v51, v35, s41, v51
    s_waitcnt vmcnt(1)
    v_dot2_f32_bf16 v44, v36, s40, v44
    v_dot2_f32_bf16 v45, v36, s41, v45
    v_dot2_f32_bf16 v46, v37, s40, v46
    v_dot2_f32_bf16 v47, v37, s41, v47
    v_dot2_f32_bf16 v48, v38, s40, v48
    v_dot2_f32_bf16 v49, v38, s41, v49
    v_dot2_f32_bf16 v50, v39, s40, v50
    v_dot2_f32_bf16 v51, v39, s41, v51
    s_waitcnt vmcnt(0)
    v_dot2_f32_bf16 v44, v40, s40, v44
    v_dot2_f32_bf16 v45, v40, s41, v45
    v_dot2_f32_bf16 v46, v41, s40, v46
    v_dot2_f32_bf16 v47, v41, s41, v47
    v_dot2_f32_bf16 v48, v42, s40, v48
    v_dot2_f32_bf16 v49, v42, s41, v49
    v_dot2_f32_bf16 v50, v43, s40, v50
    v_dot2_f32_bf16 v51, v43, s41, v51
    s_add_u32 s59, s59, 4
    v_cvt_pk_bf16_f32 v52, v44, v45
    v_cvt_pk_bf16_f32 v53, v46, v47
    v_cvt_pk_bf16_f32 v54, v48, v49
    v_cvt_pk_bf16_f32 v55, v50, v51
    buffer_store_dwordx4 v[52:55], v2, s[44:47], s69 offen
L_red_next:
    s_cmp_lt_u32 s66, 62
    s_cbranch_scc1 L_red_loop
    s_cmp_ge_u32 s59, 64
    s_cbranch_scc1 L_red_end
    s_cmp_eq_u32 s59, 63
    s_cselect_b32 s65, 9, 0
    v_min_u32 v7, s65, v0
    s_lshl_b32 s65, s62, 2
    s_add_u32 s65, s65, 66832
    s_cmp_eq_u32 s59, 63
    s_cselect_b32 s65, 69632, s65
    s_sub_u32 s65, s65, 67584
    v_lshl_add_u32 v7, v7, 2, v4
    v_add_u32 v7, s65, v7
    s_mov_b32 s65, 1
L_red_lw:
    buffer_load_dword v8, v7, s[32:35], 0 offen sc1
    s_waitcnt vmcnt(0)
    v_cmp_gt_i32 vcc, s65, v8
    s_cbranch_vccnz L_retry_67
L_ok_68:
L_red_last:
    s_add_u32 s64, s68, 0
    buffer_load_dwordx4 v[12:15], v1, s[32:35], s64 offen offset:0 sc1
    buffer_load_dwordx4 v[16:19], v1, s[32:35], s64 offen offset:1280 sc1
    buffer_load_dwordx4 v[20:23], v1, s[32:35], s64 offen offset:2560 sc1
    buffer_load_dwordx4 v[24:27], v1, s[32:35], s64 offen offset:3840 sc1
    s_add_u32 s64, s68, 5120
    buffer_load_dwordx4 v[28:31], v1, s[32:35], s64 offen offset:0 sc1
    buffer_load_dwordx4 v[32:35], v1, s[32:35], s64 offen offset:1280 sc1
    buffer_load_dwordx4 v[36:39], v1, s[32:35], s64 offen offset:2560 sc1
    buffer_load_dwordx4 v[40:43], v1, s[32:35], s64 offen offset:3840 sc1
    s_mul_i32 s69, s59, 81920
    s_waitcnt vmcnt(7)
    v_max3_u32 v6, v12, v13, 0
    v_max3_u32 v6, v14, v15, v6
    v_dot2_f32_bf16 v44, v12, s40, 0
    v_dot2_f32_bf16 v45, v12, s41, 0
    v_dot2_f32_bf16 v46, v13, s40, 0
    v_dot2_f32_bf16 v47, v13, s41, 0
    v_dot2_f32_bf16 v48, v14, s40, 0
    v_dot2_f32_bf16 v49, v14, s41, 0
    v_dot2_f32_bf16 v50, v15, s40, 0
    v_dot2_f32_bf16 v51, v15, s41, 0
    s_waitcnt vmcnt(6)
    v_max3_u32 v6, v16, v17, v6
    v_max3_u32 v6, v18, v19, v6
    v_dot2_f32_bf16 v44, v16, s40, v44
    v_dot2_f32_bf16 v45, v16, s41, v45
    v_dot2_f32_bf16 v46, v17, s40, v46
    v_dot2_f32_bf16 v47, v17, s41, v47
    v_dot2_f32_bf16 v48, v18, s40, v48
    v_dot2_f32_bf16 v49, v18, s41, v49
    v_dot2_f32_bf16 v50, v19, s40, v50
    v_dot2_f32_bf16 v51, v19, s41, v51
    s_waitcnt vmcnt(5)
    v_max3_u32 v6, v20, v21, v6
    v_max3_u32 v6, v22, v23, v6
    v_dot2_f32_bf16 v44, v20, s40, v44
    v_dot2_f32_bf16 v45, v20, s41, v45
    v_dot2_f32_bf16 v46, v21, s40, v46
    v_dot2_f32_bf16 v47, v21, s41, v47
    v_dot2_f32_bf16 v48, v22, s40, v48
    v_dot2_f32_bf16 v49, v22, s41, v49
    v_dot2_f32_bf16 v50, v23, s40, v50
    v_dot2_f32_bf16 v51, v23, s41, v51
    s_waitcnt vmcnt(4)
    v_max3_u32 v6, v24, v25, v6
    v_max3_u32 v6, v26, v27, v6
    v_dot2_f32_bf16 v44, v24, s40, v44
    v_dot2_f32_bf16 v45, v24, s41, v45
    v_dot2_f32_bf16 v46, v25, s40, v46
    v_dot2_f32_bf16 v47, v25, s41, v47
    v_dot2_f32_bf16 v48, v26, s40, v48
    v_dot2_f32_bf16 v49, v26, s41, v49
    v_dot2_f32_bf16 v50, v27, s40, v50
    v_dot2_f32_bf16 v51, v27, s41, v51
    s_waitcnt vmcnt(3)
    v_max3_u32 v6, v28, v29, v6
    v_max3_u32 v6, v30, v31, v6
    v_dot2_f32_bf16 v44, v28, s40, v44
    v_dot2_f32_bf16 v45, v28, s41, v45
    v_dot2_f32_bf16 v46, v29, s40, v46
    v_dot2_f32_bf16 v47, v29, s41, v47
    v_dot2_f32_bf16 v48, v30, s40, v48
    v_dot2_f32_bf16 v49, v30, s41, v49
    v_dot2_f32_bf16 v50, v31, s40, v50
    v_dot2_f32_bf16 v51, v31, s41, v51
    s_waitcnt vmcnt(2)
    v_max3_u32 v6, v32, v33, v6
    v_max3_u32 v6, v34, v35, v6
    v_dot2_f32_bf16 v44, v32, s40, v44
    v_dot2_f32_bf16 v45, v32, s41, v45
    v_dot2_f32_bf16 v46, v33, s40, v46
    v_dot2_f32_bf16 v47, v33, s41, v47
    v_dot2_f32_bf16 v48, v34, s40, v48
    v_dot2_f32_bf16 v49, v34, s41, v49
    v_dot2_f32_bf16 v50, v35, s40, v50
    v_dot2_f32_bf16 v51, v35, s41, v51
    s_waitcnt vmcnt(1)
    v_max3_u32 v6, v36, v37, v6
    v_max3_u32 v6, v38, v39, v6
    v_dot2_f32_bf16 v44, v36, s40, v44
    v_dot2_f32_bf16 v45, v36, s41, v45
    v_dot2_f32_bf16 v46, v37, s40, v46
    v_dot2_f32_bf16 v47, v37, s41, v47
    v_dot2_f32_bf16 v48, v38, s40, v48
    v_dot2_f32_bf16 v49, v38, s41, v49
    v_dot2_f32_bf16 v50, v39, s40, v50
    v_dot2_f32_bf16 v51, v39, s41, v51
    s_waitcnt vmcnt(0)
    v_max3_u32 v6, v40, v41, v6
    v_max3_u32 v6, v42, v43, v6
    v_dot2_f32_bf16 v44, v40, s40, v44
    v_dot2_f32_bf16 v45, v40, s41, v45
    v_dot2_f32_bf16 v46, v41, s40, v46
    v_dot2_f32_bf16 v47, v41, s41, v47
    v_dot2_f32_bf16 v48, v42, s40, v48
    v_dot2_f32_bf16 v49, v42, s41, v49
    v_dot2_f32_bf16 v50, v43, s40, v50
    v_dot2_f32_bf16 v51, v43, s41, v51
    v_cmp_eq_u32 vcc, -1, v6
    s_cbranch_vccnz L_retry_69
L_ok_70:
    v_cvt_pk_bf16_f32 v52, v44, v45
    v_cvt_pk_bf16_f32 v53, v46, v47
    v_cvt_pk_bf16_f32 v54, v48, v49
    v_cvt_pk_bf16_f32 v55, v50, v51
    buffer_store_dwordx4 v[52:55], v2, s[44:47], s69 offen
L_red_end:
    s_endpgm
L_retry_5:
    s_sub_u32 s60, s60, 1
    s_cbranch_scc0 L_wrdy_4s
    s_mov_b32 s60, 0
    s_branch L_ok_6
L_wrdy_4s:
    s_sleep 8
    s_branch L_wrdy_4
L_pqk_nan:
    v_max3_u32 v90, v16, v17, v18
    v_max3_u32 v90, v90, v19, v20
    v_max3_u32 v90, v90, v21, v22
    v_max3_u32 v90, v90, v23, v24
    v_max3_u32 v90, v90, v25, v26
    v_max3_u32 v90, v90, v27, v28
    v_max3_u32 v90, v90, v29, v30
    v_max3_u32 v90, v90, v31, v32
    v_max3_u32 v90, v90, v33, v34
    v_max3_u32 v90, v90, v35, v36
    v_max3_u32 v90, v90, v37, v38
    v_max3_u32 v90, v90, v39, v40
    v_max3_u32 v90, v90, v41, v42
    v_max3_u32 v90, v90, v43, v44
    v_max3_u32 v90, v90, v45, v46
    v_max3_u32 v90, v90, v47, v48
    v_max3_u32 v90, v90, v49, v50
    v_max3_u32 v90, v90, v51, v52
    v_max3_u32 v90, v90, v53, v54
    v_max_u32 v90, v90, v55
    v_cmp_eq_u32 vcc, -1, v90
    s_cbranch_vccz L_pqk_ok
    s_sub_u32 s68, s68, 1
    s_cbranch_scc0 L_pqk_redo
    s_mov_b32 s68, 0
    s_branch L_pqk_ok
L_pqk_redo:
    v_mov_b32 v88, 0
    v_mov_b32 v89, 0
    v_mov_b32 v90, 0
    v_mov_b32 v91, 0
    v_mov_b32 v92, 0
    v_mov_b32 v93, 0
    v_mov_b32 v94, 0
    v_mov_b32 v95, 0
    s_waitcnt lgkmcnt(0)
    s_barrier
    s_branch L_pqk_a
L_retry_8:
    s_sub_u32 s60, s60, 1
    s_cbranch_scc0 L_pv_wfree_s
    s_mov_b32 s60, 0
    s_branch L_ok_9
L_pv_wfree_s:
    s_sleep 1
    s_branch L_pv_wfree
L_retry_10:
    s_sub_u32 s60, s60, 1
    s_cbranch_scc0 L_pv_hint
    s_mov_b32 s60, 0
    s_branch L_ok_11
L_retry_5001:
    s_sub_u32 s60, s60, 1
    s_cbranch_scc0 L_pv_again
    s_mov_b32 s60, 0
    s_branch L_ok_5002
L_pv_again:
    s_waitcnt lgkmcnt(0)
    s_branch L_pv_poll
L_pv_redo:
    v_mov_b32 v56, 0
    v_mov_b32 v57, 0
    v_mov_b32 v58, 0
    v_mov_b32 v59, 0
    s_barrier
L_pv_poll:
    buffer_load_dwordx4 v[64:67], v8, s[40:43], 0 offen sc1
    buffer_load_dwordx4 v[68:71], v8, s[40:43], 0 offen offset:1024 sc1
    buffer_load_dword v72, v9, s[40:43], 0 offen offset:2048 sc1
    buffer_load_dword v73, v9, s[40:43], 0 offen offset:2304 sc1
    s_waitcnt vmcnt(3)
    ds_write_b128 v10, v[64:67]
    v_max3_u32 v88, v64, v65, v66
    s_waitcnt vmcnt(2)
    ds_write_b128 v10, v[68:71] offset:1024
    v_max3_u32 v88, v88, v67, v68
    v_max3_u32 v88, v88, v69, v70
    s_waitcnt vmcnt(0)
    ds_write2st64_b32 v11, v72, v73 offset1:1
    v_max3_u32 v88, v88, v71, v72
    v_max_u32 v88, v88, v73
    v_cmp_eq_u32 vcc, -1, v88
    s_cbranch_vccnz L_retry_5001
L_ok_5002:
    s_waitcnt lgkmcnt(0)
    s_branch L_pv_a
L_pv_nan:
    v_max3_u32 v89, v16, v17, v18
    v_max3_u32 v89, v89, v19, v20
    v_max3_u32 v89, v89, v21, v22
    v_max3_u32 v89, v89, v23, v24
    v_max3_u32 v89, v89, v25, v26
    v_max3_u32 v89, v89, v27, v28
    v_max3_u32 v89, v89, v29, v30
    v_max3_u32 v89, v89, v31, v32
    v_max3_u32 v89, v89, v33, v34
    v_max3_u32 v89, v89, v35, v36
    v_max3_u32 v89, v89, v37, v38
    v_max3_u32 v89, v89, v39, v40
    v_max3_u32 v89, v89, v41, v42
    v_max3_u32 v89, v89, v43, v44
    v_max3_u32 v89, v89, v45, v46
    v_max3_u32 v89, v89, v47, v48
    v_max3_u32 v89, v89, v49, v50
    v_max3_u32 v89, v89, v51, v52
    v_max3_u32 v89, v89, v53, v54
    v_max_u32 v89, v89, v55
    v_cmp_eq_u32 vcc, -1, v89
    s_cbranch_vccz L_pv_ok
    s_sub_u32 s68, s68, 1
    s_cbranch_scc0 L_pv_redo
    s_mov_b32 s68, 0
    s_branch L_pv_ok
L_retry_13:
    s_sub_u32 s60, s60, 1
    s_cbranch_scc0 L_os_hint
    s_mov_b32 s60, 0
    s_branch L_ok_14
L_retry_15:
    s_sub_u32 s60, s60, 1
    s_cbranch_scc0 L_os_vre
    s_mov_b32 s60, 0
    s_branch L_ok_16
L_os_vre:
    buffer_load_dwordx4 v[112:115], v11, s[44:47], 0 offen offset:0 sc1
    buffer_load_dwordx4 v[116:119], v11, s[44:47], 0 offen offset:1024 sc1
    buffer_load_dwordx4 v[120:123], v11, s[44:47], 0 offen offset:2048 sc1
    s_nop 2
    v_mov_b32 v124, 0
    v_mov_b32 v125, 0
    v_mov_b32 v126, 0
    v_mov_b32 v127, 0
    v_mov_b32 v128, 0
    v_mov_b32 v129, 0
    v_mov_b32 v130, 0
    v_mov_b32 v131, 0
    v_mov_b32 v132, 0
    v_mov_b32 v133, 0
    v_mov_b32 v134, 0
    v_mov_b32 v135, 0
    v_mov_b32 v136, 0
    v_mov_b32 v137, 0
    v_mov_b32 v138, 0
    v_mov_b32 v139, 0
    s_nop 0
    s_branch L_os_pollv
L_os_r0:
    s_sub_u32 s60, s60, 1
    s_cbranch_scc1 L_os_x0
    buffer_load_dwordx4 v[64:67], v150, s[52:55], 0 offen sc1
    buffer_load_dwordx4 v[68:71], v151, s[52:55], 0 offen sc1
    s_branch L_os_c1
L_os_x0:
    s_mov_b32 s60, 0
    s_branch L_os_g0
L_os_r1:
    s_sub_u32 s60, s60, 1
    s_cbranch_scc1 L_os_x1
    buffer_load_dwordx4 v[72:75], v152, s[52:55], 0 offen sc1
    buffer_load_dwordx4 v[76:79], v153, s[52:55], 0 offen sc1
    s_branch L_os_c0
L_os_x1:
    s_mov_b32 s60, 0
    s_branch L_os_g1
L_retry_17:
    s_sub_u32 s60, s60, 1
    s_cbranch_scc0 L_os_lw
    s_mov_b32 s60, 0
    s_branch L_ok_18
L_retry_22:
    s_sub_u32 s60, s60, 1
    s_cbranch_scc0 L_wrdy_21s
    s_mov_b32 s60, 0
    s_branch L_ok_23
L_wrdy_21s:
    s_sleep 8
    s_branch L_wrdy_21
L_retry_26:
    s_sub_u32 s60, s60, 1
    s_cbranch_scc0 L_wrdy_25w
    s_mov_b32 s60, 0
    s_branch L_ok_27
L_wrdy_25w:
    s_sleep 1
    s_branch L_wrdy_25v
L_retry_28:
    s_sub_u32 s60, s60, 1
    s_cbranch_scc0 L_os_sre
    s_mov_b32 s60, 0
    s_branch L_ok_29
L_os_sre:
    buffer_load_dword v48, v14, s[44:47], 0 offen offset:0 sc1
    buffer_load_dword v49, v14, s[44:47], 0 offen offset:256 sc1
    buffer_load_dword v50, v15, s[44:47], 0 offen offset:512 sc1
    buffer_load_dword v51, v14, s[44:47], 0 offen offset:768 sc1
    buffer_load_dword v52, v14, s[44:47], 0 offen offset:1024 sc1
    buffer_load_dword v53, v15, s[44:47], 0 offen offset:1280 sc1
    buffer_load_dword v54, v14, s[44:47], 0 offen offset:1536 sc1
    buffer_load_dword v55, v14, s[44:47], 0 offen offset:1792 sc1
    buffer_load_dword v56, v15, s[44:47], 0 offen offset:2048 sc1
    s_branch L_os_polls
L_retry_30:
    s_sub_u32 s60, s60, 1
    s_cbranch_scc0 L_ou_vf
    s_mov_b32 s60, 0
    s_branch L_ok_31
L_retry_35:
    s_sub_u32 s60, s60, 1
    s_cbranch_scc0 L_wrdy_34s
    s_mov_b32 s60, 0
    s_branch L_ok_36
L_wrdy_34s:
    s_sleep 8
    s_branch L_wrdy_34
L_retry_37:
    s_sub_u32 s60, s60, 1
    s_cbranch_scc0 L_ax_w1_s
    s_mov_b32 s60, 0
    s_branch L_ok_38
L_ax_w1_s:
    s_sleep 8
    s_branch L_ax_w1
L_retry_39:
    s_sub_u32 s60, s60, 1
    s_cbranch_scc0 L_ax_w2_s
    s_mov_b32 s60, 0
    s_branch L_ok_40
L_ax_w2_s:
    s_sleep 1
    s_branch L_ax_w2
L_retry_41:
    s_sub_u32 s60, s60, 1
    s_cbranch_scc0 L_ax_w3_s
    s_mov_b32 s60, 0
    s_branch L_ok_42
L_ax_w3_s:
    s_sleep 2
    s_branch L_ax_w3
L_retry_46:
    s_sub_u32 s60, s60, 1
    s_cbranch_scc0 L_wrdy_45s
    s_mov_b32 s60, 0
    s_branch L_ok_47
L_wrdy_45s:
    s_sleep 8
    s_branch L_wrdy_45
L_retry_48:
    s_sub_u32 s60, s60, 1
    s_cbranch_scc0 L_wrdy_45w
    s_mov_b32 s60, 0
    s_branch L_ok_49
L_wrdy_45w:
    s_sleep 16
    s_branch L_wrdy_45v
L_retry_50:
    s_sub_u32 s60, s60, 1
    s_cbranch_scc0 L_ox_wb_s
    s_mov_b32 s60, 0
    s_branch L_ok_51
L_ox_wb_s:
    s_sleep 1
    s_branch L_ox_wb
L_retry_53:
    s_sub_u32 s60, s60, 1
    s_cbranch_scc0 L_cols
    s_mov_b32 s60, 0
    s_branch L_ok_54
L_cols:
    s_sleep 8
    s_branch L_col
L_retry_57:
    s_sub_u32 s60, s60, 1
    s_cbranch_scc0 L_wrdy_56s
    s_mov_b32 s60, 0
    s_branch L_ok_58
L_wrdy_56s:
    s_sleep 8
    s_branch L_wrdy_56
L_retry_59:
    s_sub_u32 s60, s60, 1
    s_cbranch_scc0 L_wrdy_56w
    s_mov_b32 s60, 0
    s_branch L_ok_60
L_wrdy_56w:
    s_sleep 16
    s_branch L_wrdy_56v
L_retry_61:
    s_sub_u32 s60, s60, 1
    s_cbranch_scc0 L_a_w1_s
    s_mov_b32 s60, 0
    s_branch L_ok_62
L_a_w1_s:
    s_sleep 16
    s_branch L_a_w1
L_retry_63:
    s_sub_u32 s60, s60, 1
    s_cbranch_scc0 L_red_t_s
    s_mov_b32 s60, 0
    s_branch L_ok_64
L_red_t_s:
    s_sleep 2
    s_branch L_red_t
L_retry_65:
    s_sub_u32 s60, s60, 1
    s_cbranch_scc0 L_red_tick
    s_mov_b32 s60, 0
    s_branch L_ok_66
L_retry_67:
    s_sub_u32 s60, s60, 1
    s_cbranch_scc0 L_red_lw_s
    s_mov_b32 s60, 0
    s_branch L_ok_68
L_red_lw_s:
    s_sleep 0
    s_branch L_red_lw
L_retry_69:
    s_sub_u32 s60, s60, 1
    s_cbranch_scc0 L_red_last
    s_mov_b32 s60, 0
    s_branch L_ok_70
L_code_end:
.section .rodata,"a"
.p2align 6
.amdhsa_kernel concat_heads__linear_kernel_hedgehog__memory_aug_recurrent_mem_tr__prompt_kernel
  .amdhsa_next_free_vgpr 256
  .amdhsa_next_free_sgpr 102
  .amdhsa_accum_offset 256
  .amdhsa_group_segment_fixed_size 0
  .amdhsa_kernarg_size 112
  .amdhsa_user_sgpr_count 2
  .amdhsa_user_sgpr_kernarg_segment_ptr 1
  .amdhsa_system_sgpr_workgroup_id_x 1
  .amdhsa_float_denorm_mode_32 3
.end_amdhsa_kernel
```
